```python
import torch

def _softmax(x, axis=-1):
    return torch.softmax(x, dim=axis)
def _gelu(x):
    return torch.nn.functional.gelu(x, approximate="tanh")
def _silu(x):
    return torch.nn.functional.silu(x)
def _sigmoid(x):
    return torch.sigmoid(x)
def _layernorm(x, axis=-1, eps=1e-5):
    m = x.mean(dim=axis, keepdim=True)
    v = x.var(dim=axis, keepdim=True, unbiased=False)
    return (x - m) / torch.sqrt(v + eps)
def _scatter_add(tgt, idx, src, axis=0):
    return tgt.clone().index_add_(axis, idx, src)
def _segment_sum(src, seg, n):
    out = torch.zeros((n,) + src.shape[1:], dtype=src.dtype)
    return out.index_add_(0, seg, src)
def _pad(x, pw):
    flat = tuple(v for pair in reversed(pw) for v in pair)
    return torch.nn.functional.pad(x, flat)

kernel_name = 'sequential_preLN__spectral_gfnet__mixer_channel_mlp__prompt'

def setup_inputs():

    _w = (lambda a: (lambda t: t.to(torch.bfloat16) if t.is_floating_point() else t)(torch.as_tensor(a)))
    def _A_setup():
        B, S, D = 1, 2048, 640
        Df = D // 2 + 1
        return {
            "x": _w((lambda *s: torch.randn(*s, dtype=torch.bfloat16) * 0.05)(B, S, D)),
            "w_r": _w((lambda *s: torch.randn(*s, dtype=torch.bfloat16) * 0.8)(S, Df) * 0.02),
            "w_i": _w((lambda *s: torch.randn(*s, dtype=torch.bfloat16) * 0.8)(S, Df) * 0.02),
        }
    _A_in = _A_setup()

    def _B_setup():
        B, S, D, F = 1, 2048, 640, 1728
        return {
            "x": _w((lambda *s: torch.randn(*s, dtype=torch.bfloat16) * 0.05)(B, S, D)),
            "w1": _w((lambda *s: torch.randn(*s, dtype=torch.bfloat16) * 0.8)(D, F) * (D ** -0.5)),
            "b1": _w((lambda *s: torch.randn(*s, dtype=torch.bfloat16) * 0.4)(F)),
            "w2": _w((lambda *s: torch.randn(*s, dtype=torch.bfloat16) * 0.05)(F, D) * (F ** -0.5)),
            "b2": _w((lambda *s: torch.randn(*s, dtype=torch.bfloat16) * 0.05)(D)),
        }
    _B_in = _B_setup()

    return {
        "A_x": _A_in["x"],
        "A_w_r": _A_in["w_r"],
        "A_w_i": _A_in["w_i"],
        "B_x": _B_in["x"],
        "B_w1": _B_in["w1"],
        "B_b1": _B_in["b1"],
        "B_w2": _B_in["w2"],
        "B_b2": _B_in["b2"],
    }

def reference(A_x, A_w_r, A_w_i, B_x, B_w1, B_b1, B_w2, B_b2):
    def _A_ref(x, w_r, w_i):
        B, S, D = x.shape
        X = (lambda x, axes=(-2,-1): torch.fft.rfft2(x.float(), dim=axes))(x, axes=(-2, -1))
        W = w_r + 1j * w_i
        X = X * W
        y = (lambda x, s, axes=(-2,-1): torch.fft.irfft2(x, s=s, dim=axes).to(torch.bfloat16))(X, (S, D), axes=(-2, -1))
        return y

    def _B_ref(x, w1, b1, w2, b2):
        y = _layernorm(x, axis=-1)
        h = _gelu(torch.einsum("bsd,df->bsf", y, w1) + b1)
        return torch.einsum("bsf,fd->bsd", h, w2) + b2

    x = A_x
    h = x + _A_ref(_layernorm(x, axis=-1), A_w_r, A_w_i)
    h2 = h + _B_ref(_layernorm(h, axis=-1), B_w1, B_b1, B_w2, B_b2)
    return h2
```

```asm
; @launch kernel=k1_kernel grid=(256,1,1) block=(320,1,1) lds=63488
; @launch kernel=k2_kernel grid=(708,1,1) block=(256,1,1) lds=69632
; @launch kernel=k3_kernel grid=(256,1,1) block=(320,1,1) lds=66560
; @launch kernel=k4_kernel grid=(256,1,1) block=(256,1,1) lds=122880
; @launch kernel=k5_kernel grid=(256,1,1) block=(256,1,1) lds=147456
.amdgcn_target "amdgcn-amd-amdhsa--gfx950"
.text
.globl k1_kernel
.p2align 8
.type k1_kernel,@function
k1_kernel:
  s_cmp_ge_u32 s2, 256
  s_cbranch_scc1 L_k1_done
  s_load_dwordx2 s[4:5], s[0:1], 0
  s_load_dwordx2 s[6:7], s[0:1], 80
  v_readfirstlane_b32 s16, v0
  s_lshr_b32 s16, s16, 6
  s_mov_b32 s40, 0x3f3504f3
  s_mov_b32 s41, 0xbf3504f3
  s_mov_b32 s42, 0xbf3504f3
  s_mov_b32 s43, 0xbf3504f3
  s_mov_b32 s44, 0x3e9e377a
  s_mov_b32 s45, 0x3e9e377a
  s_mov_b32 s46, 0xbf4f1bbd
  s_mov_b32 s47, 0xbf4f1bbd
  s_mov_b32 s48, 0x3f737871
  s_mov_b32 s49, 0x3f737871
  s_mov_b32 s50, 0x3f167918
  s_mov_b32 s51, 0x3f167918
  s_mov_b32 s52, 0xbf737871
  s_mov_b32 s53, 0xbf737871
  s_mov_b32 s54, 0x3f800000
  s_mov_b32 s55, 0xbf800000
  s_mov_b32 s56, 0x3f000000
  s_mov_b32 s57, 0x3f000000
  s_waitcnt lgkmcnt(0)
  s_mov_b32 s8, s4
  s_mov_b32 s9, s5
  s_mov_b32 s10, 2621440
  s_mov_b32 s11, 0x00020000
  s_mov_b32 s12, s6
  s_mov_b32 s13, s7
  s_mov_b32 s14, 5505024
  s_mov_b32 s15, 0x00020000
  v_and_b32 v1, 63, v0
  s_cmp_ge_u32 s16, 4
  s_cbranch_scc1 L_k1_skipA
  s_lshl_b32 s20, s16, 9
  s_add_u32 s20, s20, s2
  s_mul_i32 s20, s20, 1280
  s_add_u32 s21, s20, 327680
  v_lshlrev_b32 v2, 2, v1
  buffer_load_dword v3, v2, s[8:11], s20 offen offset:0
  buffer_load_dword v4, v2, s[8:11], s20 offen offset:256
  buffer_load_dword v5, v2, s[8:11], s20 offen offset:512
  buffer_load_dword v6, v2, s[8:11], s20 offen offset:768
  buffer_load_dword v7, v2, s[8:11], s20 offen offset:1024
  buffer_load_dword v8, v2, s[8:11], s21 offen offset:0
  buffer_load_dword v9, v2, s[8:11], s21 offen offset:256
  buffer_load_dword v10, v2, s[8:11], s21 offen offset:512
  buffer_load_dword v11, v2, s[8:11], s21 offen offset:768
  buffer_load_dword v12, v2, s[8:11], s21 offen offset:1024
  s_waitcnt vmcnt(0)
  v_lshlrev_b32 v14, 16, v3
  v_and_b32 v15, 0xffff0000, v3
  v_lshlrev_b32 v2, 16, v4
  v_and_b32 v3, 0xffff0000, v4
  v_lshlrev_b32 v16, 16, v5
  v_and_b32 v17, 0xffff0000, v5
  v_lshlrev_b32 v4, 16, v6
  v_and_b32 v5, 0xffff0000, v6
  v_lshlrev_b32 v18, 16, v7
  v_and_b32 v19, 0xffff0000, v7
  v_lshlrev_b32 v6, 16, v8
  v_and_b32 v7, 0xffff0000, v8
  v_lshlrev_b32 v20, 16, v9
  v_and_b32 v21, 0xffff0000, v9
  v_lshlrev_b32 v8, 16, v10
  v_and_b32 v9, 0xffff0000, v10
  v_lshlrev_b32 v22, 16, v11
  v_and_b32 v23, 0xffff0000, v11
  v_lshlrev_b32 v10, 16, v12
  v_and_b32 v11, 0xffff0000, v12
  v_add_f32 v12, v14, v15
  v_add_f32 v13, v2, v3
  v_add_f32 v24, v16, v17
  v_add_f32 v25, v4, v5
  v_add_f32 v26, v18, v19
  v_add_f32 v27, v12, v13
  v_add_f32 v12, v24, v25
  v_add_f32 v13, v27, v12
  v_add_f32 v12, v13, v26
  v_add_f32 v13, v6, v7
  v_add_f32 v24, v20, v21
  v_add_f32 v25, v8, v9
  v_add_f32 v26, v22, v23
  v_add_f32 v27, v10, v11
  v_add_f32 v28, v13, v24
  v_add_f32 v13, v25, v26
  v_add_f32 v24, v28, v13
  v_add_f32 v13, v24, v27
  v_add_f32_dpp v12, v12, v12 quad_perm:[1,0,3,2] row_mask:0xf bank_mask:0xf
  s_nop 0
  v_add_f32_dpp v13, v13, v13 quad_perm:[1,0,3,2] row_mask:0xf bank_mask:0xf
  v_add_f32_dpp v12, v12, v12 quad_perm:[2,3,0,1] row_mask:0xf bank_mask:0xf
  s_nop 0
  v_add_f32_dpp v13, v13, v13 quad_perm:[2,3,0,1] row_mask:0xf bank_mask:0xf
  v_add_f32_dpp v12, v12, v12 row_half_mirror row_mask:0xf bank_mask:0xf
  s_nop 0
  v_add_f32_dpp v13, v13, v13 row_half_mirror row_mask:0xf bank_mask:0xf
  v_add_f32_dpp v12, v12, v12 row_mirror row_mask:0xf bank_mask:0xf
  s_nop 0
  v_add_f32_dpp v13, v13, v13 row_mirror row_mask:0xf bank_mask:0xf
  v_add_f32_dpp v12, v12, v12 row_bcast:15 row_mask:0xa bank_mask:0xf
  s_nop 0
  v_add_f32_dpp v13, v13, v13 row_bcast:15 row_mask:0xa bank_mask:0xf
  v_add_f32_dpp v12, v12, v12 row_bcast:31 row_mask:0xc bank_mask:0xf
  s_nop 0
  v_add_f32_dpp v13, v13, v13 row_bcast:31 row_mask:0xc bank_mask:0xf
  v_readlane_b32 s22, v12, 63
  v_readlane_b32 s23, v13, 63
  s_nop 0
  v_mov_b32 v12, s22
  v_mul_f32 v12, 0x3acccccd, v12
  v_mov_b32 v13, s23
  v_mul_f32 v13, 0x3acccccd, v13
  v_sub_f32 v24, v14, v12
  v_mul_f32 v25, v24, v24
  v_sub_f32 v24, v15, v12
  v_fma_f32 v25, v24, v24, v25
  v_sub_f32 v24, v2, v12
  v_fma_f32 v25, v24, v24, v25
  v_sub_f32 v24, v3, v12
  v_fma_f32 v25, v24, v24, v25
  v_sub_f32 v24, v16, v12
  v_fma_f32 v25, v24, v24, v25
  v_sub_f32 v24, v17, v12
  v_fma_f32 v25, v24, v24, v25
  v_sub_f32 v24, v4, v12
  v_fma_f32 v25, v24, v24, v25
  v_sub_f32 v24, v5, v12
  v_fma_f32 v25, v24, v24, v25
  v_sub_f32 v24, v18, v12
  v_fma_f32 v25, v24, v24, v25
  v_sub_f32 v24, v19, v12
  v_fma_f32 v25, v24, v24, v25
  v_sub_f32 v24, v6, v13
  v_mul_f32 v26, v24, v24
  v_sub_f32 v24, v7, v13
  v_fma_f32 v26, v24, v24, v26
  v_sub_f32 v24, v20, v13
  v_fma_f32 v26, v24, v24, v26
  v_sub_f32 v24, v21, v13
  v_fma_f32 v26, v24, v24, v26
  v_sub_f32 v24, v8, v13
  v_fma_f32 v26, v24, v24, v26
  v_sub_f32 v24, v9, v13
  v_fma_f32 v26, v24, v24, v26
  v_sub_f32 v24, v22, v13
  v_fma_f32 v26, v24, v24, v26
  v_sub_f32 v24, v23, v13
  v_fma_f32 v26, v24, v24, v26
  v_sub_f32 v24, v10, v13
  v_fma_f32 v26, v24, v24, v26
  v_sub_f32 v24, v11, v13
  v_fma_f32 v26, v24, v24, v26
  v_add_f32_dpp v25, v25, v25 quad_perm:[1,0,3,2] row_mask:0xf bank_mask:0xf
  s_nop 0
  v_add_f32_dpp v26, v26, v26 quad_perm:[1,0,3,2] row_mask:0xf bank_mask:0xf
  v_add_f32_dpp v25, v25, v25 quad_perm:[2,3,0,1] row_mask:0xf bank_mask:0xf
  s_nop 0
  v_add_f32_dpp v26, v26, v26 quad_perm:[2,3,0,1] row_mask:0xf bank_mask:0xf
  v_add_f32_dpp v25, v25, v25 row_half_mirror row_mask:0xf bank_mask:0xf
  s_nop 0
  v_add_f32_dpp v26, v26, v26 row_half_mirror row_mask:0xf bank_mask:0xf
  v_add_f32_dpp v25, v25, v25 row_mirror row_mask:0xf bank_mask:0xf
  s_nop 0
  v_add_f32_dpp v26, v26, v26 row_mirror row_mask:0xf bank_mask:0xf
  v_add_f32_dpp v25, v25, v25 row_bcast:15 row_mask:0xa bank_mask:0xf
  s_nop 0
  v_add_f32_dpp v26, v26, v26 row_bcast:15 row_mask:0xa bank_mask:0xf
  v_add_f32_dpp v25, v25, v25 row_bcast:31 row_mask:0xc bank_mask:0xf
  s_nop 0
  v_add_f32_dpp v26, v26, v26 row_bcast:31 row_mask:0xc bank_mask:0xf
  v_readlane_b32 s22, v25, 63
  v_readlane_b32 s23, v26, 63
  s_nop 0
  v_mov_b32 v24, s22
  v_mul_f32 v24, 0x3acccccd, v24
  v_cvt_pk_bf16_f32 v25, v24, v12
  v_lshlrev_b32 v24, 16, v25
  v_and_b32 v12, 0xffff0000, v25
  v_add_f32 v24, 0x3727c5ac, v24
  v_cvt_pk_bf16_f32 v25, v24, v24
  v_lshlrev_b32 v24, 16, v25
  v_sqrt_f32 v24, v24
  s_nop 0
  v_cvt_pk_bf16_f32 v25, v24, v24
  v_lshlrev_b32 v24, 16, v25
  v_rcp_f32 v25, v24
  s_nop 0
  v_fma_f32 v26, -v24, v25, 1.0
  v_fma_f32 v25, v26, v25, v25
  v_sub_f32 v14, v14, v12
  v_sub_f32 v15, v15, v12
  v_cvt_pk_bf16_f32 v24, v14, v15
  v_lshlrev_b32 v14, 16, v24
  v_and_b32 v15, 0xffff0000, v24
  v_mul_f32 v14, v14, v25
  v_mul_f32 v15, v15, v25
  v_cvt_pk_bf16_f32 v24, v14, v15
  v_lshlrev_b32 v14, 16, v24
  v_and_b32 v15, 0xffff0000, v24
  v_sub_f32 v2, v2, v12
  v_sub_f32 v3, v3, v12
  v_cvt_pk_bf16_f32 v24, v2, v3
  v_lshlrev_b32 v2, 16, v24
  v_and_b32 v3, 0xffff0000, v24
  v_mul_f32 v2, v2, v25
  v_mul_f32 v3, v3, v25
  v_cvt_pk_bf16_f32 v24, v2, v3
  v_lshlrev_b32 v2, 16, v24
  v_and_b32 v3, 0xffff0000, v24
  v_sub_f32 v16, v16, v12
  v_sub_f32 v17, v17, v12
  v_cvt_pk_bf16_f32 v24, v16, v17
  v_lshlrev_b32 v16, 16, v24
  v_and_b32 v17, 0xffff0000, v24
  v_mul_f32 v16, v16, v25
  v_mul_f32 v17, v17, v25
  v_cvt_pk_bf16_f32 v24, v16, v17
  v_lshlrev_b32 v16, 16, v24
  v_and_b32 v17, 0xffff0000, v24
  v_sub_f32 v4, v4, v12
  v_sub_f32 v5, v5, v12
  v_cvt_pk_bf16_f32 v24, v4, v5
  v_lshlrev_b32 v4, 16, v24
  v_and_b32 v5, 0xffff0000, v24
  v_mul_f32 v4, v4, v25
  v_mul_f32 v5, v5, v25
  v_cvt_pk_bf16_f32 v24, v4, v5
  v_lshlrev_b32 v4, 16, v24
  v_and_b32 v5, 0xffff0000, v24
  v_sub_f32 v18, v18, v12
  v_sub_f32 v19, v19, v12
  v_cvt_pk_bf16_f32 v12, v18, v19
  v_lshlrev_b32 v18, 16, v12
  v_and_b32 v19, 0xffff0000, v12
  v_mul_f32 v18, v18, v25
  v_mul_f32 v19, v19, v25
  v_cvt_pk_bf16_f32 v12, v18, v19
  v_lshlrev_b32 v18, 16, v12
  v_and_b32 v19, 0xffff0000, v12
  v_mov_b32 v12, s23
  v_mul_f32 v12, 0x3acccccd, v12
  v_cvt_pk_bf16_f32 v24, v12, v13
  v_lshlrev_b32 v12, 16, v24
  v_and_b32 v13, 0xffff0000, v24
  v_add_f32 v12, 0x3727c5ac, v12
  v_cvt_pk_bf16_f32 v24, v12, v12
  v_lshlrev_b32 v12, 16, v24
  v_sqrt_f32 v12, v12
  s_nop 0
  v_cvt_pk_bf16_f32 v24, v12, v12
  v_lshlrev_b32 v12, 16, v24
  v_rcp_f32 v24, v12
  s_nop 0
  v_fma_f32 v25, -v12, v24, 1.0
  v_fma_f32 v24, v25, v24, v24
  v_sub_f32 v6, v6, v13
  v_sub_f32 v7, v7, v13
  v_cvt_pk_bf16_f32 v12, v6, v7
  v_lshlrev_b32 v6, 16, v12
  v_and_b32 v7, 0xffff0000, v12
  v_mul_f32 v6, v6, v24
  v_mul_f32 v7, v7, v24
  v_cvt_pk_bf16_f32 v12, v6, v7
  v_lshlrev_b32 v6, 16, v12
  v_and_b32 v7, 0xffff0000, v12
  v_sub_f32 v20, v20, v13
  v_sub_f32 v21, v21, v13
  v_cvt_pk_bf16_f32 v12, v20, v21
  v_lshlrev_b32 v20, 16, v12
  v_and_b32 v21, 0xffff0000, v12
  v_mul_f32 v20, v20, v24
  v_mul_f32 v21, v21, v24
  v_cvt_pk_bf16_f32 v12, v20, v21
  v_lshlrev_b32 v20, 16, v12
  v_and_b32 v21, 0xffff0000, v12
  v_sub_f32 v8, v8, v13
  v_sub_f32 v9, v9, v13
  v_cvt_pk_bf16_f32 v12, v8, v9
  v_lshlrev_b32 v8, 16, v12
  v_and_b32 v9, 0xffff0000, v12
  v_mul_f32 v8, v8, v24
  v_mul_f32 v9, v9, v24
  v_cvt_pk_bf16_f32 v12, v8, v9
  v_lshlrev_b32 v8, 16, v12
  v_and_b32 v9, 0xffff0000, v12
  v_sub_f32 v22, v22, v13
  v_sub_f32 v23, v23, v13
  v_cvt_pk_bf16_f32 v12, v22, v23
  v_lshlrev_b32 v22, 16, v12
  v_and_b32 v23, 0xffff0000, v12
  v_mul_f32 v22, v22, v24
  v_mul_f32 v23, v23, v24
  v_cvt_pk_bf16_f32 v12, v22, v23
  v_lshlrev_b32 v22, 16, v12
  v_and_b32 v23, 0xffff0000, v12
  v_sub_f32 v10, v10, v13
  v_sub_f32 v11, v11, v13
  v_cvt_pk_bf16_f32 v12, v10, v11
  v_lshlrev_b32 v10, 16, v12
  v_and_b32 v11, 0xffff0000, v12
  v_mul_f32 v10, v10, v24
  v_mul_f32 v11, v11, v24
  v_cvt_pk_bf16_f32 v12, v10, v11
  v_lshlrev_b32 v10, 16, v12
  v_and_b32 v11, 0xffff0000, v12
  s_mul_i32 s24, s16, 5120
  v_lshlrev_b32 v12, 3, v1
  v_add_u32 v12, s24, v12
  ds_write_b64 v12, v[14:15] offset:0
  ds_write_b64 v12, v[2:3] offset:512
  ds_write_b64 v12, v[16:17] offset:1024
  ds_write_b64 v12, v[4:5] offset:1536
  ds_write_b64 v12, v[18:19] offset:2048
  ds_write_b64 v12, v[6:7] offset:2560
  ds_write_b64 v12, v[20:21] offset:3072
  ds_write_b64 v12, v[8:9] offset:3584
  ds_write_b64 v12, v[22:23] offset:4096
  ds_write_b64 v12, v[10:11] offset:4608
L_k1_skipA:
  v_mul_u32_u24 v2, 205, v0
  v_lshrrev_b32 v2, 14, v2
  v_mul_u32_u24 v3, 80, v2
  v_sub_u32 v4, v0, v3
  v_mul_u32_u24 v3, 205, v4
  v_lshrrev_b32 v3, 11, v3
  v_mul_u32_u24 v5, 10, v3
  v_sub_u32 v6, v4, v5
  v_cvt_f32_u32 v5, v2
  v_cmp_eq_u32 vcc, 0, v2
  v_mov_b32 v8, 1.0
  s_nop 0
  v_cndmask_b32 v9, 0, 1.0, vcc
  v_mul_f32 v7, 0x3e000000, v5
  v_cos_f32 v10, v7
  v_sin_f32 v11, v7
  s_nop 0
  v_sub_f32 v11, 0, v11
  v_cndmask_b32 v11, v11, -1.0, vcc
  v_mul_f32 v7, 0x3e800000, v5
  v_cos_f32 v12, v7
  v_sin_f32 v13, v7
  s_nop 0
  v_sub_f32 v13, 0, v13
  v_cndmask_b32 v13, v13, 1.0, vcc
  v_mul_f32 v7, 0x3ec00000, v5
  v_cos_f32 v14, v7
  v_sin_f32 v15, v7
  s_nop 0
  v_sub_f32 v15, 0, v15
  v_cndmask_b32 v15, v15, -1.0, vcc
  v_mul_f32 v7, 0x3f000000, v5
  v_cos_f32 v16, v7
  v_sin_f32 v17, v7
  s_nop 0
  v_sub_f32 v17, 0, v17
  v_cndmask_b32 v17, v17, 1.0, vcc
  v_mul_f32 v7, 0x3f200000, v5
  v_cos_f32 v18, v7
  v_sin_f32 v19, v7
  s_nop 0
  v_sub_f32 v19, 0, v19
  v_cndmask_b32 v19, v19, -1.0, vcc
  v_mul_f32 v7, 0x3f400000, v5
  v_cos_f32 v20, v7
  v_sin_f32 v21, v7
  s_nop 0
  v_sub_f32 v21, 0, v21
  v_cndmask_b32 v21, v21, 1.0, vcc
  v_mul_f32 v7, 0x3f600000, v5
  v_cos_f32 v22, v7
  v_sin_f32 v23, v7
  s_nop 0
  v_sub_f32 v23, 0, v23
  v_cndmask_b32 v23, v23, -1.0, vcc
  v_cvt_f32_u32 v5, v4
  v_cvt_f32_u32 v7, v6
  v_mul_f32 v24, 0x3acccccd, v5
  v_cos_f32 v26, v24
  v_sin_f32 v27, v24
  v_mul_f32 v24, 0x3b4ccccd, v5
  v_cos_f32 v28, v24
  v_sin_f32 v29, v24
  v_mul_f32 v24, 0x3b99999a, v5
  v_cos_f32 v30, v24
  v_sin_f32 v31, v24
  v_mul_f32 v24, 0x3bcccccd, v5
  v_cos_f32 v32, v24
  v_sin_f32 v33, v24
  v_mul_f32 v24, 0x3c000000, v5
  v_cos_f32 v34, v24
  v_sin_f32 v35, v24
  v_mul_f32 v24, 0x3c19999a, v5
  v_cos_f32 v36, v24
  v_sin_f32 v37, v24
  v_mul_f32 v24, 0x3c333333, v5
  v_cos_f32 v38, v24
  v_sin_f32 v39, v24
  v_mul_f32 v5, 0x3c4ccccd, v7
  v_cos_f32 v24, v5
  v_sin_f32 v25, v5
  v_mul_f32 v5, 0x3ccccccd, v7
  v_cos_f32 v40, v5
  v_sin_f32 v41, v5
  v_mul_f32 v5, 0x3d19999a, v7
  v_cos_f32 v42, v5
  v_sin_f32 v43, v5
  v_mul_f32 v5, 0x3d4ccccd, v7
  v_cos_f32 v44, v5
  v_sin_f32 v45, v5
  v_mul_f32 v5, 0x3d800000, v7
  v_cos_f32 v46, v5
  v_sin_f32 v47, v5
  v_mul_f32 v5, 0x3d99999a, v7
  v_cos_f32 v48, v5
  v_sin_f32 v49, v5
  v_mul_f32 v5, 0x3db33333, v7
  v_cos_f32 v50, v5
  v_sin_f32 v51, v5
  s_waitcnt lgkmcnt(0)
  s_barrier
  v_lshlrev_b32 v5, 2, v4
  ds_read_b32 v52, v5 offset:0
  ds_read_b32 v53, v5 offset:2560
  s_waitcnt lgkmcnt(0)
  v_pk_mul_f32 v[54:55], v[8:9], v[52:53] op_sel:[0,0] op_sel_hi:[1,0]
  v_pk_fma_f32 v[54:55], v[10:11], v[52:53], v[54:55] op_sel:[0,1,0] op_sel_hi:[1,1,1]
  ds_read_b32 v52, v5 offset:5120
  ds_read_b32 v53, v5 offset:7680
  s_waitcnt lgkmcnt(0)
  v_pk_fma_f32 v[54:55], v[12:13], v[52:53], v[54:55] op_sel:[0,0,0] op_sel_hi:[1,0,1]
  v_pk_fma_f32 v[54:55], v[14:15], v[52:53], v[54:55] op_sel:[0,1,0] op_sel_hi:[1,1,1]
  ds_read_b32 v52, v5 offset:10240
  ds_read_b32 v53, v5 offset:12800
  s_waitcnt lgkmcnt(0)
  v_pk_fma_f32 v[54:55], v[16:17], v[52:53], v[54:55] op_sel:[0,0,0] op_sel_hi:[1,0,1]
  v_pk_fma_f32 v[54:55], v[18:19], v[52:53], v[54:55] op_sel:[0,1,0] op_sel_hi:[1,1,1]
  ds_read_b32 v52, v5 offset:15360
  ds_read_b32 v53, v5 offset:17920
  s_waitcnt lgkmcnt(0)
  v_pk_fma_f32 v[54:55], v[20:21], v[52:53], v[54:55] op_sel:[0,0,0] op_sel_hi:[1,0,1]
  v_pk_fma_f32 v[54:55], v[22:23], v[52:53], v[54:55] op_sel:[0,1,0] op_sel_hi:[1,1,1]
  ds_read_b32 v52, v5 offset:320
  ds_read_b32 v53, v5 offset:2880
  s_waitcnt lgkmcnt(0)
  v_pk_mul_f32 v[56:57], v[8:9], v[52:53] op_sel:[0,0] op_sel_hi:[1,0]
  v_pk_fma_f32 v[56:57], v[10:11], v[52:53], v[56:57] op_sel:[0,1,0] op_sel_hi:[1,1,1]
  ds_read_b32 v52, v5 offset:5440
  ds_read_b32 v53, v5 offset:8000
  s_waitcnt lgkmcnt(0)
  v_pk_fma_f32 v[56:57], v[12:13], v[52:53], v[56:57] op_sel:[0,0,0] op_sel_hi:[1,0,1]
  v_pk_fma_f32 v[56:57], v[14:15], v[52:53], v[56:57] op_sel:[0,1,0] op_sel_hi:[1,1,1]
  ds_read_b32 v52, v5 offset:10560
  ds_read_b32 v53, v5 offset:13120
  s_waitcnt lgkmcnt(0)
  v_pk_fma_f32 v[56:57], v[16:17], v[52:53], v[56:57] op_sel:[0,0,0] op_sel_hi:[1,0,1]
  v_pk_fma_f32 v[56:57], v[18:19], v[52:53], v[56:57] op_sel:[0,1,0] op_sel_hi:[1,1,1]
  ds_read_b32 v52, v5 offset:15680
  ds_read_b32 v53, v5 offset:18240
  s_waitcnt lgkmcnt(0)
  v_pk_fma_f32 v[56:57], v[20:21], v[52:53], v[56:57] op_sel:[0,0,0] op_sel_hi:[1,0,1]
  v_pk_fma_f32 v[56:57], v[22:23], v[52:53], v[56:57] op_sel:[0,1,0] op_sel_hi:[1,1,1]
  ds_read_b32 v52, v5 offset:640
  ds_read_b32 v53, v5 offset:3200
  s_waitcnt lgkmcnt(0)
  v_pk_mul_f32 v[58:59], v[8:9], v[52:53] op_sel:[0,0] op_sel_hi:[1,0]
  v_pk_fma_f32 v[58:59], v[10:11], v[52:53], v[58:59] op_sel:[0,1,0] op_sel_hi:[1,1,1]
  ds_read_b32 v52, v5 offset:5760
  ds_read_b32 v53, v5 offset:8320
  s_waitcnt lgkmcnt(0)
  v_pk_fma_f32 v[58:59], v[12:13], v[52:53], v[58:59] op_sel:[0,0,0] op_sel_hi:[1,0,1]
  v_pk_fma_f32 v[58:59], v[14:15], v[52:53], v[58:59] op_sel:[0,1,0] op_sel_hi:[1,1,1]
  ds_read_b32 v52, v5 offset:10880
  ds_read_b32 v53, v5 offset:13440
  s_waitcnt lgkmcnt(0)
  v_pk_fma_f32 v[58:59], v[16:17], v[52:53], v[58:59] op_sel:[0,0,0] op_sel_hi:[1,0,1]
  v_pk_fma_f32 v[58:59], v[18:19], v[52:53], v[58:59] op_sel:[0,1,0] op_sel_hi:[1,1,1]
  ds_read_b32 v52, v5 offset:16000
  ds_read_b32 v53, v5 offset:18560
  s_waitcnt lgkmcnt(0)
  v_pk_fma_f32 v[58:59], v[20:21], v[52:53], v[58:59] op_sel:[0,0,0] op_sel_hi:[1,0,1]
  v_pk_fma_f32 v[58:59], v[22:23], v[52:53], v[58:59] op_sel:[0,1,0] op_sel_hi:[1,1,1]
  ds_read_b32 v52, v5 offset:960
  ds_read_b32 v53, v5 offset:3520
  s_waitcnt lgkmcnt(0)
  v_pk_mul_f32 v[60:61], v[8:9], v[52:53] op_sel:[0,0] op_sel_hi:[1,0]
  v_pk_fma_f32 v[60:61], v[10:11], v[52:53], v[60:61] op_sel:[0,1,0] op_sel_hi:[1,1,1]
  ds_read_b32 v52, v5 offset:6080
  ds_read_b32 v53, v5 offset:8640
  s_waitcnt lgkmcnt(0)
  v_pk_fma_f32 v[60:61], v[12:13], v[52:53], v[60:61] op_sel:[0,0,0] op_sel_hi:[1,0,1]
  v_pk_fma_f32 v[60:61], v[14:15], v[52:53], v[60:61] op_sel:[0,1,0] op_sel_hi:[1,1,1]
  ds_read_b32 v52, v5 offset:11200
  ds_read_b32 v53, v5 offset:13760
  s_waitcnt lgkmcnt(0)
  v_pk_fma_f32 v[60:61], v[16:17], v[52:53], v[60:61] op_sel:[0,0,0] op_sel_hi:[1,0,1]
  v_pk_fma_f32 v[60:61], v[18:19], v[52:53], v[60:61] op_sel:[0,1,0] op_sel_hi:[1,1,1]
  ds_read_b32 v52, v5 offset:16320
  ds_read_b32 v53, v5 offset:18880
  s_waitcnt lgkmcnt(0)
  v_pk_fma_f32 v[60:61], v[20:21], v[52:53], v[60:61] op_sel:[0,0,0] op_sel_hi:[1,0,1]
  v_pk_fma_f32 v[60:61], v[22:23], v[52:53], v[60:61] op_sel:[0,1,0] op_sel_hi:[1,1,1]
  ds_read_b32 v52, v5 offset:1280
  ds_read_b32 v53, v5 offset:3840
  s_waitcnt lgkmcnt(0)
  v_pk_mul_f32 v[62:63], v[8:9], v[52:53] op_sel:[0,0] op_sel_hi:[1,0]
  v_pk_fma_f32 v[62:63], v[10:11], v[52:53], v[62:63] op_sel:[0,1,0] op_sel_hi:[1,1,1]
  ds_read_b32 v52, v5 offset:6400
  ds_read_b32 v53, v5 offset:8960
  s_waitcnt lgkmcnt(0)
  v_pk_fma_f32 v[62:63], v[12:13], v[52:53], v[62:63] op_sel:[0,0,0] op_sel_hi:[1,0,1]
  v_pk_fma_f32 v[62:63], v[14:15], v[52:53], v[62:63] op_sel:[0,1,0] op_sel_hi:[1,1,1]
  ds_read_b32 v52, v5 offset:11520
  ds_read_b32 v53, v5 offset:14080
  s_waitcnt lgkmcnt(0)
  v_pk_fma_f32 v[62:63], v[16:17], v[52:53], v[62:63] op_sel:[0,0,0] op_sel_hi:[1,0,1]
  v_pk_fma_f32 v[62:63], v[18:19], v[52:53], v[62:63] op_sel:[0,1,0] op_sel_hi:[1,1,1]
  ds_read_b32 v52, v5 offset:16640
  ds_read_b32 v53, v5 offset:19200
  s_waitcnt lgkmcnt(0)
  v_pk_fma_f32 v[62:63], v[20:21], v[52:53], v[62:63] op_sel:[0,0,0] op_sel_hi:[1,0,1]
  v_pk_fma_f32 v[62:63], v[22:23], v[52:53], v[62:63] op_sel:[0,1,0] op_sel_hi:[1,1,1]
  ds_read_b32 v52, v5 offset:1600
  ds_read_b32 v53, v5 offset:4160
  s_waitcnt lgkmcnt(0)
  v_pk_mul_f32 v[64:65], v[8:9], v[52:53] op_sel:[0,0] op_sel_hi:[1,0]
  v_pk_fma_f32 v[64:65], v[10:11], v[52:53], v[64:65] op_sel:[0,1,0] op_sel_hi:[1,1,1]
  ds_read_b32 v52, v5 offset:6720
  ds_read_b32 v53, v5 offset:9280
  s_waitcnt lgkmcnt(0)
  v_pk_fma_f32 v[64:65], v[12:13], v[52:53], v[64:65] op_sel:[0,0,0] op_sel_hi:[1,0,1]
  v_pk_fma_f32 v[64:65], v[14:15], v[52:53], v[64:65] op_sel:[0,1,0] op_sel_hi:[1,1,1]
  ds_read_b32 v52, v5 offset:11840
  ds_read_b32 v53, v5 offset:14400
  s_waitcnt lgkmcnt(0)
  v_pk_fma_f32 v[64:65], v[16:17], v[52:53], v[64:65] op_sel:[0,0,0] op_sel_hi:[1,0,1]
  v_pk_fma_f32 v[64:65], v[18:19], v[52:53], v[64:65] op_sel:[0,1,0] op_sel_hi:[1,1,1]
  ds_read_b32 v52, v5 offset:16960
  ds_read_b32 v53, v5 offset:19520
  s_waitcnt lgkmcnt(0)
  v_pk_fma_f32 v[64:65], v[20:21], v[52:53], v[64:65] op_sel:[0,0,0] op_sel_hi:[1,0,1]
  v_pk_fma_f32 v[64:65], v[22:23], v[52:53], v[64:65] op_sel:[0,1,0] op_sel_hi:[1,1,1]
  ds_read_b32 v52, v5 offset:1920
  ds_read_b32 v53, v5 offset:4480
  s_waitcnt lgkmcnt(0)
  v_pk_mul_f32 v[66:67], v[8:9], v[52:53] op_sel:[0,0] op_sel_hi:[1,0]
  v_pk_fma_f32 v[66:67], v[10:11], v[52:53], v[66:67] op_sel:[0,1,0] op_sel_hi:[1,1,1]
  ds_read_b32 v52, v5 offset:7040
  ds_read_b32 v53, v5 offset:9600
  s_waitcnt lgkmcnt(0)
  v_pk_fma_f32 v[66:67], v[12:13], v[52:53], v[66:67] op_sel:[0,0,0] op_sel_hi:[1,0,1]
  v_pk_fma_f32 v[66:67], v[14:15], v[52:53], v[66:67] op_sel:[0,1,0] op_sel_hi:[1,1,1]
  ds_read_b32 v52, v5 offset:12160
  ds_read_b32 v53, v5 offset:14720
  s_waitcnt lgkmcnt(0)
  v_pk_fma_f32 v[66:67], v[16:17], v[52:53], v[66:67] op_sel:[0,0,0] op_sel_hi:[1,0,1]
  v_pk_fma_f32 v[66:67], v[18:19], v[52:53], v[66:67] op_sel:[0,1,0] op_sel_hi:[1,1,1]
  ds_read_b32 v52, v5 offset:17280
  ds_read_b32 v53, v5 offset:19840
  s_waitcnt lgkmcnt(0)
  v_pk_fma_f32 v[66:67], v[20:21], v[52:53], v[66:67] op_sel:[0,0,0] op_sel_hi:[1,0,1]
  v_pk_fma_f32 v[66:67], v[22:23], v[52:53], v[66:67] op_sel:[0,1,0] op_sel_hi:[1,1,1]
  ds_read_b32 v52, v5 offset:2240
  ds_read_b32 v53, v5 offset:4800
  s_waitcnt lgkmcnt(0)
  v_pk_mul_f32 v[68:69], v[8:9], v[52:53] op_sel:[0,0] op_sel_hi:[1,0]
  v_pk_fma_f32 v[68:69], v[10:11], v[52:53], v[68:69] op_sel:[0,1,0] op_sel_hi:[1,1,1]
  ds_read_b32 v8, v5 offset:7360
  ds_read_b32 v9, v5 offset:9920
  s_waitcnt lgkmcnt(0)
  v_pk_fma_f32 v[68:69], v[12:13], v[8:9], v[68:69] op_sel:[0,0,0] op_sel_hi:[1,0,1]
  v_pk_fma_f32 v[68:69], v[14:15], v[8:9], v[68:69] op_sel:[0,1,0] op_sel_hi:[1,1,1]
  ds_read_b32 v8, v5 offset:12480
  ds_read_b32 v9, v5 offset:15040
  s_waitcnt lgkmcnt(0)
  v_pk_fma_f32 v[68:69], v[16:17], v[8:9], v[68:69] op_sel:[0,0,0] op_sel_hi:[1,0,1]
  v_pk_fma_f32 v[68:69], v[18:19], v[8:9], v[68:69] op_sel:[0,1,0] op_sel_hi:[1,1,1]
  ds_read_b32 v8, v5 offset:17600
  ds_read_b32 v9, v5 offset:20160
  s_waitcnt lgkmcnt(0)
  v_pk_fma_f32 v[68:69], v[20:21], v[8:9], v[68:69] op_sel:[0,0,0] op_sel_hi:[1,0,1]
  v_pk_fma_f32 v[68:69], v[22:23], v[8:9], v[68:69] op_sel:[0,1,0] op_sel_hi:[1,1,1]
  v_pk_add_f32 v[8:9], v[54:55], v[62:63]
  v_pk_add_f32 v[10:11], v[54:55], v[62:63] neg_lo:[0,1] neg_hi:[0,1]
  v_pk_add_f32 v[12:13], v[58:59], v[66:67]
  v_pk_add_f32 v[14:15], v[58:59], v[66:67] neg_lo:[0,1] neg_hi:[0,1]
  v_pk_add_f32 v[16:17], v[8:9], v[12:13]
  v_pk_add_f32 v[18:19], v[8:9], v[12:13] neg_lo:[0,1] neg_hi:[0,1]
  v_pk_add_f32 v[8:9], v[10:11], v[14:15] op_sel:[0,1] op_sel_hi:[1,0] neg_hi:[0,1]
  v_pk_add_f32 v[12:13], v[10:11], v[14:15] op_sel:[0,1] op_sel_hi:[1,0] neg_lo:[0,1]
  v_pk_add_f32 v[10:11], v[56:57], v[64:65]
  v_pk_add_f32 v[14:15], v[56:57], v[64:65] neg_lo:[0,1] neg_hi:[0,1]
  v_pk_add_f32 v[20:21], v[60:61], v[68:69]
  v_pk_add_f32 v[22:23], v[60:61], v[68:69] neg_lo:[0,1] neg_hi:[0,1]
  v_pk_add_f32 v[52:53], v[10:11], v[20:21]
  v_pk_add_f32 v[54:55], v[10:11], v[20:21] neg_lo:[0,1] neg_hi:[0,1]
  v_pk_add_f32 v[10:11], v[14:15], v[22:23] op_sel:[0,1] op_sel_hi:[1,0] neg_hi:[0,1]
  v_pk_add_f32 v[20:21], v[14:15], v[22:23] op_sel:[0,1] op_sel_hi:[1,0] neg_lo:[0,1]
  v_pk_add_f32 v[14:15], v[16:17], v[52:53]
  v_pk_add_f32 v[22:23], v[16:17], v[52:53] neg_lo:[0,1] neg_hi:[0,1]
  v_pk_mul_f32 v[16:17], v[10:11], s[40:41] op_sel:[0,0] op_sel_hi:[1,0]
  v_pk_fma_f32 v[52:53], v[10:11], s[40:41], v[16:17] op_sel:[1,1,0] op_sel_hi:[0,1,1] neg_lo:[0,1,0]
  v_pk_add_f32 v[10:11], v[8:9], v[52:53]
  v_pk_add_f32 v[16:17], v[8:9], v[52:53] neg_lo:[0,1] neg_hi:[0,1]
  v_pk_add_f32 v[8:9], v[18:19], v[54:55] op_sel:[0,1] op_sel_hi:[1,0] neg_hi:[0,1]
  v_pk_add_f32 v[52:53], v[18:19], v[54:55] op_sel:[0,1] op_sel_hi:[1,0] neg_lo:[0,1]
  v_pk_mul_f32 v[18:19], v[20:21], s[42:43] op_sel:[0,0] op_sel_hi:[1,0]
  v_pk_fma_f32 v[54:55], v[20:21], s[42:43], v[18:19] op_sel:[1,1,0] op_sel_hi:[0,1,1] neg_lo:[0,1,0]
  v_pk_add_f32 v[18:19], v[12:13], v[54:55]
  v_pk_add_f32 v[20:21], v[12:13], v[54:55] neg_lo:[0,1] neg_hi:[0,1]
  v_mul_u32_u24 v5, 640, v2
  v_add_u32 v7, v5, v4
  v_lshlrev_b32 v7, 3, v7
  ds_write_b64 v7, v[14:15] offset:20480
  v_pk_mul_f32 v[12:13], v[10:11], v[26:27] op_sel:[0,0] op_sel_hi:[1,0]
  v_pk_fma_f32 v[14:15], v[10:11], v[26:27], v[12:13] op_sel:[1,1,0] op_sel_hi:[0,1,1] neg_hi:[0,1,0]
  ds_write_b64 v7, v[14:15] offset:21120
  v_pk_mul_f32 v[10:11], v[8:9], v[28:29] op_sel:[0,0] op_sel_hi:[1,0]
  v_pk_fma_f32 v[12:13], v[8:9], v[28:29], v[10:11] op_sel:[1,1,0] op_sel_hi:[0,1,1] neg_hi:[0,1,0]
  ds_write_b64 v7, v[12:13] offset:21760
  v_pk_mul_f32 v[8:9], v[18:19], v[30:31] op_sel:[0,0] op_sel_hi:[1,0]
  v_pk_fma_f32 v[10:11], v[18:19], v[30:31], v[8:9] op_sel:[1,1,0] op_sel_hi:[0,1,1] neg_hi:[0,1,0]
  ds_write_b64 v7, v[10:11] offset:22400
  v_pk_mul_f32 v[8:9], v[22:23], v[32:33] op_sel:[0,0] op_sel_hi:[1,0]
  v_pk_fma_f32 v[10:11], v[22:23], v[32:33], v[8:9] op_sel:[1,1,0] op_sel_hi:[0,1,1] neg_hi:[0,1,0]
  ds_write_b64 v7, v[10:11] offset:23040
  v_pk_mul_f32 v[8:9], v[16:17], v[34:35] op_sel:[0,0] op_sel_hi:[1,0]
  v_pk_fma_f32 v[10:11], v[16:17], v[34:35], v[8:9] op_sel:[1,1,0] op_sel_hi:[0,1,1] neg_hi:[0,1,0]
  ds_write_b64 v7, v[10:11] offset:23680
  v_pk_mul_f32 v[8:9], v[52:53], v[36:37] op_sel:[0,0] op_sel_hi:[1,0]
  v_pk_fma_f32 v[10:11], v[52:53], v[36:37], v[8:9] op_sel:[1,1,0] op_sel_hi:[0,1,1] neg_hi:[0,1,0]
  ds_write_b64 v7, v[10:11] offset:24320
  v_pk_mul_f32 v[8:9], v[20:21], v[38:39] op_sel:[0,0] op_sel_hi:[1,0]
  v_pk_fma_f32 v[10:11], v[20:21], v[38:39], v[8:9] op_sel:[1,1,0] op_sel_hi:[0,1,1] neg_hi:[0,1,0]
  ds_write_b64 v7, v[10:11] offset:24960
  s_waitcnt lgkmcnt(0)
  s_barrier
  v_mul_u32_u24 v4, 80, v3
  v_add3_u32 v7, v5, v4, v6
  v_lshlrev_b32 v7, 3, v7
  ds_read_b64 v[4:5], v7 offset:20480
  ds_read_b64 v[8:9], v7 offset:20560
  ds_read_b64 v[10:11], v7 offset:20640
  ds_read_b64 v[12:13], v7 offset:20720
  ds_read_b64 v[14:15], v7 offset:20800
  ds_read_b64 v[16:17], v7 offset:20880
  ds_read_b64 v[18:19], v7 offset:20960
  ds_read_b64 v[20:21], v7 offset:21040
  s_waitcnt lgkmcnt(0)
  v_pk_add_f32 v[22:23], v[4:5], v[14:15]
  v_pk_add_f32 v[26:27], v[4:5], v[14:15] neg_lo:[0,1] neg_hi:[0,1]
  v_pk_add_f32 v[4:5], v[10:11], v[18:19]
  v_pk_add_f32 v[14:15], v[10:11], v[18:19] neg_lo:[0,1] neg_hi:[0,1]
  v_pk_add_f32 v[10:11], v[22:23], v[4:5]
  v_pk_add_f32 v[18:19], v[22:23], v[4:5] neg_lo:[0,1] neg_hi:[0,1]
  v_pk_add_f32 v[4:5], v[26:27], v[14:15] op_sel:[0,1] op_sel_hi:[1,0] neg_hi:[0,1]
  v_pk_add_f32 v[22:23], v[26:27], v[14:15] op_sel:[0,1] op_sel_hi:[1,0] neg_lo:[0,1]
  v_pk_add_f32 v[14:15], v[8:9], v[16:17]
  v_pk_add_f32 v[26:27], v[8:9], v[16:17] neg_lo:[0,1] neg_hi:[0,1]
  v_pk_add_f32 v[8:9], v[12:13], v[20:21]
  v_pk_add_f32 v[16:17], v[12:13], v[20:21] neg_lo:[0,1] neg_hi:[0,1]
  v_pk_add_f32 v[12:13], v[14:15], v[8:9]
  v_pk_add_f32 v[20:21], v[14:15], v[8:9] neg_lo:[0,1] neg_hi:[0,1]
  v_pk_add_f32 v[8:9], v[26:27], v[16:17] op_sel:[0,1] op_sel_hi:[1,0] neg_hi:[0,1]
  v_pk_add_f32 v[14:15], v[26:27], v[16:17] op_sel:[0,1] op_sel_hi:[1,0] neg_lo:[0,1]
  v_pk_add_f32 v[16:17], v[10:11], v[12:13]
  v_pk_add_f32 v[26:27], v[10:11], v[12:13] neg_lo:[0,1] neg_hi:[0,1]
  v_pk_mul_f32 v[10:11], v[8:9], s[40:41] op_sel:[0,0] op_sel_hi:[1,0]
  v_pk_fma_f32 v[12:13], v[8:9], s[40:41], v[10:11] op_sel:[1,1,0] op_sel_hi:[0,1,1] neg_lo:[0,1,0]
  v_pk_add_f32 v[8:9], v[4:5], v[12:13]
  v_pk_add_f32 v[10:11], v[4:5], v[12:13] neg_lo:[0,1] neg_hi:[0,1]
  v_pk_add_f32 v[4:5], v[18:19], v[20:21] op_sel:[0,1] op_sel_hi:[1,0] neg_hi:[0,1]
  v_pk_add_f32 v[12:13], v[18:19], v[20:21] op_sel:[0,1] op_sel_hi:[1,0] neg_lo:[0,1]
  v_pk_mul_f32 v[18:19], v[14:15], s[42:43] op_sel:[0,0] op_sel_hi:[1,0]
  v_pk_fma_f32 v[20:21], v[14:15], s[42:43], v[18:19] op_sel:[1,1,0] op_sel_hi:[0,1,1] neg_lo:[0,1,0]
  v_pk_add_f32 v[14:15], v[22:23], v[20:21]
  v_pk_add_f32 v[18:19], v[22:23], v[20:21] neg_lo:[0,1] neg_hi:[0,1]
  v_lshl_add_u32 v7, v2, 6, v3
  v_mul_u32_u24 v7, 11, v7
  v_add_lshl_u32 v2, v7, v6, 3
  ds_write_b64 v2, v[16:17] offset:40960
  v_pk_mul_f32 v[6:7], v[8:9], v[24:25] op_sel:[0,0] op_sel_hi:[1,0]
  v_pk_fma_f32 v[16:17], v[8:9], v[24:25], v[6:7] op_sel:[1,1,0] op_sel_hi:[0,1,1] neg_hi:[0,1,0]
  ds_write_b64 v2, v[16:17] offset:41664
  v_pk_mul_f32 v[6:7], v[4:5], v[40:41] op_sel:[0,0] op_sel_hi:[1,0]
  v_pk_fma_f32 v[8:9], v[4:5], v[40:41], v[6:7] op_sel:[1,1,0] op_sel_hi:[0,1,1] neg_hi:[0,1,0]
  ds_write_b64 v2, v[8:9] offset:42368
  v_pk_mul_f32 v[4:5], v[14:15], v[42:43] op_sel:[0,0] op_sel_hi:[1,0]
  v_pk_fma_f32 v[6:7], v[14:15], v[42:43], v[4:5] op_sel:[1,1,0] op_sel_hi:[0,1,1] neg_hi:[0,1,0]
  ds_write_b64 v2, v[6:7] offset:43072
  v_pk_mul_f32 v[4:5], v[26:27], v[44:45] op_sel:[0,0] op_sel_hi:[1,0]
  v_pk_fma_f32 v[6:7], v[26:27], v[44:45], v[4:5] op_sel:[1,1,0] op_sel_hi:[0,1,1] neg_hi:[0,1,0]
  ds_write_b64 v2, v[6:7] offset:43776
  v_pk_mul_f32 v[4:5], v[10:11], v[46:47] op_sel:[0,0] op_sel_hi:[1,0]
  v_pk_fma_f32 v[6:7], v[10:11], v[46:47], v[4:5] op_sel:[1,1,0] op_sel_hi:[0,1,1] neg_hi:[0,1,0]
  ds_write_b64 v2, v[6:7] offset:44480
  v_pk_mul_f32 v[4:5], v[12:13], v[48:49] op_sel:[0,0] op_sel_hi:[1,0]
  v_pk_fma_f32 v[6:7], v[12:13], v[48:49], v[4:5] op_sel:[1,1,0] op_sel_hi:[0,1,1] neg_hi:[0,1,0]
  ds_write_b64 v2, v[6:7] offset:45184
  v_pk_mul_f32 v[4:5], v[18:19], v[50:51] op_sel:[0,0] op_sel_hi:[1,0]
  v_pk_fma_f32 v[6:7], v[18:19], v[50:51], v[4:5] op_sel:[1,1,0] op_sel_hi:[0,1,1] neg_hi:[0,1,0]
  ds_write_b64 v2, v[6:7] offset:45888
  s_waitcnt lgkmcnt(0)
  s_barrier
  s_cmp_ge_u32 s16, 4
  s_cbranch_scc1 L_k1_done
  v_mul_u32_u24 v2, 88, v0
  ds_read_b64 v[4:5], v2 offset:40960
  ds_read_b64 v[6:7], v2 offset:40968
  ds_read_b64 v[8:9], v2 offset:40976
  ds_read_b64 v[10:11], v2 offset:40984
  ds_read_b64 v[12:13], v2 offset:40992
  ds_read_b64 v[14:15], v2 offset:41000
  ds_read_b64 v[16:17], v2 offset:41008
  ds_read_b64 v[18:19], v2 offset:41016
  ds_read_b64 v[20:21], v2 offset:41024
  ds_read_b64 v[22:23], v2 offset:41032
  s_waitcnt lgkmcnt(0)
  v_pk_add_f32 v[2:3], v[4:5], v[14:15]
  v_pk_add_f32 v[24:25], v[4:5], v[14:15] neg_lo:[0,1] neg_hi:[0,1]
  v_pk_add_f32 v[4:5], v[8:9], v[18:19]
  v_pk_add_f32 v[14:15], v[8:9], v[18:19] neg_lo:[0,1] neg_hi:[0,1]
  v_pk_add_f32 v[8:9], v[12:13], v[22:23]
  v_pk_add_f32 v[18:19], v[12:13], v[22:23] neg_lo:[0,1] neg_hi:[0,1]
  v_pk_add_f32 v[12:13], v[16:17], v[6:7]
  v_pk_add_f32 v[22:23], v[16:17], v[6:7] neg_lo:[0,1] neg_hi:[0,1]
  v_pk_add_f32 v[6:7], v[20:21], v[10:11]
  v_pk_add_f32 v[16:17], v[20:21], v[10:11] neg_lo:[0,1] neg_hi:[0,1]
  v_pk_add_f32 v[10:11], v[4:5], v[6:7]
  v_pk_add_f32 v[20:21], v[8:9], v[12:13]
  v_pk_add_f32 v[26:27], v[4:5], v[6:7] neg_lo:[0,1] neg_hi:[0,1]
  v_pk_add_f32 v[4:5], v[8:9], v[12:13] neg_lo:[0,1] neg_hi:[0,1]
  v_pk_add_f32 v[6:7], v[2:3], v[10:11]
  v_pk_add_f32 v[8:9], v[6:7], v[20:21]
  v_pk_fma_f32 v[6:7], v[10:11], s[44:45], v[2:3]
  v_pk_fma_f32 v[12:13], v[20:21], s[46:47], v[6:7]
  v_pk_fma_f32 v[6:7], v[10:11], s[46:47], v[2:3]
  v_pk_fma_f32 v[2:3], v[20:21], s[44:45], v[6:7]
  v_pk_mul_f32 v[6:7], v[26:27], s[48:49]
  v_pk_fma_f32 v[10:11], v[4:5], s[50:51], v[6:7]
  v_pk_mul_f32 v[6:7], v[26:27], s[50:51]
  v_pk_fma_f32 v[20:21], v[4:5], s[52:53], v[6:7]
  v_pk_add_f32 v[4:5], v[12:13], v[10:11] op_sel:[0,1] op_sel_hi:[1,0] neg_hi:[0,1]
  v_pk_add_f32 v[6:7], v[12:13], v[10:11] op_sel:[0,1] op_sel_hi:[1,0] neg_lo:[0,1]
  v_pk_add_f32 v[10:11], v[2:3], v[20:21] op_sel:[0,1] op_sel_hi:[1,0] neg_hi:[0,1]
  v_pk_add_f32 v[12:13], v[2:3], v[20:21] op_sel:[0,1] op_sel_hi:[1,0] neg_lo:[0,1]
  v_pk_add_f32 v[2:3], v[14:15], v[16:17]
  v_pk_add_f32 v[20:21], v[18:19], v[22:23]
  v_pk_add_f32 v[26:27], v[14:15], v[16:17] neg_lo:[0,1] neg_hi:[0,1]
  v_pk_add_f32 v[14:15], v[18:19], v[22:23] neg_lo:[0,1] neg_hi:[0,1]
  v_pk_add_f32 v[16:17], v[24:25], v[2:3]
  v_pk_add_f32 v[18:19], v[16:17], v[20:21]
  v_pk_fma_f32 v[16:17], v[2:3], s[44:45], v[24:25]
  v_pk_fma_f32 v[22:23], v[20:21], s[46:47], v[16:17]
  v_pk_fma_f32 v[16:17], v[2:3], s[46:47], v[24:25]
  v_pk_fma_f32 v[2:3], v[20:21], s[44:45], v[16:17]
  v_pk_mul_f32 v[16:17], v[26:27], s[48:49]
  v_pk_fma_f32 v[20:21], v[14:15], s[50:51], v[16:17]
  v_pk_mul_f32 v[16:17], v[26:27], s[50:51]
  v_pk_fma_f32 v[24:25], v[14:15], s[52:53], v[16:17]
  v_pk_add_f32 v[14:15], v[22:23], v[20:21] op_sel:[0,1] op_sel_hi:[1,0] neg_hi:[0,1]
  v_pk_add_f32 v[16:17], v[22:23], v[20:21] op_sel:[0,1] op_sel_hi:[1,0] neg_lo:[0,1]
  v_pk_add_f32 v[20:21], v[2:3], v[24:25] op_sel:[0,1] op_sel_hi:[1,0] neg_hi:[0,1]
  v_pk_add_f32 v[22:23], v[2:3], v[24:25] op_sel:[0,1] op_sel_hi:[1,0] neg_lo:[0,1]
  v_lshlrev_b32 v2, 3, v1
  v_sub_u32 v3, 512, v2
  s_cmp_eq_u32 s16, 0
  s_cbranch_scc1 L_k1_wave0
  s_lshl_b32 s24, s16, 8
  s_add_u32 s24, s24, s2
  s_mul_i32 s24, s24, 2688
  s_sub_u32 s25, 8, s16
  s_lshl_b32 s25, s25, 8
  s_add_u32 s25, s25, s2
  s_mul_i32 s25, s25, 2688
  s_mul_i32 s26, s2, s16
  s_sub_u32 s27, 8, s16
  s_mul_i32 s27, s2, s27
  v_cvt_f32_u32 v24, s26
  v_mul_f32 v24, 0x3a000000, v24
  v_cos_f32 v26, v24
  v_sin_f32 v27, v24
  v_cvt_f32_u32 v24, s27
  v_mul_f32 v24, 0x3a000000, v24
  v_cos_f32 v28, v24
  v_sin_f32 v29, v24
  v_pk_mul_f32 v[24:25], v[8:9], v[26:27] op_sel:[0,0] op_sel_hi:[1,0]
  v_pk_fma_f32 v[30:31], v[8:9], v[26:27], v[24:25] op_sel:[1,1,0] op_sel_hi:[0,1,1] neg_hi:[0,1,0]
  buffer_store_dwordx2 v[30:31], v2, s[12:15], s24 offen offset:0
  v_pk_mul_f32 v[24:25], v[14:15], v[26:27] op_sel:[0,0] op_sel_hi:[1,0]
  v_pk_fma_f32 v[30:31], v[14:15], v[26:27], v[24:25] op_sel:[1,1,0] op_sel_hi:[0,1,1] neg_hi:[0,1,0]
  buffer_store_dwordx2 v[30:31], v2, s[12:15], s24 offen offset:512
  v_pk_mul_f32 v[24:25], v[10:11], v[26:27] op_sel:[0,0] op_sel_hi:[1,0]
  v_pk_fma_f32 v[30:31], v[10:11], v[26:27], v[24:25] op_sel:[1,1,0] op_sel_hi:[0,1,1] neg_hi:[0,1,0]
  buffer_store_dwordx2 v[30:31], v2, s[12:15], s24 offen offset:1024
  v_pk_mul_f32 v[24:25], v[22:23], v[26:27] op_sel:[0,0] op_sel_hi:[1,0]
  v_pk_fma_f32 v[30:31], v[22:23], v[26:27], v[24:25] op_sel:[1,1,0] op_sel_hi:[0,1,1] neg_hi:[0,1,0]
  buffer_store_dwordx2 v[30:31], v2, s[12:15], s24 offen offset:1536
  v_pk_mul_f32 v[24:25], v[6:7], v[26:27] op_sel:[0,0] op_sel_hi:[1,0]
  v_pk_fma_f32 v[30:31], v[6:7], v[26:27], v[24:25] op_sel:[1,1,0] op_sel_hi:[0,1,1] neg_hi:[0,1,0]
  buffer_store_dwordx2 v[30:31], v2, s[12:15], s24 offen offset:2048
  v_pk_mul_f32 v[24:25], v[18:19], v[28:29] op_sel:[0,0] op_sel_hi:[1,0]
  v_pk_fma_f32 v[30:31], v[18:19], v[28:29], v[24:25] op_sel:[1,1,0] op_sel_hi:[0,1,1] neg_lo:[0,1,0]
  v_pk_mul_f32 v[24:25], v[30:31], s[54:55]
  buffer_store_dwordx2 v[24:25], v3, s[12:15], s25 offen offset:2048
  v_pk_mul_f32 v[24:25], v[4:5], v[28:29] op_sel:[0,0] op_sel_hi:[1,0]
  v_pk_fma_f32 v[30:31], v[4:5], v[28:29], v[24:25] op_sel:[1,1,0] op_sel_hi:[0,1,1] neg_lo:[0,1,0]
  v_pk_mul_f32 v[24:25], v[30:31], s[54:55]
  buffer_store_dwordx2 v[24:25], v3, s[12:15], s25 offen offset:1536
  v_pk_mul_f32 v[24:25], v[20:21], v[28:29] op_sel:[0,0] op_sel_hi:[1,0]
  v_pk_fma_f32 v[30:31], v[20:21], v[28:29], v[24:25] op_sel:[1,1,0] op_sel_hi:[0,1,1] neg_lo:[0,1,0]
  v_pk_mul_f32 v[24:25], v[30:31], s[54:55]
  buffer_store_dwordx2 v[24:25], v3, s[12:15], s25 offen offset:1024
  v_pk_mul_f32 v[24:25], v[12:13], v[28:29] op_sel:[0,0] op_sel_hi:[1,0]
  v_pk_fma_f32 v[30:31], v[12:13], v[28:29], v[24:25] op_sel:[1,1,0] op_sel_hi:[0,1,1] neg_lo:[0,1,0]
  v_pk_mul_f32 v[24:25], v[30:31], s[54:55]
  buffer_store_dwordx2 v[24:25], v3, s[12:15], s25 offen offset:512
  v_pk_mul_f32 v[24:25], v[16:17], v[28:29] op_sel:[0,0] op_sel_hi:[1,0]
  v_pk_fma_f32 v[30:31], v[16:17], v[28:29], v[24:25] op_sel:[1,1,0] op_sel_hi:[0,1,1] neg_lo:[0,1,0]
  v_pk_mul_f32 v[24:25], v[30:31], s[54:55]
  buffer_store_dwordx2 v[24:25], v3, s[12:15], s25 offen offset:0
  v_cmp_eq_u32 vcc, 0, v1
  v_pk_mul_f32 v[24:25], v[8:9], v[28:29] op_sel:[0,0] op_sel_hi:[1,0]
  v_pk_fma_f32 v[30:31], v[8:9], v[28:29], v[24:25] op_sel:[1,1,0] op_sel_hi:[0,1,1] neg_lo:[0,1,0]
  v_pk_mul_f32 v[24:25], v[30:31], s[54:55]
  v_pk_mul_f32 v[28:29], v[18:19], v[26:27] op_sel:[0,0] op_sel_hi:[1,0]
  v_pk_fma_f32 v[30:31], v[18:19], v[26:27], v[28:29] op_sel:[1,1,0] op_sel_hi:[0,1,1] neg_hi:[0,1,0]
  s_and_saveexec_b64 s[28:29], vcc
  buffer_store_dwordx2 v[24:25], v2, s[12:15], s25 offen
  buffer_store_dwordx2 v[30:31], v2, s[12:15], s24 offen offset:2560
  s_mov_b64 exec, s[28:29]
  s_branch L_k1_done
L_k1_wave0:
  s_mul_i32 s24, s2, 2688
  s_add_u32 s25, s2, 1024
  s_mul_i32 s25, s25, 2688
  v_cvt_f32_u32 v3, s2
  v_mul_f32 v3, 0x3b000000, v3
  v_cos_f32 v24, v3
  v_sin_f32 v25, v3
  v_sub_u32 v3, 64, v1
  v_and_b32 v3, 63, v3
  v_lshlrev_b32 v3, 2, v3
  ds_bpermute_b32 v26, v3, v16
  ds_bpermute_b32 v27, v3, v17
  ds_bpermute_b32 v16, v3, v12
  ds_bpermute_b32 v17, v3, v13
  ds_bpermute_b32 v12, v3, v20
  ds_bpermute_b32 v13, v3, v21
  ds_bpermute_b32 v20, v3, v4
  ds_bpermute_b32 v21, v3, v5
  ds_bpermute_b32 v4, v3, v18
  ds_bpermute_b32 v5, v3, v19
  s_waitcnt lgkmcnt(0)
  v_cmp_eq_u32 vcc, 0, v1
  s_nop 1
  v_cndmask_b32 v28, v26, v8, vcc
  v_cndmask_b32 v29, v27, v9, vcc
  v_cndmask_b32 v30, v16, v26, vcc
  v_cndmask_b32 v31, v17, v27, vcc
  v_cndmask_b32 v26, v12, v16, vcc
  v_cndmask_b32 v27, v13, v17, vcc
  v_cndmask_b32 v16, v20, v12, vcc
  v_cndmask_b32 v17, v21, v13, vcc
  v_cndmask_b32 v12, v4, v20, vcc
  v_cndmask_b32 v13, v5, v21, vcc
  v_pk_add_f32 v[4:5], v[8:9], v[28:29] neg_hi:[0,1]
  v_pk_mul_f32 v[4:5], v[4:5], s[56:57]
  v_pk_add_f32 v[20:21], v[8:9], v[28:29] op_sel:[1,1] op_sel_hi:[0,0] neg_hi:[1,0]
  v_pk_mul_f32 v[20:21], v[20:21], s[56:57]
  v_pk_mul_f32 v[8:9], v[20:21], v[24:25] op_sel:[0,0] op_sel_hi:[1,0]
  v_pk_fma_f32 v[28:29], v[20:21], v[24:25], v[8:9] op_sel:[1,1,0] op_sel_hi:[0,1,1] neg_hi:[0,1,0]
  buffer_store_dwordx2 v[4:5], v2, s[12:15], s24 offen offset:0
  buffer_store_dwordx2 v[28:29], v2, s[12:15], s25 offen offset:0
  v_pk_add_f32 v[4:5], v[14:15], v[30:31] neg_hi:[0,1]
  v_pk_mul_f32 v[4:5], v[4:5], s[56:57]
  v_pk_add_f32 v[8:9], v[14:15], v[30:31] op_sel:[1,1] op_sel_hi:[0,0] neg_hi:[1,0]
  v_pk_mul_f32 v[8:9], v[8:9], s[56:57]
  v_pk_mul_f32 v[14:15], v[8:9], v[24:25] op_sel:[0,0] op_sel_hi:[1,0]
  v_pk_fma_f32 v[20:21], v[8:9], v[24:25], v[14:15] op_sel:[1,1,0] op_sel_hi:[0,1,1] neg_hi:[0,1,0]
  buffer_store_dwordx2 v[4:5], v2, s[12:15], s24 offen offset:512
  buffer_store_dwordx2 v[20:21], v2, s[12:15], s25 offen offset:512
  v_pk_add_f32 v[4:5], v[10:11], v[26:27] neg_hi:[0,1]
  v_pk_mul_f32 v[4:5], v[4:5], s[56:57]
  v_pk_add_f32 v[8:9], v[10:11], v[26:27] op_sel:[1,1] op_sel_hi:[0,0] neg_hi:[1,0]
  v_pk_mul_f32 v[8:9], v[8:9], s[56:57]
  v_pk_mul_f32 v[10:11], v[8:9], v[24:25] op_sel:[0,0] op_sel_hi:[1,0]
  v_pk_fma_f32 v[14:15], v[8:9], v[24:25], v[10:11] op_sel:[1,1,0] op_sel_hi:[0,1,1] neg_hi:[0,1,0]
  buffer_store_dwordx2 v[4:5], v2, s[12:15], s24 offen offset:1024
  buffer_store_dwordx2 v[14:15], v2, s[12:15], s25 offen offset:1024
  v_pk_add_f32 v[4:5], v[22:23], v[16:17] neg_hi:[0,1]
  v_pk_mul_f32 v[4:5], v[4:5], s[56:57]
  v_pk_add_f32 v[8:9], v[22:23], v[16:17] op_sel:[1,1] op_sel_hi:[0,0] neg_hi:[1,0]
  v_pk_mul_f32 v[8:9], v[8:9], s[56:57]
  v_pk_mul_f32 v[10:11], v[8:9], v[24:25] op_sel:[0,0] op_sel_hi:[1,0]
  v_pk_fma_f32 v[14:15], v[8:9], v[24:25], v[10:11] op_sel:[1,1,0] op_sel_hi:[0,1,1] neg_hi:[0,1,0]
  buffer_store_dwordx2 v[4:5], v2, s[12:15], s24 offen offset:1536
  buffer_store_dwordx2 v[14:15], v2, s[12:15], s25 offen offset:1536
  v_pk_add_f32 v[4:5], v[6:7], v[12:13] neg_hi:[0,1]
  v_pk_mul_f32 v[4:5], v[4:5], s[56:57]
  v_pk_add_f32 v[8:9], v[6:7], v[12:13] op_sel:[1,1] op_sel_hi:[0,0] neg_hi:[1,0]
  v_pk_mul_f32 v[8:9], v[8:9], s[56:57]
  v_pk_mul_f32 v[6:7], v[8:9], v[24:25] op_sel:[0,0] op_sel_hi:[1,0]
  v_pk_fma_f32 v[10:11], v[8:9], v[24:25], v[6:7] op_sel:[1,1,0] op_sel_hi:[0,1,1] neg_hi:[0,1,0]
  buffer_store_dwordx2 v[4:5], v2, s[12:15], s24 offen offset:2048
  buffer_store_dwordx2 v[10:11], v2, s[12:15], s25 offen offset:2048
  v_pk_add_f32 v[4:5], v[18:19], v[18:19] neg_hi:[0,1]
  v_pk_mul_f32 v[4:5], v[4:5], s[56:57]
  v_pk_add_f32 v[6:7], v[18:19], v[18:19] op_sel:[1,1] op_sel_hi:[0,0] neg_hi:[1,0]
  v_pk_mul_f32 v[6:7], v[6:7], s[56:57]
  v_pk_mul_f32 v[8:9], v[6:7], v[24:25] op_sel:[0,0] op_sel_hi:[1,0]
  v_pk_fma_f32 v[10:11], v[6:7], v[24:25], v[8:9] op_sel:[1,1,0] op_sel_hi:[0,1,1] neg_hi:[0,1,0]
  s_and_saveexec_b64 s[28:29], vcc
  buffer_store_dwordx2 v[4:5], v2, s[12:15], s24 offen offset:2560
  buffer_store_dwordx2 v[10:11], v2, s[12:15], s25 offen offset:2560
  s_mov_b64 exec, s[28:29]
L_k1_done:
  s_endpgm
.globl k2_kernel
.p2align 8
.type k2_kernel,@function
k2_kernel:
  s_cmp_ge_u32 s2, 168
  s_cbranch_scc1 L_k2_tr
  s_load_dwordx2 s[4:5], s[0:1], 80
  s_load_dwordx2 s[6:7], s[0:1], 8
  s_load_dwordx2 s[8:9], s[0:1], 16
  s_mul_i32 s56, s2, 3121
  s_lshr_b32 s56, s56, 16
  s_mul_i32 s57, s56, 21
  s_sub_u32 s57, s2, s57
  s_mov_b32 s60, 0x3f3504f3
  s_mov_b32 s61, 0xbf3504f3
  s_mov_b32 s62, 0xbf3504f3
  s_mov_b32 s63, 0xbf3504f3
  s_mov_b32 s64, 0x3f6c835e
  s_mov_b32 s65, 0xbec3ef15
  s_mov_b32 s66, 0x3ec3ef15
  s_mov_b32 s67, 0xbf6c835e
  s_mov_b32 s68, 0xbec3ef15
  s_mov_b32 s69, 0xbf6c835e
  s_mov_b32 s70, 0xbf6c835e
  s_mov_b32 s71, 0xbec3ef15
  s_mov_b32 s72, 0x3f3504f3
  s_mov_b32 s73, 0x3f3504f3
  s_mov_b32 s74, 0xbf3504f3
  s_mov_b32 s75, 0x3f3504f3
  s_mov_b32 s76, 0x3f6c835e
  s_mov_b32 s77, 0x3ec3ef15
  s_mov_b32 s78, 0x3ec3ef15
  s_mov_b32 s79, 0x3f6c835e
  s_mov_b32 s80, 0xbec3ef15
  s_mov_b32 s81, 0x3f6c835e
  s_mov_b32 s82, 0xbf6c835e
  s_mov_b32 s83, 0x3ec3ef15
  s_mul_i32 s24, s56, 688128
  s_mul_i32 s58, s57, 128
  s_add_u32 s24, s24, s58
  s_add_u32 s25, s24, 43008
  s_add_u32 s26, s25, 43008
  s_add_u32 s27, s26, 43008
  s_add_u32 s28, s27, 43008
  s_add_u32 s29, s28, 43008
  s_add_u32 s30, s29, 43008
  s_add_u32 s31, s30, 43008
  s_add_u32 s32, s31, 43008
  s_add_u32 s33, s32, 43008
  s_add_u32 s34, s33, 43008
  s_add_u32 s35, s34, 43008
  s_add_u32 s36, s35, 43008
  s_add_u32 s37, s36, 43008
  s_add_u32 s38, s37, 43008
  s_add_u32 s39, s38, 43008
  s_mul_i32 s40, s56, 642
  s_lshl_b32 s58, s57, 5
  s_add_u32 s40, s40, s58
  s_add_u32 s41, s40, 82176
  s_add_u32 s42, s41, 82176
  s_add_u32 s43, s42, 82176
  s_add_u32 s44, s43, 82176
  s_add_u32 s45, s44, 82176
  s_add_u32 s46, s45, 82176
  s_add_u32 s47, s46, 82176
  s_add_u32 s48, s47, 82176
  s_add_u32 s49, s48, 82176
  s_add_u32 s50, s49, 82176
  s_add_u32 s51, s50, 82176
  s_add_u32 s52, s51, 82176
  s_add_u32 s53, s52, 82176
  s_add_u32 s54, s53, 82176
  s_add_u32 s55, s54, 82176
  s_waitcnt lgkmcnt(0)
  s_mov_b32 s12, s4
  s_mov_b32 s13, s5
  s_mov_b32 s14, 5505024
  s_mov_b32 s15, 0x00020000
  s_mov_b32 s16, s6
  s_mov_b32 s17, s7
  s_mov_b32 s18, 1314816
  s_mov_b32 s19, 0x00020000
  s_mov_b32 s20, s8
  s_mov_b32 s21, s9
  s_mov_b32 s22, 1314816
  s_mov_b32 s23, 0x00020000
  v_and_b32 v1, 15, v0
  v_lshrrev_b32 v2, 4, v0
  v_mul_u32_u24 v3, 2688, v2
  v_lshl_add_u32 v4, v1, 3, v3
  v_mul_u32_u24 v3, 5136, v2
  v_lshl_add_u32 v5, v1, 1, v3
  buffer_load_dwordx2 v[6:7], v4, s[12:15], s24 offen
  buffer_load_dwordx2 v[8:9], v4, s[12:15], s25 offen
  buffer_load_dwordx2 v[10:11], v4, s[12:15], s26 offen
  buffer_load_dwordx2 v[12:13], v4, s[12:15], s27 offen
  buffer_load_dwordx2 v[14:15], v4, s[12:15], s28 offen
  buffer_load_dwordx2 v[16:17], v4, s[12:15], s29 offen
  buffer_load_dwordx2 v[18:19], v4, s[12:15], s30 offen
  buffer_load_dwordx2 v[20:21], v4, s[12:15], s31 offen
  buffer_load_dwordx2 v[22:23], v4, s[12:15], s32 offen
  buffer_load_dwordx2 v[24:25], v4, s[12:15], s33 offen
  buffer_load_dwordx2 v[26:27], v4, s[12:15], s34 offen
  buffer_load_dwordx2 v[28:29], v4, s[12:15], s35 offen
  buffer_load_dwordx2 v[30:31], v4, s[12:15], s36 offen
  buffer_load_dwordx2 v[32:33], v4, s[12:15], s37 offen
  buffer_load_dwordx2 v[34:35], v4, s[12:15], s38 offen
  buffer_load_dwordx2 v[36:37], v4, s[12:15], s39 offen
  buffer_load_ushort v38, v5, s[16:19], s40 offen
  buffer_load_ushort v39, v5, s[20:23], s40 offen
  buffer_load_ushort v40, v5, s[16:19], s41 offen
  buffer_load_ushort v41, v5, s[20:23], s41 offen
  buffer_load_ushort v42, v5, s[16:19], s42 offen
  buffer_load_ushort v43, v5, s[20:23], s42 offen
  buffer_load_ushort v44, v5, s[16:19], s43 offen
  buffer_load_ushort v45, v5, s[20:23], s43 offen
  buffer_load_ushort v46, v5, s[16:19], s44 offen
  buffer_load_ushort v47, v5, s[20:23], s44 offen
  buffer_load_ushort v48, v5, s[16:19], s45 offen
  buffer_load_ushort v49, v5, s[20:23], s45 offen
  buffer_load_ushort v50, v5, s[16:19], s46 offen
  buffer_load_ushort v51, v5, s[20:23], s46 offen
  buffer_load_ushort v52, v5, s[16:19], s47 offen
  buffer_load_ushort v53, v5, s[20:23], s47 offen
  buffer_load_ushort v54, v5, s[16:19], s48 offen
  buffer_load_ushort v55, v5, s[20:23], s48 offen
  buffer_load_ushort v56, v5, s[16:19], s49 offen
  buffer_load_ushort v57, v5, s[20:23], s49 offen
  buffer_load_ushort v58, v5, s[16:19], s50 offen
  buffer_load_ushort v59, v5, s[20:23], s50 offen
  buffer_load_ushort v60, v5, s[16:19], s51 offen
  buffer_load_ushort v61, v5, s[20:23], s51 offen
  buffer_load_ushort v62, v5, s[16:19], s52 offen
  buffer_load_ushort v63, v5, s[20:23], s52 offen
  buffer_load_ushort v64, v5, s[16:19], s53 offen
  buffer_load_ushort v65, v5, s[20:23], s53 offen
  buffer_load_ushort v66, v5, s[16:19], s54 offen
  buffer_load_ushort v67, v5, s[20:23], s54 offen
  buffer_load_ushort v68, v5, s[16:19], s55 offen
  buffer_load_ushort v69, v5, s[20:23], s55 offen
  v_cvt_f32_u32 v3, v2
  v_mul_f32 v5, 0x3b800000, v3
  v_cos_f32 v70, v5
  v_sin_f32 v71, v5
  v_mul_f32 v5, 0x3c000000, v3
  v_cos_f32 v72, v5
  v_sin_f32 v73, v5
  v_mul_f32 v5, 0x3c400000, v3
  v_cos_f32 v74, v5
  v_sin_f32 v75, v5
  v_mul_f32 v5, 0x3c800000, v3
  v_cos_f32 v76, v5
  v_sin_f32 v77, v5
  v_mul_f32 v5, 0x3ca00000, v3
  v_cos_f32 v78, v5
  v_sin_f32 v79, v5
  v_mul_f32 v5, 0x3cc00000, v3
  v_cos_f32 v80, v5
  v_sin_f32 v81, v5
  v_mul_f32 v5, 0x3ce00000, v3
  v_cos_f32 v82, v5
  v_sin_f32 v83, v5
  v_mul_f32 v5, 0x3d000000, v3
  v_cos_f32 v84, v5
  v_sin_f32 v85, v5
  v_mul_f32 v5, 0x3d100000, v3
  v_cos_f32 v86, v5
  v_sin_f32 v87, v5
  v_mul_f32 v5, 0x3d200000, v3
  v_cos_f32 v88, v5
  v_sin_f32 v89, v5
  v_mul_f32 v5, 0x3d300000, v3
  v_cos_f32 v90, v5
  v_sin_f32 v91, v5
  v_mul_f32 v5, 0x3d400000, v3
  v_cos_f32 v92, v5
  v_sin_f32 v93, v5
  v_mul_f32 v5, 0x3d500000, v3
  v_cos_f32 v94, v5
  v_sin_f32 v95, v5
  v_mul_f32 v5, 0x3d600000, v3
  v_cos_f32 v96, v5
  v_sin_f32 v97, v5
  v_mul_f32 v5, 0x3d700000, v3
  v_cos_f32 v98, v5
  v_sin_f32 v99, v5
  v_lshlrev_b32 v3, 3, v0
  v_mul_u32_u24 v5, 2176, v2
  v_lshl_add_u32 v2, v1, 3, v5
  s_waitcnt vmcnt(32)
  v_pk_add_f32 v[100:101], v[6:7], v[22:23]
  v_pk_add_f32 v[102:103], v[6:7], v[22:23] neg_lo:[0,1] neg_hi:[0,1]
  v_pk_add_f32 v[6:7], v[14:15], v[30:31]
  v_pk_add_f32 v[22:23], v[14:15], v[30:31] neg_lo:[0,1] neg_hi:[0,1]
  v_pk_add_f32 v[14:15], v[100:101], v[6:7]
  v_pk_add_f32 v[30:31], v[100:101], v[6:7] neg_lo:[0,1] neg_hi:[0,1]
  v_pk_add_f32 v[6:7], v[102:103], v[22:23] op_sel:[0,1] op_sel_hi:[1,0] neg_hi:[0,1]
  v_pk_add_f32 v[100:101], v[102:103], v[22:23] op_sel:[0,1] op_sel_hi:[1,0] neg_lo:[0,1]
  v_pk_add_f32 v[22:23], v[10:11], v[26:27]
  v_pk_add_f32 v[102:103], v[10:11], v[26:27] neg_lo:[0,1] neg_hi:[0,1]
  v_pk_add_f32 v[10:11], v[18:19], v[34:35]
  v_pk_add_f32 v[26:27], v[18:19], v[34:35] neg_lo:[0,1] neg_hi:[0,1]
  v_pk_add_f32 v[18:19], v[22:23], v[10:11]
  v_pk_add_f32 v[34:35], v[22:23], v[10:11] neg_lo:[0,1] neg_hi:[0,1]
  v_pk_add_f32 v[10:11], v[102:103], v[26:27] op_sel:[0,1] op_sel_hi:[1,0] neg_hi:[0,1]
  v_pk_add_f32 v[22:23], v[102:103], v[26:27] op_sel:[0,1] op_sel_hi:[1,0] neg_lo:[0,1]
  v_pk_add_f32 v[26:27], v[14:15], v[18:19]
  v_pk_add_f32 v[102:103], v[14:15], v[18:19] neg_lo:[0,1] neg_hi:[0,1]
  v_pk_mul_f32 v[14:15], v[10:11], s[60:61] op_sel:[0,0] op_sel_hi:[1,0]
  v_pk_fma_f32 v[18:19], v[10:11], s[60:61], v[14:15] op_sel:[1,1,0] op_sel_hi:[0,1,1] neg_lo:[0,1,0]
  v_pk_add_f32 v[10:11], v[6:7], v[18:19]
  v_pk_add_f32 v[14:15], v[6:7], v[18:19] neg_lo:[0,1] neg_hi:[0,1]
  v_pk_add_f32 v[6:7], v[30:31], v[34:35] op_sel:[0,1] op_sel_hi:[1,0] neg_hi:[0,1]
  v_pk_add_f32 v[18:19], v[30:31], v[34:35] op_sel:[0,1] op_sel_hi:[1,0] neg_lo:[0,1]
  v_pk_mul_f32 v[30:31], v[22:23], s[62:63] op_sel:[0,0] op_sel_hi:[1,0]
  v_pk_fma_f32 v[34:35], v[22:23], s[62:63], v[30:31] op_sel:[1,1,0] op_sel_hi:[0,1,1] neg_lo:[0,1,0]
  v_pk_add_f32 v[22:23], v[100:101], v[34:35]
  v_pk_add_f32 v[30:31], v[100:101], v[34:35] neg_lo:[0,1] neg_hi:[0,1]
  v_pk_add_f32 v[34:35], v[8:9], v[24:25]
  v_pk_add_f32 v[100:101], v[8:9], v[24:25] neg_lo:[0,1] neg_hi:[0,1]
  v_pk_add_f32 v[8:9], v[16:17], v[32:33]
  v_pk_add_f32 v[24:25], v[16:17], v[32:33] neg_lo:[0,1] neg_hi:[0,1]
  v_pk_add_f32 v[16:17], v[34:35], v[8:9]
  v_pk_add_f32 v[32:33], v[34:35], v[8:9] neg_lo:[0,1] neg_hi:[0,1]
  v_pk_add_f32 v[8:9], v[100:101], v[24:25] op_sel:[0,1] op_sel_hi:[1,0] neg_hi:[0,1]
  v_pk_add_f32 v[34:35], v[100:101], v[24:25] op_sel:[0,1] op_sel_hi:[1,0] neg_lo:[0,1]
  v_pk_add_f32 v[24:25], v[12:13], v[28:29]
  v_pk_add_f32 v[100:101], v[12:13], v[28:29] neg_lo:[0,1] neg_hi:[0,1]
  v_pk_add_f32 v[12:13], v[20:21], v[36:37]
  v_pk_add_f32 v[28:29], v[20:21], v[36:37] neg_lo:[0,1] neg_hi:[0,1]
  v_pk_add_f32 v[20:21], v[24:25], v[12:13]
  v_pk_add_f32 v[36:37], v[24:25], v[12:13] neg_lo:[0,1] neg_hi:[0,1]
  v_pk_add_f32 v[12:13], v[100:101], v[28:29] op_sel:[0,1] op_sel_hi:[1,0] neg_hi:[0,1]
  v_pk_add_f32 v[24:25], v[100:101], v[28:29] op_sel:[0,1] op_sel_hi:[1,0] neg_lo:[0,1]
  v_pk_add_f32 v[28:29], v[16:17], v[20:21]
  v_pk_add_f32 v[100:101], v[16:17], v[20:21] neg_lo:[0,1] neg_hi:[0,1]
  v_pk_mul_f32 v[16:17], v[12:13], s[60:61] op_sel:[0,0] op_sel_hi:[1,0]
  v_pk_fma_f32 v[20:21], v[12:13], s[60:61], v[16:17] op_sel:[1,1,0] op_sel_hi:[0,1,1] neg_lo:[0,1,0]
  v_pk_add_f32 v[12:13], v[8:9], v[20:21]
  v_pk_add_f32 v[16:17], v[8:9], v[20:21] neg_lo:[0,1] neg_hi:[0,1]
  v_pk_add_f32 v[8:9], v[32:33], v[36:37] op_sel:[0,1] op_sel_hi:[1,0] neg_hi:[0,1]
  v_pk_add_f32 v[20:21], v[32:33], v[36:37] op_sel:[0,1] op_sel_hi:[1,0] neg_lo:[0,1]
  v_pk_mul_f32 v[32:33], v[24:25], s[62:63] op_sel:[0,0] op_sel_hi:[1,0]
  v_pk_fma_f32 v[36:37], v[24:25], s[62:63], v[32:33] op_sel:[1,1,0] op_sel_hi:[0,1,1] neg_lo:[0,1,0]
  v_pk_add_f32 v[24:25], v[34:35], v[36:37]
  v_pk_add_f32 v[32:33], v[34:35], v[36:37] neg_lo:[0,1] neg_hi:[0,1]
  v_pk_add_f32 v[34:35], v[26:27], v[28:29]
  v_pk_add_f32 v[36:37], v[26:27], v[28:29] neg_lo:[0,1] neg_hi:[0,1]
  v_pk_mul_f32 v[26:27], v[12:13], s[64:65] op_sel:[0,0] op_sel_hi:[1,0]
  v_pk_fma_f32 v[28:29], v[12:13], s[64:65], v[26:27] op_sel:[1,1,0] op_sel_hi:[0,1,1] neg_lo:[0,1,0]
  v_pk_add_f32 v[12:13], v[10:11], v[28:29]
  v_pk_add_f32 v[26:27], v[10:11], v[28:29] neg_lo:[0,1] neg_hi:[0,1]
  v_pk_mul_f32 v[10:11], v[8:9], s[60:61] op_sel:[0,0] op_sel_hi:[1,0]
  v_pk_fma_f32 v[28:29], v[8:9], s[60:61], v[10:11] op_sel:[1,1,0] op_sel_hi:[0,1,1] neg_lo:[0,1,0]
  v_pk_add_f32 v[8:9], v[6:7], v[28:29]
  v_pk_add_f32 v[10:11], v[6:7], v[28:29] neg_lo:[0,1] neg_hi:[0,1]
  v_pk_mul_f32 v[6:7], v[24:25], s[66:67] op_sel:[0,0] op_sel_hi:[1,0]
  v_pk_fma_f32 v[28:29], v[24:25], s[66:67], v[6:7] op_sel:[1,1,0] op_sel_hi:[0,1,1] neg_lo:[0,1,0]
  v_pk_add_f32 v[6:7], v[22:23], v[28:29]
  v_pk_add_f32 v[24:25], v[22:23], v[28:29] neg_lo:[0,1] neg_hi:[0,1]
  v_pk_add_f32 v[22:23], v[102:103], v[100:101] op_sel:[0,1] op_sel_hi:[1,0] neg_hi:[0,1]
  v_pk_add_f32 v[28:29], v[102:103], v[100:101] op_sel:[0,1] op_sel_hi:[1,0] neg_lo:[0,1]
  v_pk_mul_f32 v[100:101], v[16:17], s[68:69] op_sel:[0,0] op_sel_hi:[1,0]
  v_pk_fma_f32 v[102:103], v[16:17], s[68:69], v[100:101] op_sel:[1,1,0] op_sel_hi:[0,1,1] neg_lo:[0,1,0]
  v_pk_add_f32 v[16:17], v[14:15], v[102:103]
  v_pk_add_f32 v[100:101], v[14:15], v[102:103] neg_lo:[0,1] neg_hi:[0,1]
  v_pk_mul_f32 v[14:15], v[20:21], s[62:63] op_sel:[0,0] op_sel_hi:[1,0]
  v_pk_fma_f32 v[102:103], v[20:21], s[62:63], v[14:15] op_sel:[1,1,0] op_sel_hi:[0,1,1] neg_lo:[0,1,0]
  v_pk_add_f32 v[14:15], v[18:19], v[102:103]
  v_pk_add_f32 v[20:21], v[18:19], v[102:103] neg_lo:[0,1] neg_hi:[0,1]
  v_pk_mul_f32 v[18:19], v[32:33], s[70:71] op_sel:[0,0] op_sel_hi:[1,0]
  v_pk_fma_f32 v[102:103], v[32:33], s[70:71], v[18:19] op_sel:[1,1,0] op_sel_hi:[0,1,1] neg_lo:[0,1,0]
  v_pk_add_f32 v[18:19], v[30:31], v[102:103]
  v_pk_add_f32 v[32:33], v[30:31], v[102:103] neg_lo:[0,1] neg_hi:[0,1]
  ds_write_b64 v3, v[34:35] offset:0
  v_pk_mul_f32 v[30:31], v[12:13], v[70:71] op_sel:[0,0] op_sel_hi:[1,0]
  v_pk_fma_f32 v[34:35], v[12:13], v[70:71], v[30:31] op_sel:[1,1,0] op_sel_hi:[0,1,1] neg_hi:[0,1,0]
  ds_write_b64 v3, v[34:35] offset:2176
  v_pk_mul_f32 v[12:13], v[8:9], v[72:73] op_sel:[0,0] op_sel_hi:[1,0]
  v_pk_fma_f32 v[30:31], v[8:9], v[72:73], v[12:13] op_sel:[1,1,0] op_sel_hi:[0,1,1] neg_hi:[0,1,0]
  ds_write_b64 v3, v[30:31] offset:4352
  v_pk_mul_f32 v[8:9], v[6:7], v[74:75] op_sel:[0,0] op_sel_hi:[1,0]
  v_pk_fma_f32 v[12:13], v[6:7], v[74:75], v[8:9] op_sel:[1,1,0] op_sel_hi:[0,1,1] neg_hi:[0,1,0]
  ds_write_b64 v3, v[12:13] offset:6528
  v_pk_mul_f32 v[6:7], v[22:23], v[76:77] op_sel:[0,0] op_sel_hi:[1,0]
  v_pk_fma_f32 v[8:9], v[22:23], v[76:77], v[6:7] op_sel:[1,1,0] op_sel_hi:[0,1,1] neg_hi:[0,1,0]
  ds_write_b64 v3, v[8:9] offset:8704
  v_pk_mul_f32 v[6:7], v[16:17], v[78:79] op_sel:[0,0] op_sel_hi:[1,0]
  v_pk_fma_f32 v[8:9], v[16:17], v[78:79], v[6:7] op_sel:[1,1,0] op_sel_hi:[0,1,1] neg_hi:[0,1,0]
  ds_write_b64 v3, v[8:9] offset:10880
  v_pk_mul_f32 v[6:7], v[14:15], v[80:81] op_sel:[0,0] op_sel_hi:[1,0]
  v_pk_fma_f32 v[8:9], v[14:15], v[80:81], v[6:7] op_sel:[1,1,0] op_sel_hi:[0,1,1] neg_hi:[0,1,0]
  ds_write_b64 v3, v[8:9] offset:13056
  v_pk_mul_f32 v[6:7], v[18:19], v[82:83] op_sel:[0,0] op_sel_hi:[1,0]
  v_pk_fma_f32 v[8:9], v[18:19], v[82:83], v[6:7] op_sel:[1,1,0] op_sel_hi:[0,1,1] neg_hi:[0,1,0]
  ds_write_b64 v3, v[8:9] offset:15232
  v_pk_mul_f32 v[6:7], v[36:37], v[84:85] op_sel:[0,0] op_sel_hi:[1,0]
  v_pk_fma_f32 v[8:9], v[36:37], v[84:85], v[6:7] op_sel:[1,1,0] op_sel_hi:[0,1,1] neg_hi:[0,1,0]
  ds_write_b64 v3, v[8:9] offset:17408
  v_pk_mul_f32 v[6:7], v[26:27], v[86:87] op_sel:[0,0] op_sel_hi:[1,0]
  v_pk_fma_f32 v[8:9], v[26:27], v[86:87], v[6:7] op_sel:[1,1,0] op_sel_hi:[0,1,1] neg_hi:[0,1,0]
  ds_write_b64 v3, v[8:9] offset:19584
  v_pk_mul_f32 v[6:7], v[10:11], v[88:89] op_sel:[0,0] op_sel_hi:[1,0]
  v_pk_fma_f32 v[8:9], v[10:11], v[88:89], v[6:7] op_sel:[1,1,0] op_sel_hi:[0,1,1] neg_hi:[0,1,0]
  ds_write_b64 v3, v[8:9] offset:21760
  v_pk_mul_f32 v[6:7], v[24:25], v[90:91] op_sel:[0,0] op_sel_hi:[1,0]
  v_pk_fma_f32 v[8:9], v[24:25], v[90:91], v[6:7] op_sel:[1,1,0] op_sel_hi:[0,1,1] neg_hi:[0,1,0]
  ds_write_b64 v3, v[8:9] offset:23936
  v_pk_mul_f32 v[6:7], v[28:29], v[92:93] op_sel:[0,0] op_sel_hi:[1,0]
  v_pk_fma_f32 v[8:9], v[28:29], v[92:93], v[6:7] op_sel:[1,1,0] op_sel_hi:[0,1,1] neg_hi:[0,1,0]
  ds_write_b64 v3, v[8:9] offset:26112
  v_pk_mul_f32 v[6:7], v[100:101], v[94:95] op_sel:[0,0] op_sel_hi:[1,0]
  v_pk_fma_f32 v[8:9], v[100:101], v[94:95], v[6:7] op_sel:[1,1,0] op_sel_hi:[0,1,1] neg_hi:[0,1,0]
  ds_write_b64 v3, v[8:9] offset:28288
  v_pk_mul_f32 v[6:7], v[20:21], v[96:97] op_sel:[0,0] op_sel_hi:[1,0]
  v_pk_fma_f32 v[8:9], v[20:21], v[96:97], v[6:7] op_sel:[1,1,0] op_sel_hi:[0,1,1] neg_hi:[0,1,0]
  ds_write_b64 v3, v[8:9] offset:30464
  v_pk_mul_f32 v[6:7], v[32:33], v[98:99] op_sel:[0,0] op_sel_hi:[1,0]
  v_pk_fma_f32 v[8:9], v[32:33], v[98:99], v[6:7] op_sel:[1,1,0] op_sel_hi:[0,1,1] neg_hi:[0,1,0]
  ds_write_b64 v3, v[8:9] offset:32640
  s_waitcnt lgkmcnt(0)
  s_barrier
  ds_read_b64 v[6:7], v2 offset:0
  ds_read_b64 v[8:9], v2 offset:128
  ds_read_b64 v[10:11], v2 offset:256
  ds_read_b64 v[12:13], v2 offset:384
  ds_read_b64 v[14:15], v2 offset:512
  ds_read_b64 v[16:17], v2 offset:640
  ds_read_b64 v[18:19], v2 offset:768
  ds_read_b64 v[20:21], v2 offset:896
  ds_read_b64 v[22:23], v2 offset:1024
  ds_read_b64 v[24:25], v2 offset:1152
  ds_read_b64 v[26:27], v2 offset:1280
  ds_read_b64 v[28:29], v2 offset:1408
  ds_read_b64 v[30:31], v2 offset:1536
  ds_read_b64 v[32:33], v2 offset:1664
  ds_read_b64 v[34:35], v2 offset:1792
  ds_read_b64 v[36:37], v2 offset:1920
  s_waitcnt lgkmcnt(0)
  v_pk_add_f32 v[100:101], v[6:7], v[22:23]
  v_pk_add_f32 v[102:103], v[6:7], v[22:23] neg_lo:[0,1] neg_hi:[0,1]
  v_pk_add_f32 v[6:7], v[14:15], v[30:31]
  v_pk_add_f32 v[22:23], v[14:15], v[30:31] neg_lo:[0,1] neg_hi:[0,1]
  v_pk_add_f32 v[14:15], v[100:101], v[6:7]
  v_pk_add_f32 v[30:31], v[100:101], v[6:7] neg_lo:[0,1] neg_hi:[0,1]
  v_pk_add_f32 v[6:7], v[102:103], v[22:23] op_sel:[0,1] op_sel_hi:[1,0] neg_hi:[0,1]
  v_pk_add_f32 v[100:101], v[102:103], v[22:23] op_sel:[0,1] op_sel_hi:[1,0] neg_lo:[0,1]
  v_pk_add_f32 v[22:23], v[10:11], v[26:27]
  v_pk_add_f32 v[102:103], v[10:11], v[26:27] neg_lo:[0,1] neg_hi:[0,1]
  v_pk_add_f32 v[10:11], v[18:19], v[34:35]
  v_pk_add_f32 v[26:27], v[18:19], v[34:35] neg_lo:[0,1] neg_hi:[0,1]
  v_pk_add_f32 v[18:19], v[22:23], v[10:11]
  v_pk_add_f32 v[34:35], v[22:23], v[10:11] neg_lo:[0,1] neg_hi:[0,1]
  v_pk_add_f32 v[10:11], v[102:103], v[26:27] op_sel:[0,1] op_sel_hi:[1,0] neg_hi:[0,1]
  v_pk_add_f32 v[22:23], v[102:103], v[26:27] op_sel:[0,1] op_sel_hi:[1,0] neg_lo:[0,1]
  v_pk_add_f32 v[26:27], v[14:15], v[18:19]
  v_pk_add_f32 v[102:103], v[14:15], v[18:19] neg_lo:[0,1] neg_hi:[0,1]
  v_pk_mul_f32 v[14:15], v[10:11], s[60:61] op_sel:[0,0] op_sel_hi:[1,0]
  v_pk_fma_f32 v[18:19], v[10:11], s[60:61], v[14:15] op_sel:[1,1,0] op_sel_hi:[0,1,1] neg_lo:[0,1,0]
  v_pk_add_f32 v[10:11], v[6:7], v[18:19]
  v_pk_add_f32 v[14:15], v[6:7], v[18:19] neg_lo:[0,1] neg_hi:[0,1]
  v_pk_add_f32 v[6:7], v[30:31], v[34:35] op_sel:[0,1] op_sel_hi:[1,0] neg_hi:[0,1]
  v_pk_add_f32 v[18:19], v[30:31], v[34:35] op_sel:[0,1] op_sel_hi:[1,0] neg_lo:[0,1]
  v_pk_mul_f32 v[30:31], v[22:23], s[62:63] op_sel:[0,0] op_sel_hi:[1,0]
  v_pk_fma_f32 v[34:35], v[22:23], s[62:63], v[30:31] op_sel:[1,1,0] op_sel_hi:[0,1,1] neg_lo:[0,1,0]
  v_pk_add_f32 v[22:23], v[100:101], v[34:35]
  v_pk_add_f32 v[30:31], v[100:101], v[34:35] neg_lo:[0,1] neg_hi:[0,1]
  v_pk_add_f32 v[34:35], v[8:9], v[24:25]
  v_pk_add_f32 v[100:101], v[8:9], v[24:25] neg_lo:[0,1] neg_hi:[0,1]
  v_pk_add_f32 v[8:9], v[16:17], v[32:33]
  v_pk_add_f32 v[24:25], v[16:17], v[32:33] neg_lo:[0,1] neg_hi:[0,1]
  v_pk_add_f32 v[16:17], v[34:35], v[8:9]
  v_pk_add_f32 v[32:33], v[34:35], v[8:9] neg_lo:[0,1] neg_hi:[0,1]
  v_pk_add_f32 v[8:9], v[100:101], v[24:25] op_sel:[0,1] op_sel_hi:[1,0] neg_hi:[0,1]
  v_pk_add_f32 v[34:35], v[100:101], v[24:25] op_sel:[0,1] op_sel_hi:[1,0] neg_lo:[0,1]
  v_pk_add_f32 v[24:25], v[12:13], v[28:29]
  v_pk_add_f32 v[100:101], v[12:13], v[28:29] neg_lo:[0,1] neg_hi:[0,1]
  v_pk_add_f32 v[12:13], v[20:21], v[36:37]
  v_pk_add_f32 v[28:29], v[20:21], v[36:37] neg_lo:[0,1] neg_hi:[0,1]
  v_pk_add_f32 v[20:21], v[24:25], v[12:13]
  v_pk_add_f32 v[36:37], v[24:25], v[12:13] neg_lo:[0,1] neg_hi:[0,1]
  v_pk_add_f32 v[12:13], v[100:101], v[28:29] op_sel:[0,1] op_sel_hi:[1,0] neg_hi:[0,1]
  v_pk_add_f32 v[24:25], v[100:101], v[28:29] op_sel:[0,1] op_sel_hi:[1,0] neg_lo:[0,1]
  v_pk_add_f32 v[28:29], v[16:17], v[20:21]
  v_pk_add_f32 v[100:101], v[16:17], v[20:21] neg_lo:[0,1] neg_hi:[0,1]
  v_pk_mul_f32 v[16:17], v[12:13], s[60:61] op_sel:[0,0] op_sel_hi:[1,0]
  v_pk_fma_f32 v[20:21], v[12:13], s[60:61], v[16:17] op_sel:[1,1,0] op_sel_hi:[0,1,1] neg_lo:[0,1,0]
  v_pk_add_f32 v[12:13], v[8:9], v[20:21]
  v_pk_add_f32 v[16:17], v[8:9], v[20:21] neg_lo:[0,1] neg_hi:[0,1]
  v_pk_add_f32 v[8:9], v[32:33], v[36:37] op_sel:[0,1] op_sel_hi:[1,0] neg_hi:[0,1]
  v_pk_add_f32 v[20:21], v[32:33], v[36:37] op_sel:[0,1] op_sel_hi:[1,0] neg_lo:[0,1]
  v_pk_mul_f32 v[32:33], v[24:25], s[62:63] op_sel:[0,0] op_sel_hi:[1,0]
  v_pk_fma_f32 v[36:37], v[24:25], s[62:63], v[32:33] op_sel:[1,1,0] op_sel_hi:[0,1,1] neg_lo:[0,1,0]
  v_pk_add_f32 v[24:25], v[34:35], v[36:37]
  v_pk_add_f32 v[32:33], v[34:35], v[36:37] neg_lo:[0,1] neg_hi:[0,1]
  v_pk_add_f32 v[34:35], v[26:27], v[28:29]
  v_pk_add_f32 v[36:37], v[26:27], v[28:29] neg_lo:[0,1] neg_hi:[0,1]
  v_pk_mul_f32 v[26:27], v[12:13], s[64:65] op_sel:[0,0] op_sel_hi:[1,0]
  v_pk_fma_f32 v[28:29], v[12:13], s[64:65], v[26:27] op_sel:[1,1,0] op_sel_hi:[0,1,1] neg_lo:[0,1,0]
  v_pk_add_f32 v[12:13], v[10:11], v[28:29]
  v_pk_add_f32 v[26:27], v[10:11], v[28:29] neg_lo:[0,1] neg_hi:[0,1]
  v_pk_mul_f32 v[10:11], v[8:9], s[60:61] op_sel:[0,0] op_sel_hi:[1,0]
  v_pk_fma_f32 v[28:29], v[8:9], s[60:61], v[10:11] op_sel:[1,1,0] op_sel_hi:[0,1,1] neg_lo:[0,1,0]
  v_pk_add_f32 v[8:9], v[6:7], v[28:29]
  v_pk_add_f32 v[10:11], v[6:7], v[28:29] neg_lo:[0,1] neg_hi:[0,1]
  v_pk_mul_f32 v[6:7], v[24:25], s[66:67] op_sel:[0,0] op_sel_hi:[1,0]
  v_pk_fma_f32 v[28:29], v[24:25], s[66:67], v[6:7] op_sel:[1,1,0] op_sel_hi:[0,1,1] neg_lo:[0,1,0]
  v_pk_add_f32 v[6:7], v[22:23], v[28:29]
  v_pk_add_f32 v[24:25], v[22:23], v[28:29] neg_lo:[0,1] neg_hi:[0,1]
  v_pk_add_f32 v[22:23], v[102:103], v[100:101] op_sel:[0,1] op_sel_hi:[1,0] neg_hi:[0,1]
  v_pk_add_f32 v[28:29], v[102:103], v[100:101] op_sel:[0,1] op_sel_hi:[1,0] neg_lo:[0,1]
  v_pk_mul_f32 v[100:101], v[16:17], s[68:69] op_sel:[0,0] op_sel_hi:[1,0]
  v_pk_fma_f32 v[102:103], v[16:17], s[68:69], v[100:101] op_sel:[1,1,0] op_sel_hi:[0,1,1] neg_lo:[0,1,0]
  v_pk_add_f32 v[16:17], v[14:15], v[102:103]
  v_pk_add_f32 v[100:101], v[14:15], v[102:103] neg_lo:[0,1] neg_hi:[0,1]
  v_pk_mul_f32 v[14:15], v[20:21], s[62:63] op_sel:[0,0] op_sel_hi:[1,0]
  v_pk_fma_f32 v[102:103], v[20:21], s[62:63], v[14:15] op_sel:[1,1,0] op_sel_hi:[0,1,1] neg_lo:[0,1,0]
  v_pk_add_f32 v[14:15], v[18:19], v[102:103]
  v_pk_add_f32 v[20:21], v[18:19], v[102:103] neg_lo:[0,1] neg_hi:[0,1]
  v_pk_mul_f32 v[18:19], v[32:33], s[70:71] op_sel:[0,0] op_sel_hi:[1,0]
  v_pk_fma_f32 v[102:103], v[32:33], s[70:71], v[18:19] op_sel:[1,1,0] op_sel_hi:[0,1,1] neg_lo:[0,1,0]
  v_pk_add_f32 v[18:19], v[30:31], v[102:103]
  v_pk_add_f32 v[32:33], v[30:31], v[102:103] neg_lo:[0,1] neg_hi:[0,1]
  s_waitcnt vmcnt(0)
  v_lshlrev_b32 v38, 16, v38
  v_lshlrev_b32 v39, 16, v39
  v_pk_mul_f32 v[30:31], v[34:35], v[38:39] op_sel:[0,0] op_sel_hi:[1,0]
  v_pk_fma_f32 v[102:103], v[34:35], v[38:39], v[30:31] op_sel:[1,1,0] op_sel_hi:[0,1,1] neg_lo:[0,1,0]
  v_lshlrev_b32 v40, 16, v40
  v_lshlrev_b32 v41, 16, v41
  v_pk_mul_f32 v[30:31], v[12:13], v[40:41] op_sel:[0,0] op_sel_hi:[1,0]
  v_pk_fma_f32 v[34:35], v[12:13], v[40:41], v[30:31] op_sel:[1,1,0] op_sel_hi:[0,1,1] neg_lo:[0,1,0]
  v_lshlrev_b32 v42, 16, v42
  v_lshlrev_b32 v43, 16, v43
  v_pk_mul_f32 v[12:13], v[8:9], v[42:43] op_sel:[0,0] op_sel_hi:[1,0]
  v_pk_fma_f32 v[30:31], v[8:9], v[42:43], v[12:13] op_sel:[1,1,0] op_sel_hi:[0,1,1] neg_lo:[0,1,0]
  v_lshlrev_b32 v44, 16, v44
  v_lshlrev_b32 v45, 16, v45
  v_pk_mul_f32 v[8:9], v[6:7], v[44:45] op_sel:[0,0] op_sel_hi:[1,0]
  v_pk_fma_f32 v[12:13], v[6:7], v[44:45], v[8:9] op_sel:[1,1,0] op_sel_hi:[0,1,1] neg_lo:[0,1,0]
  v_lshlrev_b32 v46, 16, v46
  v_lshlrev_b32 v47, 16, v47
  v_pk_mul_f32 v[6:7], v[22:23], v[46:47] op_sel:[0,0] op_sel_hi:[1,0]
  v_pk_fma_f32 v[8:9], v[22:23], v[46:47], v[6:7] op_sel:[1,1,0] op_sel_hi:[0,1,1] neg_lo:[0,1,0]
  v_lshlrev_b32 v48, 16, v48
  v_lshlrev_b32 v49, 16, v49
  v_pk_mul_f32 v[6:7], v[16:17], v[48:49] op_sel:[0,0] op_sel_hi:[1,0]
  v_pk_fma_f32 v[22:23], v[16:17], v[48:49], v[6:7] op_sel:[1,1,0] op_sel_hi:[0,1,1] neg_lo:[0,1,0]
  v_lshlrev_b32 v50, 16, v50
  v_lshlrev_b32 v51, 16, v51
  v_pk_mul_f32 v[6:7], v[14:15], v[50:51] op_sel:[0,0] op_sel_hi:[1,0]
  v_pk_fma_f32 v[16:17], v[14:15], v[50:51], v[6:7] op_sel:[1,1,0] op_sel_hi:[0,1,1] neg_lo:[0,1,0]
  v_lshlrev_b32 v52, 16, v52
  v_lshlrev_b32 v53, 16, v53
  v_pk_mul_f32 v[6:7], v[18:19], v[52:53] op_sel:[0,0] op_sel_hi:[1,0]
  v_pk_fma_f32 v[14:15], v[18:19], v[52:53], v[6:7] op_sel:[1,1,0] op_sel_hi:[0,1,1] neg_lo:[0,1,0]
  v_lshlrev_b32 v54, 16, v54
  v_lshlrev_b32 v55, 16, v55
  v_pk_mul_f32 v[6:7], v[36:37], v[54:55] op_sel:[0,0] op_sel_hi:[1,0]
  v_pk_fma_f32 v[18:19], v[36:37], v[54:55], v[6:7] op_sel:[1,1,0] op_sel_hi:[0,1,1] neg_lo:[0,1,0]
  v_lshlrev_b32 v56, 16, v56
  v_lshlrev_b32 v57, 16, v57
  v_pk_mul_f32 v[6:7], v[26:27], v[56:57] op_sel:[0,0] op_sel_hi:[1,0]
  v_pk_fma_f32 v[36:37], v[26:27], v[56:57], v[6:7] op_sel:[1,1,0] op_sel_hi:[0,1,1] neg_lo:[0,1,0]
  v_lshlrev_b32 v58, 16, v58
  v_lshlrev_b32 v59, 16, v59
  v_pk_mul_f32 v[6:7], v[10:11], v[58:59] op_sel:[0,0] op_sel_hi:[1,0]
  v_pk_fma_f32 v[26:27], v[10:11], v[58:59], v[6:7] op_sel:[1,1,0] op_sel_hi:[0,1,1] neg_lo:[0,1,0]
  v_lshlrev_b32 v60, 16, v60
  v_lshlrev_b32 v61, 16, v61
  v_pk_mul_f32 v[6:7], v[24:25], v[60:61] op_sel:[0,0] op_sel_hi:[1,0]
  v_pk_fma_f32 v[10:11], v[24:25], v[60:61], v[6:7] op_sel:[1,1,0] op_sel_hi:[0,1,1] neg_lo:[0,1,0]
  v_lshlrev_b32 v62, 16, v62
  v_lshlrev_b32 v63, 16, v63
  v_pk_mul_f32 v[6:7], v[28:29], v[62:63] op_sel:[0,0] op_sel_hi:[1,0]
  v_pk_fma_f32 v[24:25], v[28:29], v[62:63], v[6:7] op_sel:[1,1,0] op_sel_hi:[0,1,1] neg_lo:[0,1,0]
  v_lshlrev_b32 v64, 16, v64
  v_lshlrev_b32 v65, 16, v65
  v_pk_mul_f32 v[6:7], v[100:101], v[64:65] op_sel:[0,0] op_sel_hi:[1,0]
  v_pk_fma_f32 v[28:29], v[100:101], v[64:65], v[6:7] op_sel:[1,1,0] op_sel_hi:[0,1,1] neg_lo:[0,1,0]
  v_lshlrev_b32 v66, 16, v66
  v_lshlrev_b32 v67, 16, v67
  v_pk_mul_f32 v[6:7], v[20:21], v[66:67] op_sel:[0,0] op_sel_hi:[1,0]
  v_pk_fma_f32 v[38:39], v[20:21], v[66:67], v[6:7] op_sel:[1,1,0] op_sel_hi:[0,1,1] neg_lo:[0,1,0]
  v_lshlrev_b32 v68, 16, v68
  v_lshlrev_b32 v69, 16, v69
  v_pk_mul_f32 v[6:7], v[32:33], v[68:69] op_sel:[0,0] op_sel_hi:[1,0]
  v_pk_fma_f32 v[20:21], v[32:33], v[68:69], v[6:7] op_sel:[1,1,0] op_sel_hi:[0,1,1] neg_lo:[0,1,0]
  v_add_u32 v1, 34816, v3
  v_add_u32 v3, 34816, v2
  v_pk_add_f32 v[6:7], v[102:103], v[18:19]
  v_pk_add_f32 v[32:33], v[102:103], v[18:19] neg_lo:[0,1] neg_hi:[0,1]
  v_pk_add_f32 v[18:19], v[8:9], v[24:25]
  v_pk_add_f32 v[40:41], v[8:9], v[24:25] neg_lo:[0,1] neg_hi:[0,1]
  v_pk_add_f32 v[8:9], v[6:7], v[18:19]
  v_pk_add_f32 v[24:25], v[6:7], v[18:19] neg_lo:[0,1] neg_hi:[0,1]
  v_pk_add_f32 v[6:7], v[32:33], v[40:41] op_sel:[0,1] op_sel_hi:[1,0] neg_lo:[0,1]
  v_pk_add_f32 v[18:19], v[32:33], v[40:41] op_sel:[0,1] op_sel_hi:[1,0] neg_hi:[0,1]
  v_pk_add_f32 v[32:33], v[30:31], v[26:27]
  v_pk_add_f32 v[40:41], v[30:31], v[26:27] neg_lo:[0,1] neg_hi:[0,1]
  v_pk_add_f32 v[26:27], v[16:17], v[38:39]
  v_pk_add_f32 v[30:31], v[16:17], v[38:39] neg_lo:[0,1] neg_hi:[0,1]
  v_pk_add_f32 v[16:17], v[32:33], v[26:27]
  v_pk_add_f32 v[38:39], v[32:33], v[26:27] neg_lo:[0,1] neg_hi:[0,1]
  v_pk_add_f32 v[26:27], v[40:41], v[30:31] op_sel:[0,1] op_sel_hi:[1,0] neg_lo:[0,1]
  v_pk_add_f32 v[32:33], v[40:41], v[30:31] op_sel:[0,1] op_sel_hi:[1,0] neg_hi:[0,1]
  v_pk_add_f32 v[30:31], v[8:9], v[16:17]
  v_pk_add_f32 v[40:41], v[8:9], v[16:17] neg_lo:[0,1] neg_hi:[0,1]
  v_pk_mul_f32 v[8:9], v[26:27], s[72:73] op_sel:[0,0] op_sel_hi:[1,0]
  v_pk_fma_f32 v[16:17], v[26:27], s[72:73], v[8:9] op_sel:[1,1,0] op_sel_hi:[0,1,1] neg_lo:[0,1,0]
  v_pk_add_f32 v[8:9], v[6:7], v[16:17]
  v_pk_add_f32 v[26:27], v[6:7], v[16:17] neg_lo:[0,1] neg_hi:[0,1]
  v_pk_add_f32 v[6:7], v[24:25], v[38:39] op_sel:[0,1] op_sel_hi:[1,0] neg_lo:[0,1]
  v_pk_add_f32 v[16:17], v[24:25], v[38:39] op_sel:[0,1] op_sel_hi:[1,0] neg_hi:[0,1]
  v_pk_mul_f32 v[24:25], v[32:33], s[74:75] op_sel:[0,0] op_sel_hi:[1,0]
  v_pk_fma_f32 v[38:39], v[32:33], s[74:75], v[24:25] op_sel:[1,1,0] op_sel_hi:[0,1,1] neg_lo:[0,1,0]
  v_pk_add_f32 v[24:25], v[18:19], v[38:39]
  v_pk_add_f32 v[32:33], v[18:19], v[38:39] neg_lo:[0,1] neg_hi:[0,1]
  v_pk_add_f32 v[18:19], v[34:35], v[36:37]
  v_pk_add_f32 v[38:39], v[34:35], v[36:37] neg_lo:[0,1] neg_hi:[0,1]
  v_pk_add_f32 v[34:35], v[22:23], v[28:29]
  v_pk_add_f32 v[36:37], v[22:23], v[28:29] neg_lo:[0,1] neg_hi:[0,1]
  v_pk_add_f32 v[22:23], v[18:19], v[34:35]
  v_pk_add_f32 v[28:29], v[18:19], v[34:35] neg_lo:[0,1] neg_hi:[0,1]
  v_pk_add_f32 v[18:19], v[38:39], v[36:37] op_sel:[0,1] op_sel_hi:[1,0] neg_lo:[0,1]
  v_pk_add_f32 v[34:35], v[38:39], v[36:37] op_sel:[0,1] op_sel_hi:[1,0] neg_hi:[0,1]
  v_pk_add_f32 v[36:37], v[12:13], v[10:11]
  v_pk_add_f32 v[38:39], v[12:13], v[10:11] neg_lo:[0,1] neg_hi:[0,1]
  v_pk_add_f32 v[10:11], v[14:15], v[20:21]
  v_pk_add_f32 v[12:13], v[14:15], v[20:21] neg_lo:[0,1] neg_hi:[0,1]
  v_pk_add_f32 v[14:15], v[36:37], v[10:11]
  v_pk_add_f32 v[20:21], v[36:37], v[10:11] neg_lo:[0,1] neg_hi:[0,1]
  v_pk_add_f32 v[10:11], v[38:39], v[12:13] op_sel:[0,1] op_sel_hi:[1,0] neg_lo:[0,1]
  v_pk_add_f32 v[36:37], v[38:39], v[12:13] op_sel:[0,1] op_sel_hi:[1,0] neg_hi:[0,1]
  v_pk_add_f32 v[12:13], v[22:23], v[14:15]
  v_pk_add_f32 v[38:39], v[22:23], v[14:15] neg_lo:[0,1] neg_hi:[0,1]
  v_pk_mul_f32 v[14:15], v[10:11], s[72:73] op_sel:[0,0] op_sel_hi:[1,0]
  v_pk_fma_f32 v[22:23], v[10:11], s[72:73], v[14:15] op_sel:[1,1,0] op_sel_hi:[0,1,1] neg_lo:[0,1,0]
  v_pk_add_f32 v[10:11], v[18:19], v[22:23]
  v_pk_add_f32 v[14:15], v[18:19], v[22:23] neg_lo:[0,1] neg_hi:[0,1]
  v_pk_add_f32 v[18:19], v[28:29], v[20:21] op_sel:[0,1] op_sel_hi:[1,0] neg_lo:[0,1]
  v_pk_add_f32 v[22:23], v[28:29], v[20:21] op_sel:[0,1] op_sel_hi:[1,0] neg_hi:[0,1]
  v_pk_mul_f32 v[20:21], v[36:37], s[74:75] op_sel:[0,0] op_sel_hi:[1,0]
  v_pk_fma_f32 v[28:29], v[36:37], s[74:75], v[20:21] op_sel:[1,1,0] op_sel_hi:[0,1,1] neg_lo:[0,1,0]
  v_pk_add_f32 v[20:21], v[34:35], v[28:29]
  v_pk_add_f32 v[36:37], v[34:35], v[28:29] neg_lo:[0,1] neg_hi:[0,1]
  v_pk_add_f32 v[28:29], v[30:31], v[12:13]
  v_pk_add_f32 v[34:35], v[30:31], v[12:13] neg_lo:[0,1] neg_hi:[0,1]
  v_pk_mul_f32 v[12:13], v[10:11], s[76:77] op_sel:[0,0] op_sel_hi:[1,0]
  v_pk_fma_f32 v[30:31], v[10:11], s[76:77], v[12:13] op_sel:[1,1,0] op_sel_hi:[0,1,1] neg_lo:[0,1,0]
  v_pk_add_f32 v[10:11], v[8:9], v[30:31]
  v_pk_add_f32 v[12:13], v[8:9], v[30:31] neg_lo:[0,1] neg_hi:[0,1]
  v_pk_mul_f32 v[8:9], v[18:19], s[72:73] op_sel:[0,0] op_sel_hi:[1,0]
  v_pk_fma_f32 v[30:31], v[18:19], s[72:73], v[8:9] op_sel:[1,1,0] op_sel_hi:[0,1,1] neg_lo:[0,1,0]
  v_pk_add_f32 v[8:9], v[6:7], v[30:31]
  v_pk_add_f32 v[18:19], v[6:7], v[30:31] neg_lo:[0,1] neg_hi:[0,1]
  v_pk_mul_f32 v[6:7], v[20:21], s[78:79] op_sel:[0,0] op_sel_hi:[1,0]
  v_pk_fma_f32 v[30:31], v[20:21], s[78:79], v[6:7] op_sel:[1,1,0] op_sel_hi:[0,1,1] neg_lo:[0,1,0]
  v_pk_add_f32 v[6:7], v[24:25], v[30:31]
  v_pk_add_f32 v[20:21], v[24:25], v[30:31] neg_lo:[0,1] neg_hi:[0,1]
  v_pk_add_f32 v[24:25], v[40:41], v[38:39] op_sel:[0,1] op_sel_hi:[1,0] neg_lo:[0,1]
  v_pk_add_f32 v[30:31], v[40:41], v[38:39] op_sel:[0,1] op_sel_hi:[1,0] neg_hi:[0,1]
  v_pk_mul_f32 v[38:39], v[14:15], s[80:81] op_sel:[0,0] op_sel_hi:[1,0]
  v_pk_fma_f32 v[40:41], v[14:15], s[80:81], v[38:39] op_sel:[1,1,0] op_sel_hi:[0,1,1] neg_lo:[0,1,0]
  v_pk_add_f32 v[14:15], v[26:27], v[40:41]
  v_pk_add_f32 v[38:39], v[26:27], v[40:41] neg_lo:[0,1] neg_hi:[0,1]
  v_pk_mul_f32 v[26:27], v[22:23], s[74:75] op_sel:[0,0] op_sel_hi:[1,0]
  v_pk_fma_f32 v[40:41], v[22:23], s[74:75], v[26:27] op_sel:[1,1,0] op_sel_hi:[0,1,1] neg_lo:[0,1,0]
  v_pk_add_f32 v[22:23], v[16:17], v[40:41]
  v_pk_add_f32 v[26:27], v[16:17], v[40:41] neg_lo:[0,1] neg_hi:[0,1]
  v_pk_mul_f32 v[16:17], v[36:37], s[82:83] op_sel:[0,0] op_sel_hi:[1,0]
  v_pk_fma_f32 v[40:41], v[36:37], s[82:83], v[16:17] op_sel:[1,1,0] op_sel_hi:[0,1,1] neg_lo:[0,1,0]
  v_pk_add_f32 v[16:17], v[32:33], v[40:41]
  v_pk_add_f32 v[36:37], v[32:33], v[40:41] neg_lo:[0,1] neg_hi:[0,1]
  ds_write_b64 v1, v[28:29] offset:0
  v_pk_mul_f32 v[28:29], v[10:11], v[70:71] op_sel:[0,0] op_sel_hi:[1,0]
  v_pk_fma_f32 v[32:33], v[10:11], v[70:71], v[28:29] op_sel:[1,1,0] op_sel_hi:[0,1,1] neg_lo:[0,1,0]
  ds_write_b64 v1, v[32:33] offset:2176
  v_pk_mul_f32 v[10:11], v[8:9], v[72:73] op_sel:[0,0] op_sel_hi:[1,0]
  v_pk_fma_f32 v[28:29], v[8:9], v[72:73], v[10:11] op_sel:[1,1,0] op_sel_hi:[0,1,1] neg_lo:[0,1,0]
  ds_write_b64 v1, v[28:29] offset:4352
  v_pk_mul_f32 v[8:9], v[6:7], v[74:75] op_sel:[0,0] op_sel_hi:[1,0]
  v_pk_fma_f32 v[10:11], v[6:7], v[74:75], v[8:9] op_sel:[1,1,0] op_sel_hi:[0,1,1] neg_lo:[0,1,0]
  ds_write_b64 v1, v[10:11] offset:6528
  v_pk_mul_f32 v[6:7], v[24:25], v[76:77] op_sel:[0,0] op_sel_hi:[1,0]
  v_pk_fma_f32 v[8:9], v[24:25], v[76:77], v[6:7] op_sel:[1,1,0] op_sel_hi:[0,1,1] neg_lo:[0,1,0]
  ds_write_b64 v1, v[8:9] offset:8704
  v_pk_mul_f32 v[6:7], v[14:15], v[78:79] op_sel:[0,0] op_sel_hi:[1,0]
  v_pk_fma_f32 v[8:9], v[14:15], v[78:79], v[6:7] op_sel:[1,1,0] op_sel_hi:[0,1,1] neg_lo:[0,1,0]
  ds_write_b64 v1, v[8:9] offset:10880
  v_pk_mul_f32 v[6:7], v[22:23], v[80:81] op_sel:[0,0] op_sel_hi:[1,0]
  v_pk_fma_f32 v[8:9], v[22:23], v[80:81], v[6:7] op_sel:[1,1,0] op_sel_hi:[0,1,1] neg_lo:[0,1,0]
  ds_write_b64 v1, v[8:9] offset:13056
  v_pk_mul_f32 v[6:7], v[16:17], v[82:83] op_sel:[0,0] op_sel_hi:[1,0]
  v_pk_fma_f32 v[8:9], v[16:17], v[82:83], v[6:7] op_sel:[1,1,0] op_sel_hi:[0,1,1] neg_lo:[0,1,0]
  ds_write_b64 v1, v[8:9] offset:15232
  v_pk_mul_f32 v[6:7], v[34:35], v[84:85] op_sel:[0,0] op_sel_hi:[1,0]
  v_pk_fma_f32 v[8:9], v[34:35], v[84:85], v[6:7] op_sel:[1,1,0] op_sel_hi:[0,1,1] neg_lo:[0,1,0]
  ds_write_b64 v1, v[8:9] offset:17408
  v_pk_mul_f32 v[6:7], v[12:13], v[86:87] op_sel:[0,0] op_sel_hi:[1,0]
  v_pk_fma_f32 v[8:9], v[12:13], v[86:87], v[6:7] op_sel:[1,1,0] op_sel_hi:[0,1,1] neg_lo:[0,1,0]
  ds_write_b64 v1, v[8:9] offset:19584
  v_pk_mul_f32 v[6:7], v[18:19], v[88:89] op_sel:[0,0] op_sel_hi:[1,0]
  v_pk_fma_f32 v[8:9], v[18:19], v[88:89], v[6:7] op_sel:[1,1,0] op_sel_hi:[0,1,1] neg_lo:[0,1,0]
  ds_write_b64 v1, v[8:9] offset:21760
  v_pk_mul_f32 v[6:7], v[20:21], v[90:91] op_sel:[0,0] op_sel_hi:[1,0]
  v_pk_fma_f32 v[8:9], v[20:21], v[90:91], v[6:7] op_sel:[1,1,0] op_sel_hi:[0,1,1] neg_lo:[0,1,0]
  ds_write_b64 v1, v[8:9] offset:23936
  v_pk_mul_f32 v[6:7], v[30:31], v[92:93] op_sel:[0,0] op_sel_hi:[1,0]
  v_pk_fma_f32 v[8:9], v[30:31], v[92:93], v[6:7] op_sel:[1,1,0] op_sel_hi:[0,1,1] neg_lo:[0,1,0]
  ds_write_b64 v1, v[8:9] offset:26112
  v_pk_mul_f32 v[6:7], v[38:39], v[94:95] op_sel:[0,0] op_sel_hi:[1,0]
  v_pk_fma_f32 v[8:9], v[38:39], v[94:95], v[6:7] op_sel:[1,1,0] op_sel_hi:[0,1,1] neg_lo:[0,1,0]
  ds_write_b64 v1, v[8:9] offset:28288
  v_pk_mul_f32 v[6:7], v[26:27], v[96:97] op_sel:[0,0] op_sel_hi:[1,0]
  v_pk_fma_f32 v[8:9], v[26:27], v[96:97], v[6:7] op_sel:[1,1,0] op_sel_hi:[0,1,1] neg_lo:[0,1,0]
  ds_write_b64 v1, v[8:9] offset:30464
  v_pk_mul_f32 v[6:7], v[36:37], v[98:99] op_sel:[0,0] op_sel_hi:[1,0]
  v_pk_fma_f32 v[8:9], v[36:37], v[98:99], v[6:7] op_sel:[1,1,0] op_sel_hi:[0,1,1] neg_lo:[0,1,0]
  ds_write_b64 v1, v[8:9] offset:32640
  s_waitcnt lgkmcnt(0)
  s_barrier
  ds_read_b64 v[6:7], v3 offset:0
  ds_read_b64 v[8:9], v3 offset:128
  ds_read_b64 v[10:11], v3 offset:256
  ds_read_b64 v[12:13], v3 offset:384
  ds_read_b64 v[14:15], v3 offset:512
  ds_read_b64 v[16:17], v3 offset:640
  ds_read_b64 v[18:19], v3 offset:768
  ds_read_b64 v[20:21], v3 offset:896
  ds_read_b64 v[22:23], v3 offset:1024
  ds_read_b64 v[24:25], v3 offset:1152
  ds_read_b64 v[26:27], v3 offset:1280
  ds_read_b64 v[28:29], v3 offset:1408
  ds_read_b64 v[30:31], v3 offset:1536
  ds_read_b64 v[32:33], v3 offset:1664
  ds_read_b64 v[34:35], v3 offset:1792
  ds_read_b64 v[36:37], v3 offset:1920
  s_waitcnt lgkmcnt(0)
  v_pk_add_f32 v[2:3], v[6:7], v[22:23]
  v_pk_add_f32 v[38:39], v[6:7], v[22:23] neg_lo:[0,1] neg_hi:[0,1]
  v_pk_add_f32 v[6:7], v[14:15], v[30:31]
  v_pk_add_f32 v[22:23], v[14:15], v[30:31] neg_lo:[0,1] neg_hi:[0,1]
  v_pk_add_f32 v[14:15], v[2:3], v[6:7]
  v_pk_add_f32 v[30:31], v[2:3], v[6:7] neg_lo:[0,1] neg_hi:[0,1]
  v_pk_add_f32 v[2:3], v[38:39], v[22:23] op_sel:[0,1] op_sel_hi:[1,0] neg_lo:[0,1]
  v_pk_add_f32 v[6:7], v[38:39], v[22:23] op_sel:[0,1] op_sel_hi:[1,0] neg_hi:[0,1]
  v_pk_add_f32 v[22:23], v[10:11], v[26:27]
  v_pk_add_f32 v[38:39], v[10:11], v[26:27] neg_lo:[0,1] neg_hi:[0,1]
  v_pk_add_f32 v[10:11], v[18:19], v[34:35]
  v_pk_add_f32 v[26:27], v[18:19], v[34:35] neg_lo:[0,1] neg_hi:[0,1]
  v_pk_add_f32 v[18:19], v[22:23], v[10:11]
  v_pk_add_f32 v[34:35], v[22:23], v[10:11] neg_lo:[0,1] neg_hi:[0,1]
  v_pk_add_f32 v[10:11], v[38:39], v[26:27] op_sel:[0,1] op_sel_hi:[1,0] neg_lo:[0,1]
  v_pk_add_f32 v[22:23], v[38:39], v[26:27] op_sel:[0,1] op_sel_hi:[1,0] neg_hi:[0,1]
  v_pk_add_f32 v[26:27], v[14:15], v[18:19]
  v_pk_add_f32 v[38:39], v[14:15], v[18:19] neg_lo:[0,1] neg_hi:[0,1]
  v_pk_mul_f32 v[14:15], v[10:11], s[72:73] op_sel:[0,0] op_sel_hi:[1,0]
  v_pk_fma_f32 v[18:19], v[10:11], s[72:73], v[14:15] op_sel:[1,1,0] op_sel_hi:[0,1,1] neg_lo:[0,1,0]
  v_pk_add_f32 v[10:11], v[2:3], v[18:19]
  v_pk_add_f32 v[14:15], v[2:3], v[18:19] neg_lo:[0,1] neg_hi:[0,1]
  v_pk_add_f32 v[2:3], v[30:31], v[34:35] op_sel:[0,1] op_sel_hi:[1,0] neg_lo:[0,1]
  v_pk_add_f32 v[18:19], v[30:31], v[34:35] op_sel:[0,1] op_sel_hi:[1,0] neg_hi:[0,1]
  v_pk_mul_f32 v[30:31], v[22:23], s[74:75] op_sel:[0,0] op_sel_hi:[1,0]
  v_pk_fma_f32 v[34:35], v[22:23], s[74:75], v[30:31] op_sel:[1,1,0] op_sel_hi:[0,1,1] neg_lo:[0,1,0]
  v_pk_add_f32 v[22:23], v[6:7], v[34:35]
  v_pk_add_f32 v[30:31], v[6:7], v[34:35] neg_lo:[0,1] neg_hi:[0,1]
  v_pk_add_f32 v[6:7], v[8:9], v[24:25]
  v_pk_add_f32 v[34:35], v[8:9], v[24:25] neg_lo:[0,1] neg_hi:[0,1]
  v_pk_add_f32 v[8:9], v[16:17], v[32:33]
  v_pk_add_f32 v[24:25], v[16:17], v[32:33] neg_lo:[0,1] neg_hi:[0,1]
  v_pk_add_f32 v[16:17], v[6:7], v[8:9]
  v_pk_add_f32 v[32:33], v[6:7], v[8:9] neg_lo:[0,1] neg_hi:[0,1]
  v_pk_add_f32 v[6:7], v[34:35], v[24:25] op_sel:[0,1] op_sel_hi:[1,0] neg_lo:[0,1]
  v_pk_add_f32 v[8:9], v[34:35], v[24:25] op_sel:[0,1] op_sel_hi:[1,0] neg_hi:[0,1]
  v_pk_add_f32 v[24:25], v[12:13], v[28:29]
  v_pk_add_f32 v[34:35], v[12:13], v[28:29] neg_lo:[0,1] neg_hi:[0,1]
  v_pk_add_f32 v[12:13], v[20:21], v[36:37]
  v_pk_add_f32 v[28:29], v[20:21], v[36:37] neg_lo:[0,1] neg_hi:[0,1]
  v_pk_add_f32 v[20:21], v[24:25], v[12:13]
  v_pk_add_f32 v[36:37], v[24:25], v[12:13] neg_lo:[0,1] neg_hi:[0,1]
  v_pk_add_f32 v[12:13], v[34:35], v[28:29] op_sel:[0,1] op_sel_hi:[1,0] neg_lo:[0,1]
  v_pk_add_f32 v[24:25], v[34:35], v[28:29] op_sel:[0,1] op_sel_hi:[1,0] neg_hi:[0,1]
  v_pk_add_f32 v[28:29], v[16:17], v[20:21]
  v_pk_add_f32 v[34:35], v[16:17], v[20:21] neg_lo:[0,1] neg_hi:[0,1]
  v_pk_mul_f32 v[16:17], v[12:13], s[72:73] op_sel:[0,0] op_sel_hi:[1,0]
  v_pk_fma_f32 v[20:21], v[12:13], s[72:73], v[16:17] op_sel:[1,1,0] op_sel_hi:[0,1,1] neg_lo:[0,1,0]
  v_pk_add_f32 v[12:13], v[6:7], v[20:21]
  v_pk_add_f32 v[16:17], v[6:7], v[20:21] neg_lo:[0,1] neg_hi:[0,1]
  v_pk_add_f32 v[6:7], v[32:33], v[36:37] op_sel:[0,1] op_sel_hi:[1,0] neg_lo:[0,1]
  v_pk_add_f32 v[20:21], v[32:33], v[36:37] op_sel:[0,1] op_sel_hi:[1,0] neg_hi:[0,1]
  v_pk_mul_f32 v[32:33], v[24:25], s[74:75] op_sel:[0,0] op_sel_hi:[1,0]
  v_pk_fma_f32 v[36:37], v[24:25], s[74:75], v[32:33] op_sel:[1,1,0] op_sel_hi:[0,1,1] neg_lo:[0,1,0]
  v_pk_add_f32 v[24:25], v[8:9], v[36:37]
  v_pk_add_f32 v[32:33], v[8:9], v[36:37] neg_lo:[0,1] neg_hi:[0,1]
  v_pk_add_f32 v[8:9], v[26:27], v[28:29]
  v_pk_add_f32 v[36:37], v[26:27], v[28:29] neg_lo:[0,1] neg_hi:[0,1]
  v_pk_mul_f32 v[26:27], v[12:13], s[76:77] op_sel:[0,0] op_sel_hi:[1,0]
  v_pk_fma_f32 v[28:29], v[12:13], s[76:77], v[26:27] op_sel:[1,1,0] op_sel_hi:[0,1,1] neg_lo:[0,1,0]
  v_pk_add_f32 v[12:13], v[10:11], v[28:29]
  v_pk_add_f32 v[26:27], v[10:11], v[28:29] neg_lo:[0,1] neg_hi:[0,1]
  v_pk_mul_f32 v[10:11], v[6:7], s[72:73] op_sel:[0,0] op_sel_hi:[1,0]
  v_pk_fma_f32 v[28:29], v[6:7], s[72:73], v[10:11] op_sel:[1,1,0] op_sel_hi:[0,1,1] neg_lo:[0,1,0]
  v_pk_add_f32 v[6:7], v[2:3], v[28:29]
  v_pk_add_f32 v[10:11], v[2:3], v[28:29] neg_lo:[0,1] neg_hi:[0,1]
  v_pk_mul_f32 v[2:3], v[24:25], s[78:79] op_sel:[0,0] op_sel_hi:[1,0]
  v_pk_fma_f32 v[28:29], v[24:25], s[78:79], v[2:3] op_sel:[1,1,0] op_sel_hi:[0,1,1] neg_lo:[0,1,0]
  v_pk_add_f32 v[2:3], v[22:23], v[28:29]
  v_pk_add_f32 v[24:25], v[22:23], v[28:29] neg_lo:[0,1] neg_hi:[0,1]
  v_pk_add_f32 v[22:23], v[38:39], v[34:35] op_sel:[0,1] op_sel_hi:[1,0] neg_lo:[0,1]
  v_pk_add_f32 v[28:29], v[38:39], v[34:35] op_sel:[0,1] op_sel_hi:[1,0] neg_hi:[0,1]
  v_pk_mul_f32 v[34:35], v[16:17], s[80:81] op_sel:[0,0] op_sel_hi:[1,0]
  v_pk_fma_f32 v[38:39], v[16:17], s[80:81], v[34:35] op_sel:[1,1,0] op_sel_hi:[0,1,1] neg_lo:[0,1,0]
  v_pk_add_f32 v[16:17], v[14:15], v[38:39]
  v_pk_add_f32 v[34:35], v[14:15], v[38:39] neg_lo:[0,1] neg_hi:[0,1]
  v_pk_mul_f32 v[14:15], v[20:21], s[74:75] op_sel:[0,0] op_sel_hi:[1,0]
  v_pk_fma_f32 v[38:39], v[20:21], s[74:75], v[14:15] op_sel:[1,1,0] op_sel_hi:[0,1,1] neg_lo:[0,1,0]
  v_pk_add_f32 v[14:15], v[18:19], v[38:39]
  v_pk_add_f32 v[20:21], v[18:19], v[38:39] neg_lo:[0,1] neg_hi:[0,1]
  v_pk_mul_f32 v[18:19], v[32:33], s[82:83] op_sel:[0,0] op_sel_hi:[1,0]
  v_pk_fma_f32 v[38:39], v[32:33], s[82:83], v[18:19] op_sel:[1,1,0] op_sel_hi:[0,1,1] neg_lo:[0,1,0]
  v_pk_add_f32 v[18:19], v[30:31], v[38:39]
  v_pk_add_f32 v[32:33], v[30:31], v[38:39] neg_lo:[0,1] neg_hi:[0,1]
  buffer_store_dwordx2 v[8:9], v4, s[12:15], s24 offen
  buffer_store_dwordx2 v[12:13], v4, s[12:15], s25 offen
  buffer_store_dwordx2 v[6:7], v4, s[12:15], s26 offen
  buffer_store_dwordx2 v[2:3], v4, s[12:15], s27 offen
  buffer_store_dwordx2 v[22:23], v4, s[12:15], s28 offen
  buffer_store_dwordx2 v[16:17], v4, s[12:15], s29 offen
  buffer_store_dwordx2 v[14:15], v4, s[12:15], s30 offen
  buffer_store_dwordx2 v[18:19], v4, s[12:15], s31 offen
  buffer_store_dwordx2 v[36:37], v4, s[12:15], s32 offen
  buffer_store_dwordx2 v[26:27], v4, s[12:15], s33 offen
  buffer_store_dwordx2 v[10:11], v4, s[12:15], s34 offen
  buffer_store_dwordx2 v[24:25], v4, s[12:15], s35 offen
  buffer_store_dwordx2 v[28:29], v4, s[12:15], s36 offen
  buffer_store_dwordx2 v[34:35], v4, s[12:15], s37 offen
  buffer_store_dwordx2 v[20:21], v4, s[12:15], s38 offen
  buffer_store_dwordx2 v[32:33], v4, s[12:15], s39 offen
  s_branch L_k2_done
L_k2_tr:
  s_cmp_ge_u32 s2, 708
  s_cbranch_scc1 L_k2_done
  s_load_dwordx2 s[4:5], s[0:1], 80
  s_load_dwordx2 s[6:7], s[0:1], 32
  s_load_dwordx2 s[8:9], s[0:1], 48
  s_sub_u32 s3, s2, 168
  v_lshrrev_b32 v1, 2, v0
  v_and_b32 v2, 3, v0
  v_lshlrev_b32 v3, 5, v2
  v_mul_u32_u24 v4, 2112, v2
  v_lshl_add_u32 v4, v1, 1, v4
  v_mul_u32_u24 v5, 132, v1
  v_add_u32 v5, v5, v3
  s_waitcnt lgkmcnt(0)
  s_mov_b32 s12, s6
  s_mov_b32 s13, s7
  s_mov_b32 s14, 2211840
  s_mov_b32 s15, 0x00020000
  s_mov_b32 s16, s8
  s_mov_b32 s17, s9
  s_mov_b32 s18, 2211840
  s_mov_b32 s19, 0x00020000
  s_add_u32 s20, s4, 6291456
  s_addc_u32 s21, s5, 0
  s_mov_b32 s22, 2211840
  s_mov_b32 s23, 0x00020000
  s_add_u32 s24, s4, 9437184
  s_addc_u32 s25, s5, 0
  s_mov_b32 s26, 2211840
  s_mov_b32 s27, 0x00020000
L_k2_trloop:
  s_cmp_lt_u32 s3, 270
  s_cbranch_scc0 L_k2_trB
  s_mul_i32 s30, s3, 2428
  s_lshr_b32 s30, s30, 16
  s_mul_i32 s31, s30, 27
  s_sub_u32 s31, s3, s31
  s_mul_i32 s32, s30, 221184
  s_lshl_b32 s33, s31, 7
  s_add_u32 s32, s32, s33
  s_mul_i32 s33, s31, 81920
  s_lshl_b32 s34, s30, 7
  s_add_u32 s33, s33, s34
  v_mul_u32_u24 v6, 3456, v1
  v_add_u32 v6, v6, v3
  v_mul_u32_u24 v7, 1280, v1
  v_add_u32 v7, v7, v3
  buffer_load_dwordx4 v[8:11], v6, s[12:15], s32 offen
  buffer_load_dwordx4 v[12:15], v6, s[12:15], s32 offen offset:16
  s_mov_b64 s[36:37], s[20:21]
  s_mov_b64 s[38:39], s[22:23]
  s_branch L_k2_trJ
L_k2_trB:
  s_sub_u32 s35, s3, 270
  s_mul_i32 s30, s35, 6554
  s_lshr_b32 s30, s30, 16
  s_mul_i32 s31, s30, 10
  s_sub_u32 s31, s35, s31
  s_mul_i32 s32, s30, 81920
  s_lshl_b32 s33, s31, 7
  s_add_u32 s32, s32, s33
  s_mul_i32 s33, s31, 221184
  s_lshl_b32 s34, s30, 7
  s_add_u32 s33, s33, s34
  v_mul_u32_u24 v6, 1280, v1
  v_add_u32 v6, v6, v3
  v_mul_u32_u24 v7, 3456, v1
  v_add_u32 v7, v7, v3
  buffer_load_dwordx4 v[8:11], v6, s[16:19], s32 offen
  buffer_load_dwordx4 v[12:15], v6, s[16:19], s32 offen offset:16
  s_mov_b64 s[36:37], s[24:25]
  s_mov_b64 s[38:39], s[26:27]
L_k2_trJ:
  s_waitcnt vmcnt(0)
  ds_write_b16 v4, v8 offset:0
  ds_write_b16_d16_hi v4, v8 offset:132
  ds_write_b16 v4, v9 offset:264
  ds_write_b16_d16_hi v4, v9 offset:396
  ds_write_b16 v4, v10 offset:528
  ds_write_b16_d16_hi v4, v10 offset:660
  ds_write_b16 v4, v11 offset:792
  ds_write_b16_d16_hi v4, v11 offset:924
  ds_write_b16 v4, v12 offset:1056
  ds_write_b16_d16_hi v4, v12 offset:1188
  ds_write_b16 v4, v13 offset:1320
  ds_write_b16_d16_hi v4, v13 offset:1452
  ds_write_b16 v4, v14 offset:1584
  ds_write_b16_d16_hi v4, v14 offset:1716
  ds_write_b16 v4, v15 offset:1848
  ds_write_b16_d16_hi v4, v15 offset:1980
  s_waitcnt lgkmcnt(0)
  s_barrier
  ds_read_b32 v16, v5 offset:0
  ds_read_b32 v17, v5 offset:4
  ds_read_b32 v18, v5 offset:8
  ds_read_b32 v19, v5 offset:12
  ds_read_b32 v20, v5 offset:16
  ds_read_b32 v21, v5 offset:20
  ds_read_b32 v22, v5 offset:24
  ds_read_b32 v23, v5 offset:28
  s_waitcnt lgkmcnt(0)
  buffer_store_dwordx4 v[16:19], v7, s[36:39], s33 offen
  buffer_store_dwordx4 v[20:23], v7, s[36:39], s33 offen offset:16
L_k2_done:
  s_endpgm
.globl k3_kernel
.p2align 8
.type k3_kernel,@function
k3_kernel:
  s_cmp_ge_u32 s2, 256
  s_cbranch_scc1 L_k3_done
  s_load_dwordx2 s[4:5], s[0:1], 80
  s_load_dwordx2 s[6:7], s[0:1], 0
  v_readfirstlane_b32 s24, v0
  s_lshr_b32 s24, s24, 6
  s_mov_b32 s40, 0x3f800000
  s_mov_b32 s41, 0xbf800000
  s_mov_b32 s42, 0x3f000000
  s_mov_b32 s43, 0x3f000000
  s_mov_b32 s44, 0x3e9e377a
  s_mov_b32 s45, 0x3e9e377a
  s_mov_b32 s46, 0xbf4f1bbd
  s_mov_b32 s47, 0xbf4f1bbd
  s_mov_b32 s48, 0x3f737871
  s_mov_b32 s49, 0x3f737871
  s_mov_b32 s50, 0x3f167918
  s_mov_b32 s51, 0x3f167918
  s_mov_b32 s52, 0xbf737871
  s_mov_b32 s53, 0xbf737871
  s_mov_b32 s54, 0x3f3504f3
  s_mov_b32 s55, 0x3f3504f3
  s_mov_b32 s56, 0xbf3504f3
  s_mov_b32 s57, 0x3f3504f3
  s_mov_b32 s58, 0x354ccccd
  s_mov_b32 s59, 0x354ccccd
  s_mov_b32 s60, 0x354ccccd
  s_mov_b32 s61, 0xb54ccccd
  s_waitcnt lgkmcnt(0)
  s_mov_b32 s8, s4
  s_mov_b32 s9, s5
  s_mov_b32 s10, 5505024
  s_mov_b32 s11, 0x00020000
  s_mov_b32 s12, s6
  s_mov_b32 s13, s7
  s_mov_b32 s14, 2621440
  s_mov_b32 s15, 0x00020000
  s_add_u32 s16, s4, 12582912
  s_addc_u32 s17, s5, 0
  s_mov_b32 s18, 2621440
  s_mov_b32 s19, 0x00020000
  s_add_u32 s20, s4, 15728640
  s_addc_u32 s21, s5, 0
  s_mov_b32 s22, 2621440
  s_mov_b32 s23, 0x00020000
  v_and_b32 v1, 63, v0
  v_lshlrev_b32 v2, 3, v1
  v_sub_u32 v3, 512, v2
  s_cmp_ge_u32 s24, 4
  s_cbranch_scc1 L_k3_skipA
  v_cvt_f32_u32 v4, v1
  v_mul_f32 v5, 0x3acccccd, v4
  v_cos_f32 v6, v5
  v_sin_f32 v7, v5
  v_mul_f32 v5, 0x3b4ccccd, v4
  v_cos_f32 v8, v5
  v_sin_f32 v9, v5
  v_mul_f32 v5, 0x3b99999a, v4
  v_cos_f32 v10, v5
  v_sin_f32 v11, v5
  v_mul_f32 v5, 0x3bcccccd, v4
  v_cos_f32 v12, v5
  v_sin_f32 v13, v5
  v_mul_f32 v5, 0x3c000000, v4
  v_cos_f32 v14, v5
  v_sin_f32 v15, v5
  v_mul_f32 v5, 0x3c19999a, v4
  v_cos_f32 v16, v5
  v_sin_f32 v17, v5
  v_mul_f32 v5, 0x3c333333, v4
  v_cos_f32 v18, v5
  v_sin_f32 v19, v5
  v_mul_f32 v5, 0x3c4ccccd, v4
  v_cos_f32 v20, v5
  v_sin_f32 v21, v5
  v_mul_f32 v5, 0x3c666666, v4
  v_cos_f32 v22, v5
  v_sin_f32 v23, v5
  v_cmp_eq_u32 vcc, 0, v1
  s_mov_b64 s[30:31], vcc
  s_cmp_eq_u32 s24, 0
  s_cbranch_scc1 L_k3_wave0
  s_lshl_b32 s25, s24, 8
  s_add_u32 s25, s25, s2
  s_mul_i32 s25, s25, 2688
  s_sub_u32 s26, 8, s24
  s_lshl_b32 s26, s26, 8
  s_add_u32 s26, s26, s2
  s_mul_i32 s26, s26, 2688
  s_mul_i32 s27, s2, s24
  s_sub_u32 s28, 8, s24
  s_mul_i32 s28, s2, s28
  buffer_load_dwordx2 v[4:5], v2, s[8:11], s25 offen offset:0
  buffer_load_dwordx2 v[24:25], v2, s[8:11], s25 offen offset:512
  buffer_load_dwordx2 v[26:27], v2, s[8:11], s25 offen offset:1024
  buffer_load_dwordx2 v[28:29], v2, s[8:11], s25 offen offset:1536
  buffer_load_dwordx2 v[30:31], v2, s[8:11], s25 offen offset:2048
  buffer_load_dwordx2 v[32:33], v3, s[8:11], s26 offen offset:2048
  buffer_load_dwordx2 v[34:35], v3, s[8:11], s26 offen offset:1536
  buffer_load_dwordx2 v[36:37], v3, s[8:11], s26 offen offset:1024
  buffer_load_dwordx2 v[38:39], v3, s[8:11], s26 offen offset:512
  buffer_load_dwordx2 v[40:41], v3, s[8:11], s26 offen offset:0
  v_mov_b32 v42, 0
  buffer_load_dwordx2 v[44:45], v42, s[8:11], s26 offen
  buffer_load_dwordx2 v[46:47], v42, s[8:11], s25 offen offset:2560
  v_cvt_f32_u32 v42, s27
  v_mul_f32 v42, 0x3a000000, v42
  v_cos_f32 v48, v42
  v_sin_f32 v49, v42
  v_cvt_f32_u32 v42, s28
  v_mul_f32 v42, 0x3a000000, v42
  v_cos_f32 v50, v42
  v_sin_f32 v51, v42
  s_waitcnt vmcnt(0)
  v_pk_mul_f32 v[42:43], v[4:5], v[48:49] op_sel:[0,0] op_sel_hi:[1,0]
  v_pk_fma_f32 v[52:53], v[4:5], v[48:49], v[42:43] op_sel:[1,1,0] op_sel_hi:[0,1,1] neg_lo:[0,1,0]
  v_pk_mul_f32 v[4:5], v[24:25], v[48:49] op_sel:[0,0] op_sel_hi:[1,0]
  v_pk_fma_f32 v[42:43], v[24:25], v[48:49], v[4:5] op_sel:[1,1,0] op_sel_hi:[0,1,1] neg_lo:[0,1,0]
  v_pk_mul_f32 v[4:5], v[26:27], v[48:49] op_sel:[0,0] op_sel_hi:[1,0]
  v_pk_fma_f32 v[24:25], v[26:27], v[48:49], v[4:5] op_sel:[1,1,0] op_sel_hi:[0,1,1] neg_lo:[0,1,0]
  v_pk_mul_f32 v[4:5], v[28:29], v[48:49] op_sel:[0,0] op_sel_hi:[1,0]
  v_pk_fma_f32 v[26:27], v[28:29], v[48:49], v[4:5] op_sel:[1,1,0] op_sel_hi:[0,1,1] neg_lo:[0,1,0]
  v_pk_mul_f32 v[4:5], v[30:31], v[48:49] op_sel:[0,0] op_sel_hi:[1,0]
  v_pk_fma_f32 v[28:29], v[30:31], v[48:49], v[4:5] op_sel:[1,1,0] op_sel_hi:[0,1,1] neg_lo:[0,1,0]
  v_pk_mul_f32 v[4:5], v[32:33], v[50:51] op_sel:[0,0] op_sel_hi:[1,0]
  v_pk_fma_f32 v[30:31], v[32:33], v[50:51], v[4:5] op_sel:[1,1,0] op_sel_hi:[0,1,1] neg_lo:[0,1,0]
  v_pk_mul_f32 v[4:5], v[30:31], s[40:41]
  v_pk_mul_f32 v[30:31], v[34:35], v[50:51] op_sel:[0,0] op_sel_hi:[1,0]
  v_pk_fma_f32 v[32:33], v[34:35], v[50:51], v[30:31] op_sel:[1,1,0] op_sel_hi:[0,1,1] neg_lo:[0,1,0]
  v_pk_mul_f32 v[30:31], v[32:33], s[40:41]
  v_pk_mul_f32 v[32:33], v[36:37], v[50:51] op_sel:[0,0] op_sel_hi:[1,0]
  v_pk_fma_f32 v[34:35], v[36:37], v[50:51], v[32:33] op_sel:[1,1,0] op_sel_hi:[0,1,1] neg_lo:[0,1,0]
  v_pk_mul_f32 v[32:33], v[34:35], s[40:41]
  v_pk_mul_f32 v[34:35], v[38:39], v[50:51] op_sel:[0,0] op_sel_hi:[1,0]
  v_pk_fma_f32 v[36:37], v[38:39], v[50:51], v[34:35] op_sel:[1,1,0] op_sel_hi:[0,1,1] neg_lo:[0,1,0]
  v_pk_mul_f32 v[34:35], v[36:37], s[40:41]
  v_pk_mul_f32 v[36:37], v[40:41], v[50:51] op_sel:[0,0] op_sel_hi:[1,0]
  v_pk_fma_f32 v[38:39], v[40:41], v[50:51], v[36:37] op_sel:[1,1,0] op_sel_hi:[0,1,1] neg_lo:[0,1,0]
  v_pk_mul_f32 v[36:37], v[38:39], s[40:41]
  v_pk_mul_f32 v[38:39], v[44:45], v[50:51] op_sel:[0,0] op_sel_hi:[1,0]
  v_pk_fma_f32 v[40:41], v[44:45], v[50:51], v[38:39] op_sel:[1,1,0] op_sel_hi:[0,1,1] neg_lo:[0,1,0]
  v_pk_mul_f32 v[40:41], v[40:41], s[40:41]
  v_pk_mul_f32 v[38:39], v[46:47], v[48:49] op_sel:[0,0] op_sel_hi:[1,0]
  v_pk_fma_f32 v[44:45], v[46:47], v[48:49], v[38:39] op_sel:[1,1,0] op_sel_hi:[0,1,1] neg_lo:[0,1,0]
  v_pk_add_f32 v[40:41], v[40:41], v[52:53]
  v_pk_mul_f32 v[40:41], v[40:41], s[42:43]
  v_cndmask_b32 v52, v52, v40, s[30:31]
  v_cndmask_b32 v53, v53, v41, s[30:31]
  v_pk_add_f32 v[44:45], v[44:45], v[4:5]
  v_pk_mul_f32 v[44:45], v[44:45], s[42:43]
  v_cndmask_b32 v4, v4, v44, s[30:31]
  v_cndmask_b32 v5, v5, v45, s[30:31]
  s_branch L_k3_joinA
L_k3_wave0:
  s_mul_i32 s25, s2, 2688
  s_add_u32 s26, s2, 1024
  s_mul_i32 s26, s26, 2688
  buffer_load_dwordx2 v[38:39], v2, s[8:11], s25 offen offset:0
  buffer_load_dwordx2 v[40:41], v2, s[8:11], s26 offen offset:0
  buffer_load_dwordx2 v[44:45], v2, s[8:11], s25 offen offset:512
  buffer_load_dwordx2 v[46:47], v2, s[8:11], s26 offen offset:512
  buffer_load_dwordx2 v[48:49], v2, s[8:11], s25 offen offset:1024
  buffer_load_dwordx2 v[50:51], v2, s[8:11], s26 offen offset:1024
  buffer_load_dwordx2 v[54:55], v2, s[8:11], s25 offen offset:1536
  buffer_load_dwordx2 v[56:57], v2, s[8:11], s26 offen offset:1536
  buffer_load_dwordx2 v[58:59], v2, s[8:11], s25 offen offset:2048
  buffer_load_dwordx2 v[60:61], v2, s[8:11], s26 offen offset:2048
  buffer_load_dwordx2 v[62:63], v3, s[8:11], s25 offen offset:2048
  buffer_load_dwordx2 v[64:65], v3, s[8:11], s26 offen offset:2048
  buffer_load_dwordx2 v[66:67], v3, s[8:11], s25 offen offset:1536
  buffer_load_dwordx2 v[68:69], v3, s[8:11], s26 offen offset:1536
  buffer_load_dwordx2 v[70:71], v3, s[8:11], s25 offen offset:1024
  buffer_load_dwordx2 v[72:73], v3, s[8:11], s26 offen offset:1024
  buffer_load_dwordx2 v[74:75], v3, s[8:11], s25 offen offset:512
  buffer_load_dwordx2 v[76:77], v3, s[8:11], s26 offen offset:512
  buffer_load_dwordx2 v[78:79], v3, s[8:11], s25 offen offset:0
  buffer_load_dwordx2 v[80:81], v3, s[8:11], s26 offen offset:0
  v_cvt_f32_u32 v3, s2
  v_mul_f32 v3, 0x3b000000, v3
  v_cos_f32 v82, v3
  v_sin_f32 v83, v3
  s_waitcnt vmcnt(0)
  v_pk_mul_f32 v[84:85], v[40:41], v[82:83] op_sel:[0,0] op_sel_hi:[1,0]
  v_pk_fma_f32 v[86:87], v[40:41], v[82:83], v[84:85] op_sel:[1,1,0] op_sel_hi:[0,1,1] neg_lo:[0,1,0]
  v_cndmask_b32 v39, v39, 0, s[30:31]
  v_cndmask_b32 v87, v87, 0, s[30:31]
  v_pk_add_f32 v[52:53], v[38:39], v[86:87] op_sel:[0,1] op_sel_hi:[1,0] neg_lo:[0,1]
  v_pk_mul_f32 v[38:39], v[46:47], v[82:83] op_sel:[0,0] op_sel_hi:[1,0]
  v_pk_fma_f32 v[40:41], v[46:47], v[82:83], v[38:39] op_sel:[1,1,0] op_sel_hi:[0,1,1] neg_lo:[0,1,0]
  v_pk_add_f32 v[42:43], v[44:45], v[40:41] op_sel:[0,1] op_sel_hi:[1,0] neg_lo:[0,1]
  v_pk_mul_f32 v[38:39], v[50:51], v[82:83] op_sel:[0,0] op_sel_hi:[1,0]
  v_pk_fma_f32 v[40:41], v[50:51], v[82:83], v[38:39] op_sel:[1,1,0] op_sel_hi:[0,1,1] neg_lo:[0,1,0]
  v_pk_add_f32 v[24:25], v[48:49], v[40:41] op_sel:[0,1] op_sel_hi:[1,0] neg_lo:[0,1]
  v_pk_mul_f32 v[38:39], v[56:57], v[82:83] op_sel:[0,0] op_sel_hi:[1,0]
  v_pk_fma_f32 v[40:41], v[56:57], v[82:83], v[38:39] op_sel:[1,1,0] op_sel_hi:[0,1,1] neg_lo:[0,1,0]
  v_pk_add_f32 v[26:27], v[54:55], v[40:41] op_sel:[0,1] op_sel_hi:[1,0] neg_lo:[0,1]
  v_pk_mul_f32 v[38:39], v[60:61], v[82:83] op_sel:[0,0] op_sel_hi:[1,0]
  v_pk_fma_f32 v[40:41], v[60:61], v[82:83], v[38:39] op_sel:[1,1,0] op_sel_hi:[0,1,1] neg_lo:[0,1,0]
  v_pk_add_f32 v[28:29], v[58:59], v[40:41] op_sel:[0,1] op_sel_hi:[1,0] neg_lo:[0,1]
  v_pk_mul_f32 v[38:39], v[64:65], v[82:83] op_sel:[0,0] op_sel_hi:[1,0]
  v_pk_fma_f32 v[40:41], v[64:65], v[82:83], v[38:39] op_sel:[1,1,0] op_sel_hi:[0,1,1] neg_lo:[0,1,0]
  v_cndmask_b32 v63, v63, 0, s[30:31]
  v_cndmask_b32 v41, v41, 0, s[30:31]
  v_pk_add_f32 v[4:5], v[62:63], v[40:41] op_sel:[0,1] op_sel_hi:[1,0] neg_hi:[1,0]
  v_pk_mul_f32 v[38:39], v[68:69], v[82:83] op_sel:[0,0] op_sel_hi:[1,0]
  v_pk_fma_f32 v[40:41], v[68:69], v[82:83], v[38:39] op_sel:[1,1,0] op_sel_hi:[0,1,1] neg_lo:[0,1,0]
  v_pk_add_f32 v[30:31], v[66:67], v[40:41] op_sel:[0,1] op_sel_hi:[1,0] neg_hi:[1,0]
  v_pk_mul_f32 v[38:39], v[72:73], v[82:83] op_sel:[0,0] op_sel_hi:[1,0]
  v_pk_fma_f32 v[40:41], v[72:73], v[82:83], v[38:39] op_sel:[1,1,0] op_sel_hi:[0,1,1] neg_lo:[0,1,0]
  v_pk_add_f32 v[32:33], v[70:71], v[40:41] op_sel:[0,1] op_sel_hi:[1,0] neg_hi:[1,0]
  v_pk_mul_f32 v[38:39], v[76:77], v[82:83] op_sel:[0,0] op_sel_hi:[1,0]
  v_pk_fma_f32 v[40:41], v[76:77], v[82:83], v[38:39] op_sel:[1,1,0] op_sel_hi:[0,1,1] neg_lo:[0,1,0]
  v_pk_add_f32 v[34:35], v[74:75], v[40:41] op_sel:[0,1] op_sel_hi:[1,0] neg_hi:[1,0]
  v_pk_mul_f32 v[38:39], v[80:81], v[82:83] op_sel:[0,0] op_sel_hi:[1,0]
  v_pk_fma_f32 v[40:41], v[80:81], v[82:83], v[38:39] op_sel:[1,1,0] op_sel_hi:[0,1,1] neg_lo:[0,1,0]
  v_pk_add_f32 v[36:37], v[78:79], v[40:41] op_sel:[0,1] op_sel_hi:[1,0] neg_hi:[1,0]
L_k3_joinA:
  v_pk_add_f32 v[38:39], v[52:53], v[4:5]
  v_pk_add_f32 v[40:41], v[52:53], v[4:5] neg_lo:[0,1] neg_hi:[0,1]
  v_pk_add_f32 v[4:5], v[24:25], v[32:33]
  v_pk_add_f32 v[44:45], v[24:25], v[32:33] neg_lo:[0,1] neg_hi:[0,1]
  v_pk_add_f32 v[24:25], v[28:29], v[36:37]
  v_pk_add_f32 v[32:33], v[28:29], v[36:37] neg_lo:[0,1] neg_hi:[0,1]
  v_pk_add_f32 v[28:29], v[30:31], v[42:43]
  v_pk_add_f32 v[36:37], v[30:31], v[42:43] neg_lo:[0,1] neg_hi:[0,1]
  v_pk_add_f32 v[30:31], v[34:35], v[26:27]
  v_pk_add_f32 v[42:43], v[34:35], v[26:27] neg_lo:[0,1] neg_hi:[0,1]
  v_pk_add_f32 v[26:27], v[4:5], v[30:31]
  v_pk_add_f32 v[34:35], v[24:25], v[28:29]
  v_pk_add_f32 v[46:47], v[4:5], v[30:31] neg_lo:[0,1] neg_hi:[0,1]
  v_pk_add_f32 v[4:5], v[24:25], v[28:29] neg_lo:[0,1] neg_hi:[0,1]
  v_pk_add_f32 v[24:25], v[38:39], v[26:27]
  v_pk_add_f32 v[28:29], v[24:25], v[34:35]
  v_pk_fma_f32 v[24:25], v[26:27], s[44:45], v[38:39]
  v_pk_fma_f32 v[30:31], v[34:35], s[46:47], v[24:25]
  v_pk_fma_f32 v[24:25], v[26:27], s[46:47], v[38:39]
  v_pk_fma_f32 v[26:27], v[34:35], s[44:45], v[24:25]
  v_pk_mul_f32 v[24:25], v[46:47], s[48:49]
  v_pk_fma_f32 v[34:35], v[4:5], s[50:51], v[24:25]
  v_pk_mul_f32 v[24:25], v[46:47], s[50:51]
  v_pk_fma_f32 v[38:39], v[4:5], s[52:53], v[24:25]
  v_pk_add_f32 v[4:5], v[30:31], v[34:35] op_sel:[0,1] op_sel_hi:[1,0] neg_lo:[0,1]
  v_pk_add_f32 v[24:25], v[30:31], v[34:35] op_sel:[0,1] op_sel_hi:[1,0] neg_hi:[0,1]
  v_pk_add_f32 v[30:31], v[26:27], v[38:39] op_sel:[0,1] op_sel_hi:[1,0] neg_lo:[0,1]
  v_pk_add_f32 v[34:35], v[26:27], v[38:39] op_sel:[0,1] op_sel_hi:[1,0] neg_hi:[0,1]
  v_pk_add_f32 v[26:27], v[44:45], v[42:43]
  v_pk_add_f32 v[38:39], v[32:33], v[36:37]
  v_pk_add_f32 v[46:47], v[44:45], v[42:43] neg_lo:[0,1] neg_hi:[0,1]
  v_pk_add_f32 v[42:43], v[32:33], v[36:37] neg_lo:[0,1] neg_hi:[0,1]
  v_pk_add_f32 v[32:33], v[40:41], v[26:27]
  v_pk_add_f32 v[36:37], v[32:33], v[38:39]
  v_pk_fma_f32 v[32:33], v[26:27], s[44:45], v[40:41]
  v_pk_fma_f32 v[44:45], v[38:39], s[46:47], v[32:33]
  v_pk_fma_f32 v[32:33], v[26:27], s[46:47], v[40:41]
  v_pk_fma_f32 v[26:27], v[38:39], s[44:45], v[32:33]
  v_pk_mul_f32 v[32:33], v[46:47], s[48:49]
  v_pk_fma_f32 v[38:39], v[42:43], s[50:51], v[32:33]
  v_pk_mul_f32 v[32:33], v[46:47], s[50:51]
  v_pk_fma_f32 v[40:41], v[42:43], s[52:53], v[32:33]
  v_pk_add_f32 v[32:33], v[44:45], v[38:39] op_sel:[0,1] op_sel_hi:[1,0] neg_lo:[0,1]
  v_pk_add_f32 v[42:43], v[44:45], v[38:39] op_sel:[0,1] op_sel_hi:[1,0] neg_hi:[0,1]
  v_pk_add_f32 v[38:39], v[26:27], v[40:41] op_sel:[0,1] op_sel_hi:[1,0] neg_lo:[0,1]
  v_pk_add_f32 v[44:45], v[26:27], v[40:41] op_sel:[0,1] op_sel_hi:[1,0] neg_hi:[0,1]
  s_mul_i32 s29, s24, 5760
  v_add_u32 v3, s29, v2
  ds_write_b64 v3, v[28:29] offset:0
  v_pk_mul_f32 v[26:27], v[32:33], v[6:7] op_sel:[0,0] op_sel_hi:[1,0]
  v_pk_fma_f32 v[28:29], v[32:33], v[6:7], v[26:27] op_sel:[1,1,0] op_sel_hi:[0,1,1] neg_lo:[0,1,0]
  ds_write_b64 v3, v[28:29] offset:576
  v_pk_mul_f32 v[6:7], v[30:31], v[8:9] op_sel:[0,0] op_sel_hi:[1,0]
  v_pk_fma_f32 v[26:27], v[30:31], v[8:9], v[6:7] op_sel:[1,1,0] op_sel_hi:[0,1,1] neg_lo:[0,1,0]
  ds_write_b64 v3, v[26:27] offset:1152
  v_pk_mul_f32 v[6:7], v[44:45], v[10:11] op_sel:[0,0] op_sel_hi:[1,0]
  v_pk_fma_f32 v[8:9], v[44:45], v[10:11], v[6:7] op_sel:[1,1,0] op_sel_hi:[0,1,1] neg_lo:[0,1,0]
  ds_write_b64 v3, v[8:9] offset:1728
  v_pk_mul_f32 v[6:7], v[24:25], v[12:13] op_sel:[0,0] op_sel_hi:[1,0]
  v_pk_fma_f32 v[8:9], v[24:25], v[12:13], v[6:7] op_sel:[1,1,0] op_sel_hi:[0,1,1] neg_lo:[0,1,0]
  ds_write_b64 v3, v[8:9] offset:2304
  v_pk_mul_f32 v[6:7], v[36:37], v[14:15] op_sel:[0,0] op_sel_hi:[1,0]
  v_pk_fma_f32 v[8:9], v[36:37], v[14:15], v[6:7] op_sel:[1,1,0] op_sel_hi:[0,1,1] neg_lo:[0,1,0]
  ds_write_b64 v3, v[8:9] offset:2880
  v_pk_mul_f32 v[6:7], v[4:5], v[16:17] op_sel:[0,0] op_sel_hi:[1,0]
  v_pk_fma_f32 v[8:9], v[4:5], v[16:17], v[6:7] op_sel:[1,1,0] op_sel_hi:[0,1,1] neg_lo:[0,1,0]
  ds_write_b64 v3, v[8:9] offset:3456
  v_pk_mul_f32 v[4:5], v[38:39], v[18:19] op_sel:[0,0] op_sel_hi:[1,0]
  v_pk_fma_f32 v[6:7], v[38:39], v[18:19], v[4:5] op_sel:[1,1,0] op_sel_hi:[0,1,1] neg_lo:[0,1,0]
  ds_write_b64 v3, v[6:7] offset:4032
  v_pk_mul_f32 v[4:5], v[34:35], v[20:21] op_sel:[0,0] op_sel_hi:[1,0]
  v_pk_fma_f32 v[6:7], v[34:35], v[20:21], v[4:5] op_sel:[1,1,0] op_sel_hi:[0,1,1] neg_lo:[0,1,0]
  ds_write_b64 v3, v[6:7] offset:4608
  v_pk_mul_f32 v[4:5], v[42:43], v[22:23] op_sel:[0,0] op_sel_hi:[1,0]
  v_pk_fma_f32 v[6:7], v[42:43], v[22:23], v[4:5] op_sel:[1,1,0] op_sel_hi:[0,1,1] neg_lo:[0,1,0]
  ds_write_b64 v3, v[6:7] offset:5184
L_k3_skipA:
  v_mul_u32_u24 v2, 205, v0
  v_lshrrev_b32 v2, 14, v2
  v_mul_u32_u24 v3, 80, v2
  v_sub_u32 v4, v0, v3
  v_lshrrev_b32 v5, 3, v4
  v_and_b32 v6, 7, v4
  v_mul_u32_u24 v7, 205, v4
  v_lshrrev_b32 v7, 11, v7
  v_mul_u32_u24 v8, 10, v7
  v_sub_u32 v7, v4, v8
  v_cvt_f32_u32 v7, v6
  v_mul_f32 v8, 0x3c800000, v7
  v_cos_f32 v10, v8
  v_sin_f32 v11, v8
  v_mul_f32 v8, 0x3d000000, v7
  v_cos_f32 v12, v8
  v_sin_f32 v13, v8
  v_mul_f32 v8, 0x3d400000, v7
  v_cos_f32 v14, v8
  v_sin_f32 v15, v8
  v_mul_f32 v8, 0x3d800000, v7
  v_cos_f32 v16, v8
  v_sin_f32 v17, v8
  v_mul_f32 v8, 0x3da00000, v7
  v_cos_f32 v18, v8
  v_sin_f32 v19, v8
  v_mul_f32 v8, 0x3dc00000, v7
  v_cos_f32 v20, v8
  v_sin_f32 v21, v8
  v_mul_f32 v8, 0x3de00000, v7
  v_cos_f32 v22, v8
  v_sin_f32 v23, v8
  s_waitcnt lgkmcnt(0)
  s_barrier
  v_mul_u32_u24 v7, 10, v2
  v_add_u32 v7, v7, v5
  v_mul_u32_u24 v7, 72, v7
  v_add_lshl_u32 v8, v7, v6, 3
  ds_read_b64 v[24:25], v8 offset:0
  ds_read_b64 v[26:27], v8 offset:64
  ds_read_b64 v[28:29], v8 offset:128
  ds_read_b64 v[30:31], v8 offset:192
  ds_read_b64 v[32:33], v8 offset:256
  ds_read_b64 v[34:35], v8 offset:320
  ds_read_b64 v[36:37], v8 offset:384
  ds_read_b64 v[38:39], v8 offset:448
  s_waitcnt lgkmcnt(0)
  v_pk_add_f32 v[8:9], v[24:25], v[32:33]
  v_pk_add_f32 v[40:41], v[24:25], v[32:33] neg_lo:[0,1] neg_hi:[0,1]
  v_pk_add_f32 v[24:25], v[28:29], v[36:37]
  v_pk_add_f32 v[32:33], v[28:29], v[36:37] neg_lo:[0,1] neg_hi:[0,1]
  v_pk_add_f32 v[28:29], v[8:9], v[24:25]
  v_pk_add_f32 v[36:37], v[8:9], v[24:25] neg_lo:[0,1] neg_hi:[0,1]
  v_pk_add_f32 v[8:9], v[40:41], v[32:33] op_sel:[0,1] op_sel_hi:[1,0] neg_lo:[0,1]
  v_pk_add_f32 v[24:25], v[40:41], v[32:33] op_sel:[0,1] op_sel_hi:[1,0] neg_hi:[0,1]
  v_pk_add_f32 v[32:33], v[26:27], v[34:35]
  v_pk_add_f32 v[40:41], v[26:27], v[34:35] neg_lo:[0,1] neg_hi:[0,1]
  v_pk_add_f32 v[26:27], v[30:31], v[38:39]
  v_pk_add_f32 v[34:35], v[30:31], v[38:39] neg_lo:[0,1] neg_hi:[0,1]
  v_pk_add_f32 v[30:31], v[32:33], v[26:27]
  v_pk_add_f32 v[38:39], v[32:33], v[26:27] neg_lo:[0,1] neg_hi:[0,1]
  v_pk_add_f32 v[26:27], v[40:41], v[34:35] op_sel:[0,1] op_sel_hi:[1,0] neg_lo:[0,1]
  v_pk_add_f32 v[32:33], v[40:41], v[34:35] op_sel:[0,1] op_sel_hi:[1,0] neg_hi:[0,1]
  v_pk_add_f32 v[34:35], v[28:29], v[30:31]
  v_pk_add_f32 v[40:41], v[28:29], v[30:31] neg_lo:[0,1] neg_hi:[0,1]
  v_pk_mul_f32 v[28:29], v[26:27], s[54:55] op_sel:[0,0] op_sel_hi:[1,0]
  v_pk_fma_f32 v[30:31], v[26:27], s[54:55], v[28:29] op_sel:[1,1,0] op_sel_hi:[0,1,1] neg_lo:[0,1,0]
  v_pk_add_f32 v[26:27], v[8:9], v[30:31]
  v_pk_add_f32 v[28:29], v[8:9], v[30:31] neg_lo:[0,1] neg_hi:[0,1]
  v_pk_add_f32 v[8:9], v[36:37], v[38:39] op_sel:[0,1] op_sel_hi:[1,0] neg_lo:[0,1]
  v_pk_add_f32 v[30:31], v[36:37], v[38:39] op_sel:[0,1] op_sel_hi:[1,0] neg_hi:[0,1]
  v_pk_mul_f32 v[36:37], v[32:33], s[56:57] op_sel:[0,0] op_sel_hi:[1,0]
  v_pk_fma_f32 v[38:39], v[32:33], s[56:57], v[36:37] op_sel:[1,1,0] op_sel_hi:[0,1,1] neg_lo:[0,1,0]
  v_pk_add_f32 v[32:33], v[24:25], v[38:39]
  v_pk_add_f32 v[36:37], v[24:25], v[38:39] neg_lo:[0,1] neg_hi:[0,1]
  v_add_u32 v7, v3, v5
  v_mul_u32_u24 v7, 9, v7
  v_add_lshl_u32 v7, v7, v6, 3
  ds_write_b64 v7, v[34:35] offset:23040
  v_pk_mul_f32 v[24:25], v[26:27], v[10:11] op_sel:[0,0] op_sel_hi:[1,0]
  v_pk_fma_f32 v[34:35], v[26:27], v[10:11], v[24:25] op_sel:[1,1,0] op_sel_hi:[0,1,1] neg_lo:[0,1,0]
  ds_write_b64 v7, v[34:35] offset:23760
  v_pk_mul_f32 v[10:11], v[8:9], v[12:13] op_sel:[0,0] op_sel_hi:[1,0]
  v_pk_fma_f32 v[24:25], v[8:9], v[12:13], v[10:11] op_sel:[1,1,0] op_sel_hi:[0,1,1] neg_lo:[0,1,0]
  ds_write_b64 v7, v[24:25] offset:24480
  v_pk_mul_f32 v[8:9], v[32:33], v[14:15] op_sel:[0,0] op_sel_hi:[1,0]
  v_pk_fma_f32 v[10:11], v[32:33], v[14:15], v[8:9] op_sel:[1,1,0] op_sel_hi:[0,1,1] neg_lo:[0,1,0]
  ds_write_b64 v7, v[10:11] offset:25200
  v_pk_mul_f32 v[8:9], v[40:41], v[16:17] op_sel:[0,0] op_sel_hi:[1,0]
  v_pk_fma_f32 v[10:11], v[40:41], v[16:17], v[8:9] op_sel:[1,1,0] op_sel_hi:[0,1,1] neg_lo:[0,1,0]
  ds_write_b64 v7, v[10:11] offset:25920
  v_pk_mul_f32 v[8:9], v[28:29], v[18:19] op_sel:[0,0] op_sel_hi:[1,0]
  v_pk_fma_f32 v[10:11], v[28:29], v[18:19], v[8:9] op_sel:[1,1,0] op_sel_hi:[0,1,1] neg_lo:[0,1,0]
  ds_write_b64 v7, v[10:11] offset:26640
  v_pk_mul_f32 v[8:9], v[30:31], v[20:21] op_sel:[0,0] op_sel_hi:[1,0]
  v_pk_fma_f32 v[10:11], v[30:31], v[20:21], v[8:9] op_sel:[1,1,0] op_sel_hi:[0,1,1] neg_lo:[0,1,0]
  ds_write_b64 v7, v[10:11] offset:27360
  v_pk_mul_f32 v[8:9], v[36:37], v[22:23] op_sel:[0,0] op_sel_hi:[1,0]
  v_pk_fma_f32 v[10:11], v[36:37], v[22:23], v[8:9] op_sel:[1,1,0] op_sel_hi:[0,1,1] neg_lo:[0,1,0]
  ds_write_b64 v7, v[10:11] offset:28080
  s_waitcnt lgkmcnt(0)
  s_barrier
  v_mul_u32_u24 v3, 72, v0
  ds_read_b64 v[6:7], v3 offset:23040
  ds_read_b64 v[8:9], v3 offset:23048
  ds_read_b64 v[10:11], v3 offset:23056
  ds_read_b64 v[12:13], v3 offset:23064
  ds_read_b64 v[14:15], v3 offset:23072
  ds_read_b64 v[16:17], v3 offset:23080
  ds_read_b64 v[18:19], v3 offset:23088
  ds_read_b64 v[20:21], v3 offset:23096
  s_waitcnt lgkmcnt(0)
  v_pk_add_f32 v[22:23], v[6:7], v[14:15]
  v_pk_add_f32 v[24:25], v[6:7], v[14:15] neg_lo:[0,1] neg_hi:[0,1]
  v_pk_add_f32 v[6:7], v[10:11], v[18:19]
  v_pk_add_f32 v[14:15], v[10:11], v[18:19] neg_lo:[0,1] neg_hi:[0,1]
  v_pk_add_f32 v[10:11], v[22:23], v[6:7]
  v_pk_add_f32 v[18:19], v[22:23], v[6:7] neg_lo:[0,1] neg_hi:[0,1]
  v_pk_add_f32 v[6:7], v[24:25], v[14:15] op_sel:[0,1] op_sel_hi:[1,0] neg_lo:[0,1]
  v_pk_add_f32 v[22:23], v[24:25], v[14:15] op_sel:[0,1] op_sel_hi:[1,0] neg_hi:[0,1]
  v_pk_add_f32 v[14:15], v[8:9], v[16:17]
  v_pk_add_f32 v[24:25], v[8:9], v[16:17] neg_lo:[0,1] neg_hi:[0,1]
  v_pk_add_f32 v[8:9], v[12:13], v[20:21]
  v_pk_add_f32 v[16:17], v[12:13], v[20:21] neg_lo:[0,1] neg_hi:[0,1]
  v_pk_add_f32 v[12:13], v[14:15], v[8:9]
  v_pk_add_f32 v[20:21], v[14:15], v[8:9] neg_lo:[0,1] neg_hi:[0,1]
  v_pk_add_f32 v[8:9], v[24:25], v[16:17] op_sel:[0,1] op_sel_hi:[1,0] neg_lo:[0,1]
  v_pk_add_f32 v[14:15], v[24:25], v[16:17] op_sel:[0,1] op_sel_hi:[1,0] neg_hi:[0,1]
  v_pk_add_f32 v[16:17], v[10:11], v[12:13]
  v_pk_add_f32 v[24:25], v[10:11], v[12:13] neg_lo:[0,1] neg_hi:[0,1]
  v_pk_mul_f32 v[10:11], v[8:9], s[54:55] op_sel:[0,0] op_sel_hi:[1,0]
  v_pk_fma_f32 v[12:13], v[8:9], s[54:55], v[10:11] op_sel:[1,1,0] op_sel_hi:[0,1,1] neg_lo:[0,1,0]
  v_pk_add_f32 v[8:9], v[6:7], v[12:13]
  v_pk_add_f32 v[10:11], v[6:7], v[12:13] neg_lo:[0,1] neg_hi:[0,1]
  v_pk_add_f32 v[6:7], v[18:19], v[20:21] op_sel:[0,1] op_sel_hi:[1,0] neg_lo:[0,1]
  v_pk_add_f32 v[12:13], v[18:19], v[20:21] op_sel:[0,1] op_sel_hi:[1,0] neg_hi:[0,1]
  v_pk_mul_f32 v[18:19], v[14:15], s[56:57] op_sel:[0,0] op_sel_hi:[1,0]
  v_pk_fma_f32 v[20:21], v[14:15], s[56:57], v[18:19] op_sel:[1,1,0] op_sel_hi:[0,1,1] neg_lo:[0,1,0]
  v_pk_add_f32 v[14:15], v[22:23], v[20:21]
  v_pk_add_f32 v[18:19], v[22:23], v[20:21] neg_lo:[0,1] neg_hi:[0,1]
  v_mul_u32_u24 v3, 640, v2
  v_add_lshl_u32 v2, v3, v4, 3
  ds_write_b64 v2, v[16:17] offset:46080
  ds_write_b64 v2, v[8:9] offset:46720
  ds_write_b64 v2, v[6:7] offset:47360
  ds_write_b64 v2, v[14:15] offset:48000
  ds_write_b64 v2, v[24:25] offset:48640
  ds_write_b64 v2, v[10:11] offset:49280
  ds_write_b64 v2, v[12:13] offset:49920
  ds_write_b64 v2, v[18:19] offset:50560
  s_waitcnt lgkmcnt(0)
  s_barrier
  s_cmp_ge_u32 s24, 4
  s_cbranch_scc1 L_k3_done
  s_lshl_b32 s25, s24, 9
  s_add_u32 s25, s25, s2
  s_mul_i32 s25, s25, 1280
  s_add_u32 s26, s25, 327680
  v_lshlrev_b32 v2, 2, v1
  buffer_load_dword v3, v2, s[12:15], s25 offen offset:0
  buffer_load_dword v4, v2, s[12:15], s25 offen offset:256
  buffer_load_dword v5, v2, s[12:15], s25 offen offset:512
  buffer_load_dword v6, v2, s[12:15], s25 offen offset:768
  buffer_load_dword v7, v2, s[12:15], s25 offen offset:1024
  buffer_load_dword v8, v2, s[12:15], s26 offen offset:0
  buffer_load_dword v9, v2, s[12:15], s26 offen offset:256
  buffer_load_dword v10, v2, s[12:15], s26 offen offset:512
  buffer_load_dword v11, v2, s[12:15], s26 offen offset:768
  buffer_load_dword v12, v2, s[12:15], s26 offen offset:1024
  s_lshl_b32 s27, s24, 1
  v_cvt_f32_u32 v14, s27
  v_add_f32 v15, 1.0, v14
  v_mul_f32 v13, 0x3e000000, v14
  v_cos_f32 v16, v13
  v_sin_f32 v18, v13
  v_mul_f32 v16, 0x35cccccd, v16
  v_mul_f32 v18, 0xb5cccccd, v18
  v_mul_f32 v13, 0x3e000000, v15
  v_cos_f32 v17, v13
  v_sin_f32 v19, v13
  v_mul_f32 v17, 0x35cccccd, v17
  v_mul_f32 v19, 0xb5cccccd, v19
  v_mul_f32 v13, 0x3e800000, v14
  v_cos_f32 v20, v13
  v_sin_f32 v22, v13
  v_mul_f32 v20, 0x35cccccd, v20
  v_mul_f32 v22, 0xb5cccccd, v22
  v_mul_f32 v13, 0x3e800000, v15
  v_cos_f32 v21, v13
  v_sin_f32 v23, v13
  v_mul_f32 v21, 0x35cccccd, v21
  v_mul_f32 v23, 0xb5cccccd, v23
  v_mul_f32 v13, 0x3ec00000, v14
  v_cos_f32 v24, v13
  v_sin_f32 v26, v13
  v_mul_f32 v24, 0x35cccccd, v24
  v_mul_f32 v26, 0xb5cccccd, v26
  v_mul_f32 v13, 0x3ec00000, v15
  v_cos_f32 v25, v13
  v_sin_f32 v27, v13
  v_mul_f32 v25, 0x35cccccd, v25
  v_mul_f32 v27, 0xb5cccccd, v27
  v_lshlrev_b32 v13, 4, v1
  v_add_u32 v13, 46080, v13
  ds_read_b128 v[28:31], v13 offset:0
  ds_read_b128 v[32:35], v13 offset:5120
  ds_read_b128 v[36:39], v13 offset:10240
  ds_read_b128 v[40:43], v13 offset:15360
  s_waitcnt lgkmcnt(0)
  v_pk_mul_f32 v[14:15], v[28:29], s[58:59] op_sel:[0,0] op_sel_hi:[0,1]
  v_pk_fma_f32 v[14:15], v[28:29], s[60:61], v[14:15] op_sel:[1,0,0] op_sel_hi:[1,1,1]
  v_pk_fma_f32 v[14:15], v[32:33], v[16:17], v[14:15] op_sel:[0,0,0] op_sel_hi:[0,1,1]
  v_pk_fma_f32 v[14:15], v[32:33], v[18:19], v[14:15] op_sel:[1,0,0] op_sel_hi:[1,1,1]
  v_pk_fma_f32 v[14:15], v[36:37], v[20:21], v[14:15] op_sel:[0,0,0] op_sel_hi:[0,1,1]
  v_pk_fma_f32 v[14:15], v[36:37], v[22:23], v[14:15] op_sel:[1,0,0] op_sel_hi:[1,1,1]
  v_pk_fma_f32 v[14:15], v[40:41], v[24:25], v[14:15] op_sel:[0,0,0] op_sel_hi:[0,1,1]
  v_pk_fma_f32 v[14:15], v[40:41], v[26:27], v[14:15] op_sel:[1,0,0] op_sel_hi:[1,1,1]
  v_pk_mul_f32 v[44:45], v[30:31], s[58:59] op_sel:[0,0] op_sel_hi:[0,1]
  v_pk_fma_f32 v[44:45], v[30:31], s[60:61], v[44:45] op_sel:[1,0,0] op_sel_hi:[1,1,1]
  v_pk_fma_f32 v[44:45], v[34:35], v[16:17], v[44:45] op_sel:[0,0,0] op_sel_hi:[0,1,1]
  v_pk_fma_f32 v[44:45], v[34:35], v[18:19], v[44:45] op_sel:[1,0,0] op_sel_hi:[1,1,1]
  v_pk_fma_f32 v[44:45], v[38:39], v[20:21], v[44:45] op_sel:[0,0,0] op_sel_hi:[0,1,1]
  v_pk_fma_f32 v[44:45], v[38:39], v[22:23], v[44:45] op_sel:[1,0,0] op_sel_hi:[1,1,1]
  v_pk_fma_f32 v[44:45], v[42:43], v[24:25], v[44:45] op_sel:[0,0,0] op_sel_hi:[0,1,1]
  v_pk_fma_f32 v[44:45], v[42:43], v[26:27], v[44:45] op_sel:[1,0,0] op_sel_hi:[1,1,1]
  ds_read_b128 v[28:31], v13 offset:1024
  ds_read_b128 v[32:35], v13 offset:6144
  ds_read_b128 v[36:39], v13 offset:11264
  ds_read_b128 v[40:43], v13 offset:16384
  s_waitcnt lgkmcnt(0)
  v_pk_mul_f32 v[46:47], v[28:29], s[58:59] op_sel:[0,0] op_sel_hi:[0,1]
  v_pk_fma_f32 v[46:47], v[28:29], s[60:61], v[46:47] op_sel:[1,0,0] op_sel_hi:[1,1,1]
  v_pk_fma_f32 v[46:47], v[32:33], v[16:17], v[46:47] op_sel:[0,0,0] op_sel_hi:[0,1,1]
  v_pk_fma_f32 v[46:47], v[32:33], v[18:19], v[46:47] op_sel:[1,0,0] op_sel_hi:[1,1,1]
  v_pk_fma_f32 v[46:47], v[36:37], v[20:21], v[46:47] op_sel:[0,0,0] op_sel_hi:[0,1,1]
  v_pk_fma_f32 v[46:47], v[36:37], v[22:23], v[46:47] op_sel:[1,0,0] op_sel_hi:[1,1,1]
  v_pk_fma_f32 v[46:47], v[40:41], v[24:25], v[46:47] op_sel:[0,0,0] op_sel_hi:[0,1,1]
  v_pk_fma_f32 v[46:47], v[40:41], v[26:27], v[46:47] op_sel:[1,0,0] op_sel_hi:[1,1,1]
  v_pk_mul_f32 v[48:49], v[30:31], s[58:59] op_sel:[0,0] op_sel_hi:[0,1]
  v_pk_fma_f32 v[48:49], v[30:31], s[60:61], v[48:49] op_sel:[1,0,0] op_sel_hi:[1,1,1]
  v_pk_fma_f32 v[48:49], v[34:35], v[16:17], v[48:49] op_sel:[0,0,0] op_sel_hi:[0,1,1]
  v_pk_fma_f32 v[48:49], v[34:35], v[18:19], v[48:49] op_sel:[1,0,0] op_sel_hi:[1,1,1]
  v_pk_fma_f32 v[48:49], v[38:39], v[20:21], v[48:49] op_sel:[0,0,0] op_sel_hi:[0,1,1]
  v_pk_fma_f32 v[48:49], v[38:39], v[22:23], v[48:49] op_sel:[1,0,0] op_sel_hi:[1,1,1]
  v_pk_fma_f32 v[48:49], v[42:43], v[24:25], v[48:49] op_sel:[0,0,0] op_sel_hi:[0,1,1]
  v_pk_fma_f32 v[48:49], v[42:43], v[26:27], v[48:49] op_sel:[1,0,0] op_sel_hi:[1,1,1]
  ds_read_b128 v[28:31], v13 offset:2048
  ds_read_b128 v[32:35], v13 offset:7168
  ds_read_b128 v[36:39], v13 offset:12288
  ds_read_b128 v[40:43], v13 offset:17408
  s_waitcnt lgkmcnt(0)
  v_pk_mul_f32 v[50:51], v[28:29], s[58:59] op_sel:[0,0] op_sel_hi:[0,1]
  v_pk_fma_f32 v[50:51], v[28:29], s[60:61], v[50:51] op_sel:[1,0,0] op_sel_hi:[1,1,1]
  v_pk_fma_f32 v[50:51], v[32:33], v[16:17], v[50:51] op_sel:[0,0,0] op_sel_hi:[0,1,1]
  v_pk_fma_f32 v[50:51], v[32:33], v[18:19], v[50:51] op_sel:[1,0,0] op_sel_hi:[1,1,1]
  v_pk_fma_f32 v[50:51], v[36:37], v[20:21], v[50:51] op_sel:[0,0,0] op_sel_hi:[0,1,1]
  v_pk_fma_f32 v[50:51], v[36:37], v[22:23], v[50:51] op_sel:[1,0,0] op_sel_hi:[1,1,1]
  v_pk_fma_f32 v[50:51], v[40:41], v[24:25], v[50:51] op_sel:[0,0,0] op_sel_hi:[0,1,1]
  v_pk_fma_f32 v[50:51], v[40:41], v[26:27], v[50:51] op_sel:[1,0,0] op_sel_hi:[1,1,1]
  v_pk_mul_f32 v[52:53], v[30:31], s[58:59] op_sel:[0,0] op_sel_hi:[0,1]
  v_pk_fma_f32 v[52:53], v[30:31], s[60:61], v[52:53] op_sel:[1,0,0] op_sel_hi:[1,1,1]
  v_pk_fma_f32 v[52:53], v[34:35], v[16:17], v[52:53] op_sel:[0,0,0] op_sel_hi:[0,1,1]
  v_pk_fma_f32 v[52:53], v[34:35], v[18:19], v[52:53] op_sel:[1,0,0] op_sel_hi:[1,1,1]
  v_pk_fma_f32 v[52:53], v[38:39], v[20:21], v[52:53] op_sel:[0,0,0] op_sel_hi:[0,1,1]
  v_pk_fma_f32 v[52:53], v[38:39], v[22:23], v[52:53] op_sel:[1,0,0] op_sel_hi:[1,1,1]
  v_pk_fma_f32 v[52:53], v[42:43], v[24:25], v[52:53] op_sel:[0,0,0] op_sel_hi:[0,1,1]
  v_pk_fma_f32 v[52:53], v[42:43], v[26:27], v[52:53] op_sel:[1,0,0] op_sel_hi:[1,1,1]
  ds_read_b128 v[28:31], v13 offset:3072
  ds_read_b128 v[32:35], v13 offset:8192
  ds_read_b128 v[36:39], v13 offset:13312
  ds_read_b128 v[40:43], v13 offset:18432
  s_waitcnt lgkmcnt(0)
  v_pk_mul_f32 v[54:55], v[28:29], s[58:59] op_sel:[0,0] op_sel_hi:[0,1]
  v_pk_fma_f32 v[54:55], v[28:29], s[60:61], v[54:55] op_sel:[1,0,0] op_sel_hi:[1,1,1]
  v_pk_fma_f32 v[54:55], v[32:33], v[16:17], v[54:55] op_sel:[0,0,0] op_sel_hi:[0,1,1]
  v_pk_fma_f32 v[54:55], v[32:33], v[18:19], v[54:55] op_sel:[1,0,0] op_sel_hi:[1,1,1]
  v_pk_fma_f32 v[54:55], v[36:37], v[20:21], v[54:55] op_sel:[0,0,0] op_sel_hi:[0,1,1]
  v_pk_fma_f32 v[54:55], v[36:37], v[22:23], v[54:55] op_sel:[1,0,0] op_sel_hi:[1,1,1]
  v_pk_fma_f32 v[54:55], v[40:41], v[24:25], v[54:55] op_sel:[0,0,0] op_sel_hi:[0,1,1]
  v_pk_fma_f32 v[54:55], v[40:41], v[26:27], v[54:55] op_sel:[1,0,0] op_sel_hi:[1,1,1]
  v_pk_mul_f32 v[56:57], v[30:31], s[58:59] op_sel:[0,0] op_sel_hi:[0,1]
  v_pk_fma_f32 v[56:57], v[30:31], s[60:61], v[56:57] op_sel:[1,0,0] op_sel_hi:[1,1,1]
  v_pk_fma_f32 v[56:57], v[34:35], v[16:17], v[56:57] op_sel:[0,0,0] op_sel_hi:[0,1,1]
  v_pk_fma_f32 v[56:57], v[34:35], v[18:19], v[56:57] op_sel:[1,0,0] op_sel_hi:[1,1,1]
  v_pk_fma_f32 v[56:57], v[38:39], v[20:21], v[56:57] op_sel:[0,0,0] op_sel_hi:[0,1,1]
  v_pk_fma_f32 v[56:57], v[38:39], v[22:23], v[56:57] op_sel:[1,0,0] op_sel_hi:[1,1,1]
  v_pk_fma_f32 v[56:57], v[42:43], v[24:25], v[56:57] op_sel:[0,0,0] op_sel_hi:[0,1,1]
  v_pk_fma_f32 v[56:57], v[42:43], v[26:27], v[56:57] op_sel:[1,0,0] op_sel_hi:[1,1,1]
  ds_read_b128 v[28:31], v13 offset:4096
  ds_read_b128 v[32:35], v13 offset:9216
  ds_read_b128 v[36:39], v13 offset:14336
  ds_read_b128 v[40:43], v13 offset:19456
  s_waitcnt lgkmcnt(0)
  v_pk_mul_f32 v[58:59], v[28:29], s[58:59] op_sel:[0,0] op_sel_hi:[0,1]
  v_pk_fma_f32 v[58:59], v[28:29], s[60:61], v[58:59] op_sel:[1,0,0] op_sel_hi:[1,1,1]
  v_pk_fma_f32 v[58:59], v[32:33], v[16:17], v[58:59] op_sel:[0,0,0] op_sel_hi:[0,1,1]
  v_pk_fma_f32 v[58:59], v[32:33], v[18:19], v[58:59] op_sel:[1,0,0] op_sel_hi:[1,1,1]
  v_pk_fma_f32 v[58:59], v[36:37], v[20:21], v[58:59] op_sel:[0,0,0] op_sel_hi:[0,1,1]
  v_pk_fma_f32 v[58:59], v[36:37], v[22:23], v[58:59] op_sel:[1,0,0] op_sel_hi:[1,1,1]
  v_pk_fma_f32 v[58:59], v[40:41], v[24:25], v[58:59] op_sel:[0,0,0] op_sel_hi:[0,1,1]
  v_pk_fma_f32 v[58:59], v[40:41], v[26:27], v[58:59] op_sel:[1,0,0] op_sel_hi:[1,1,1]
  v_pk_mul_f32 v[60:61], v[30:31], s[58:59] op_sel:[0,0] op_sel_hi:[0,1]
  v_pk_fma_f32 v[60:61], v[30:31], s[60:61], v[60:61] op_sel:[1,0,0] op_sel_hi:[1,1,1]
  v_pk_fma_f32 v[60:61], v[34:35], v[16:17], v[60:61] op_sel:[0,0,0] op_sel_hi:[0,1,1]
  v_pk_fma_f32 v[60:61], v[34:35], v[18:19], v[60:61] op_sel:[1,0,0] op_sel_hi:[1,1,1]
  v_pk_fma_f32 v[60:61], v[38:39], v[20:21], v[60:61] op_sel:[0,0,0] op_sel_hi:[0,1,1]
  v_pk_fma_f32 v[60:61], v[38:39], v[22:23], v[60:61] op_sel:[1,0,0] op_sel_hi:[1,1,1]
  v_pk_fma_f32 v[60:61], v[42:43], v[24:25], v[60:61] op_sel:[0,0,0] op_sel_hi:[0,1,1]
  v_pk_fma_f32 v[60:61], v[42:43], v[26:27], v[60:61] op_sel:[1,0,0] op_sel_hi:[1,1,1]
  s_waitcnt vmcnt(0)
  v_cvt_pk_bf16_f32 v1, v14, v44
  v_lshlrev_b32 v13, 16, v1
  v_and_b32 v16, 0xffff0000, v1
  v_lshlrev_b32 v1, 16, v3
  v_and_b32 v17, 0xffff0000, v3
  v_add_f32 v18, v1, v13
  v_add_f32 v19, v17, v16
  v_cvt_pk_bf16_f32 v1, v18, v19
  buffer_store_dword v1, v2, s[16:19], s25 offen offset:0
  v_lshlrev_b32 v18, 16, v1
  v_and_b32 v19, 0xffff0000, v1
  v_cvt_pk_bf16_f32 v1, v46, v48
  v_lshlrev_b32 v3, 16, v1
  v_and_b32 v13, 0xffff0000, v1
  v_lshlrev_b32 v1, 16, v4
  v_and_b32 v16, 0xffff0000, v4
  v_add_f32 v20, v1, v3
  v_add_f32 v21, v16, v13
  v_cvt_pk_bf16_f32 v1, v20, v21
  buffer_store_dword v1, v2, s[16:19], s25 offen offset:256
  v_lshlrev_b32 v20, 16, v1
  v_and_b32 v21, 0xffff0000, v1
  v_cvt_pk_bf16_f32 v1, v50, v52
  v_lshlrev_b32 v3, 16, v1
  v_and_b32 v4, 0xffff0000, v1
  v_lshlrev_b32 v1, 16, v5
  v_and_b32 v13, 0xffff0000, v5
  v_add_f32 v16, v1, v3
  v_add_f32 v17, v13, v4
  v_cvt_pk_bf16_f32 v1, v16, v17
  buffer_store_dword v1, v2, s[16:19], s25 offen offset:512
  v_lshlrev_b32 v16, 16, v1
  v_and_b32 v17, 0xffff0000, v1
  v_cvt_pk_bf16_f32 v1, v54, v56
  v_lshlrev_b32 v3, 16, v1
  v_and_b32 v4, 0xffff0000, v1
  v_lshlrev_b32 v1, 16, v6
  v_and_b32 v5, 0xffff0000, v6
  v_add_f32 v22, v1, v3
  v_add_f32 v23, v5, v4
  v_cvt_pk_bf16_f32 v1, v22, v23
  buffer_store_dword v1, v2, s[16:19], s25 offen offset:768
  v_lshlrev_b32 v22, 16, v1
  v_and_b32 v23, 0xffff0000, v1
  v_cvt_pk_bf16_f32 v1, v58, v60
  v_lshlrev_b32 v3, 16, v1
  v_and_b32 v4, 0xffff0000, v1
  v_lshlrev_b32 v1, 16, v7
  v_and_b32 v5, 0xffff0000, v7
  v_add_f32 v6, v1, v3
  v_add_f32 v7, v5, v4
  v_cvt_pk_bf16_f32 v1, v6, v7
  buffer_store_dword v1, v2, s[16:19], s25 offen offset:1024
  v_lshlrev_b32 v6, 16, v1
  v_and_b32 v7, 0xffff0000, v1
  v_cvt_pk_bf16_f32 v1, v15, v45
  v_lshlrev_b32 v3, 16, v1
  v_and_b32 v4, 0xffff0000, v1
  v_lshlrev_b32 v1, 16, v8
  v_and_b32 v5, 0xffff0000, v8
  v_add_f32 v14, v1, v3
  v_add_f32 v15, v5, v4
  v_cvt_pk_bf16_f32 v1, v14, v15
  buffer_store_dword v1, v2, s[16:19], s26 offen offset:0
  v_lshlrev_b32 v14, 16, v1
  v_and_b32 v15, 0xffff0000, v1
  v_cvt_pk_bf16_f32 v1, v47, v49
  v_lshlrev_b32 v3, 16, v1
  v_and_b32 v4, 0xffff0000, v1
  v_lshlrev_b32 v1, 16, v9
  v_and_b32 v5, 0xffff0000, v9
  v_add_f32 v8, v1, v3
  v_add_f32 v9, v5, v4
  v_cvt_pk_bf16_f32 v1, v8, v9
  buffer_store_dword v1, v2, s[16:19], s26 offen offset:256
  v_lshlrev_b32 v8, 16, v1
  v_and_b32 v9, 0xffff0000, v1
  v_cvt_pk_bf16_f32 v1, v51, v53
  v_lshlrev_b32 v3, 16, v1
  v_and_b32 v4, 0xffff0000, v1
  v_lshlrev_b32 v1, 16, v10
  v_and_b32 v5, 0xffff0000, v10
  v_add_f32 v24, v1, v3
  v_add_f32 v25, v5, v4
  v_cvt_pk_bf16_f32 v1, v24, v25
  buffer_store_dword v1, v2, s[16:19], s26 offen offset:512
  v_lshlrev_b32 v24, 16, v1
  v_and_b32 v25, 0xffff0000, v1
  v_cvt_pk_bf16_f32 v1, v55, v57
  v_lshlrev_b32 v3, 16, v1
  v_and_b32 v4, 0xffff0000, v1
  v_lshlrev_b32 v1, 16, v11
  v_and_b32 v5, 0xffff0000, v11
  v_add_f32 v10, v1, v3
  v_add_f32 v11, v5, v4
  v_cvt_pk_bf16_f32 v1, v10, v11
  buffer_store_dword v1, v2, s[16:19], s26 offen offset:768
  v_lshlrev_b32 v10, 16, v1
  v_and_b32 v11, 0xffff0000, v1
  v_cvt_pk_bf16_f32 v1, v59, v61
  v_lshlrev_b32 v3, 16, v1
  v_and_b32 v4, 0xffff0000, v1
  v_lshlrev_b32 v1, 16, v12
  v_and_b32 v5, 0xffff0000, v12
  v_add_f32 v12, v1, v3
  v_add_f32 v13, v5, v4
  v_cvt_pk_bf16_f32 v1, v12, v13
  buffer_store_dword v1, v2, s[16:19], s26 offen offset:1024
  v_lshlrev_b32 v12, 16, v1
  v_and_b32 v13, 0xffff0000, v1
  v_add_f32 v1, v18, v19
  v_add_f32 v3, v20, v21
  v_add_f32 v4, v16, v17
  v_add_f32 v5, v22, v23
  v_add_f32 v26, v6, v7
  v_add_f32 v27, v1, v3
  v_add_f32 v1, v4, v5
  v_add_f32 v3, v27, v1
  v_add_f32 v1, v3, v26
  v_add_f32 v3, v14, v15
  v_add_f32 v4, v8, v9
  v_add_f32 v5, v24, v25
  v_add_f32 v26, v10, v11
  v_add_f32 v27, v12, v13
  v_add_f32 v28, v3, v4
  v_add_f32 v3, v5, v26
  v_add_f32 v4, v28, v3
  v_add_f32 v3, v4, v27
  v_add_f32_dpp v1, v1, v1 quad_perm:[1,0,3,2] row_mask:0xf bank_mask:0xf
  s_nop 0
  v_add_f32_dpp v3, v3, v3 quad_perm:[1,0,3,2] row_mask:0xf bank_mask:0xf
  v_add_f32_dpp v1, v1, v1 quad_perm:[2,3,0,1] row_mask:0xf bank_mask:0xf
  s_nop 0
  v_add_f32_dpp v3, v3, v3 quad_perm:[2,3,0,1] row_mask:0xf bank_mask:0xf
  v_add_f32_dpp v1, v1, v1 row_half_mirror row_mask:0xf bank_mask:0xf
  s_nop 0
  v_add_f32_dpp v3, v3, v3 row_half_mirror row_mask:0xf bank_mask:0xf
  v_add_f32_dpp v1, v1, v1 row_mirror row_mask:0xf bank_mask:0xf
  s_nop 0
  v_add_f32_dpp v3, v3, v3 row_mirror row_mask:0xf bank_mask:0xf
  v_add_f32_dpp v1, v1, v1 row_bcast:15 row_mask:0xa bank_mask:0xf
  s_nop 0
  v_add_f32_dpp v3, v3, v3 row_bcast:15 row_mask:0xa bank_mask:0xf
  v_add_f32_dpp v1, v1, v1 row_bcast:31 row_mask:0xc bank_mask:0xf
  s_nop 0
  v_add_f32_dpp v3, v3, v3 row_bcast:31 row_mask:0xc bank_mask:0xf
  v_readlane_b32 s28, v1, 63
  v_readlane_b32 s29, v3, 63
  s_nop 0
  v_mov_b32 v1, s28
  v_mul_f32 v1, 0x3acccccd, v1
  v_mov_b32 v3, s29
  v_mul_f32 v3, 0x3acccccd, v3
  v_sub_f32 v4, v18, v1
  v_mul_f32 v5, v4, v4
  v_sub_f32 v4, v19, v1
  v_fma_f32 v5, v4, v4, v5
  v_sub_f32 v4, v20, v1
  v_fma_f32 v5, v4, v4, v5
  v_sub_f32 v4, v21, v1
  v_fma_f32 v5, v4, v4, v5
  v_sub_f32 v4, v16, v1
  v_fma_f32 v5, v4, v4, v5
  v_sub_f32 v4, v17, v1
  v_fma_f32 v5, v4, v4, v5
  v_sub_f32 v4, v22, v1
  v_fma_f32 v5, v4, v4, v5
  v_sub_f32 v4, v23, v1
  v_fma_f32 v5, v4, v4, v5
  v_sub_f32 v4, v6, v1
  v_fma_f32 v5, v4, v4, v5
  v_sub_f32 v4, v7, v1
  v_fma_f32 v5, v4, v4, v5
  v_sub_f32 v4, v14, v3
  v_mul_f32 v26, v4, v4
  v_sub_f32 v4, v15, v3
  v_fma_f32 v26, v4, v4, v26
  v_sub_f32 v4, v8, v3
  v_fma_f32 v26, v4, v4, v26
  v_sub_f32 v4, v9, v3
  v_fma_f32 v26, v4, v4, v26
  v_sub_f32 v4, v24, v3
  v_fma_f32 v26, v4, v4, v26
  v_sub_f32 v4, v25, v3
  v_fma_f32 v26, v4, v4, v26
  v_sub_f32 v4, v10, v3
  v_fma_f32 v26, v4, v4, v26
  v_sub_f32 v4, v11, v3
  v_fma_f32 v26, v4, v4, v26
  v_sub_f32 v4, v12, v3
  v_fma_f32 v26, v4, v4, v26
  v_sub_f32 v4, v13, v3
  v_fma_f32 v26, v4, v4, v26
  v_add_f32_dpp v5, v5, v5 quad_perm:[1,0,3,2] row_mask:0xf bank_mask:0xf
  s_nop 0
  v_add_f32_dpp v26, v26, v26 quad_perm:[1,0,3,2] row_mask:0xf bank_mask:0xf
  v_add_f32_dpp v5, v5, v5 quad_perm:[2,3,0,1] row_mask:0xf bank_mask:0xf
  s_nop 0
  v_add_f32_dpp v26, v26, v26 quad_perm:[2,3,0,1] row_mask:0xf bank_mask:0xf
  v_add_f32_dpp v5, v5, v5 row_half_mirror row_mask:0xf bank_mask:0xf
  s_nop 0
  v_add_f32_dpp v26, v26, v26 row_half_mirror row_mask:0xf bank_mask:0xf
  v_add_f32_dpp v5, v5, v5 row_mirror row_mask:0xf bank_mask:0xf
  s_nop 0
  v_add_f32_dpp v26, v26, v26 row_mirror row_mask:0xf bank_mask:0xf
  v_add_f32_dpp v5, v5, v5 row_bcast:15 row_mask:0xa bank_mask:0xf
  s_nop 0
  v_add_f32_dpp v26, v26, v26 row_bcast:15 row_mask:0xa bank_mask:0xf
  v_add_f32_dpp v5, v5, v5 row_bcast:31 row_mask:0xc bank_mask:0xf
  s_nop 0
  v_add_f32_dpp v26, v26, v26 row_bcast:31 row_mask:0xc bank_mask:0xf
  v_readlane_b32 s28, v5, 63
  v_readlane_b32 s29, v26, 63
  s_nop 0
  v_mov_b32 v4, s28
  v_mul_f32 v4, 0x3acccccd, v4
  v_cvt_pk_bf16_f32 v5, v4, v1
  v_lshlrev_b32 v4, 16, v5
  v_and_b32 v1, 0xffff0000, v5
  v_add_f32 v4, 0x3727c5ac, v4
  v_cvt_pk_bf16_f32 v5, v4, v4
  v_lshlrev_b32 v4, 16, v5
  v_sqrt_f32 v4, v4
  s_nop 0
  v_cvt_pk_bf16_f32 v5, v4, v4
  v_lshlrev_b32 v4, 16, v5
  v_rcp_f32 v5, v4
  s_nop 0
  v_fma_f32 v26, -v4, v5, 1.0
  v_fma_f32 v5, v26, v5, v5
  v_sub_f32 v18, v18, v1
  v_sub_f32 v19, v19, v1
  v_cvt_pk_bf16_f32 v4, v18, v19
  v_lshlrev_b32 v18, 16, v4
  v_and_b32 v19, 0xffff0000, v4
  v_mul_f32 v18, v18, v5
  v_mul_f32 v19, v19, v5
  v_cvt_pk_bf16_f32 v4, v18, v19
  v_lshlrev_b32 v18, 16, v4
  v_and_b32 v19, 0xffff0000, v4
  v_sub_f32 v20, v20, v1
  v_sub_f32 v21, v21, v1
  v_cvt_pk_bf16_f32 v4, v20, v21
  v_lshlrev_b32 v20, 16, v4
  v_and_b32 v21, 0xffff0000, v4
  v_mul_f32 v20, v20, v5
  v_mul_f32 v21, v21, v5
  v_cvt_pk_bf16_f32 v4, v20, v21
  v_lshlrev_b32 v20, 16, v4
  v_and_b32 v21, 0xffff0000, v4
  v_sub_f32 v16, v16, v1
  v_sub_f32 v17, v17, v1
  v_cvt_pk_bf16_f32 v4, v16, v17
  v_lshlrev_b32 v16, 16, v4
  v_and_b32 v17, 0xffff0000, v4
  v_mul_f32 v16, v16, v5
  v_mul_f32 v17, v17, v5
  v_cvt_pk_bf16_f32 v4, v16, v17
  v_lshlrev_b32 v16, 16, v4
  v_and_b32 v17, 0xffff0000, v4
  v_sub_f32 v22, v22, v1
  v_sub_f32 v23, v23, v1
  v_cvt_pk_bf16_f32 v4, v22, v23
  v_lshlrev_b32 v22, 16, v4
  v_and_b32 v23, 0xffff0000, v4
  v_mul_f32 v22, v22, v5
  v_mul_f32 v23, v23, v5
  v_cvt_pk_bf16_f32 v4, v22, v23
  v_lshlrev_b32 v22, 16, v4
  v_and_b32 v23, 0xffff0000, v4
  v_sub_f32 v6, v6, v1
  v_sub_f32 v7, v7, v1
  v_cvt_pk_bf16_f32 v1, v6, v7
  v_lshlrev_b32 v6, 16, v1
  v_and_b32 v7, 0xffff0000, v1
  v_mul_f32 v6, v6, v5
  v_mul_f32 v7, v7, v5
  v_cvt_pk_bf16_f32 v1, v6, v7
  v_lshlrev_b32 v6, 16, v1
  v_and_b32 v7, 0xffff0000, v1
  v_mov_b32 v1, s29
  v_mul_f32 v1, 0x3acccccd, v1
  v_cvt_pk_bf16_f32 v4, v1, v3
  v_lshlrev_b32 v1, 16, v4
  v_and_b32 v3, 0xffff0000, v4
  v_add_f32 v1, 0x3727c5ac, v1
  v_cvt_pk_bf16_f32 v4, v1, v1
  v_lshlrev_b32 v1, 16, v4
  v_sqrt_f32 v1, v1
  s_nop 0
  v_cvt_pk_bf16_f32 v4, v1, v1
  v_lshlrev_b32 v1, 16, v4
  v_rcp_f32 v4, v1
  s_nop 0
  v_fma_f32 v5, -v1, v4, 1.0
  v_fma_f32 v4, v5, v4, v4
  v_sub_f32 v14, v14, v3
  v_sub_f32 v15, v15, v3
  v_cvt_pk_bf16_f32 v1, v14, v15
  v_lshlrev_b32 v14, 16, v1
  v_and_b32 v15, 0xffff0000, v1
  v_mul_f32 v14, v14, v4
  v_mul_f32 v15, v15, v4
  v_cvt_pk_bf16_f32 v1, v14, v15
  v_lshlrev_b32 v14, 16, v1
  v_and_b32 v15, 0xffff0000, v1
  v_sub_f32 v8, v8, v3
  v_sub_f32 v9, v9, v3
  v_cvt_pk_bf16_f32 v1, v8, v9
  v_lshlrev_b32 v8, 16, v1
  v_and_b32 v9, 0xffff0000, v1
  v_mul_f32 v8, v8, v4
  v_mul_f32 v9, v9, v4
  v_cvt_pk_bf16_f32 v1, v8, v9
  v_lshlrev_b32 v8, 16, v1
  v_and_b32 v9, 0xffff0000, v1
  v_sub_f32 v24, v24, v3
  v_sub_f32 v25, v25, v3
  v_cvt_pk_bf16_f32 v1, v24, v25
  v_lshlrev_b32 v24, 16, v1
  v_and_b32 v25, 0xffff0000, v1
  v_mul_f32 v24, v24, v4
  v_mul_f32 v25, v25, v4
  v_cvt_pk_bf16_f32 v1, v24, v25
  v_lshlrev_b32 v24, 16, v1
  v_and_b32 v25, 0xffff0000, v1
  v_sub_f32 v10, v10, v3
  v_sub_f32 v11, v11, v3
  v_cvt_pk_bf16_f32 v1, v10, v11
  v_lshlrev_b32 v10, 16, v1
  v_and_b32 v11, 0xffff0000, v1
  v_mul_f32 v10, v10, v4
  v_mul_f32 v11, v11, v4
  v_cvt_pk_bf16_f32 v1, v10, v11
  v_lshlrev_b32 v10, 16, v1
  v_and_b32 v11, 0xffff0000, v1
  v_sub_f32 v12, v12, v3
  v_sub_f32 v13, v13, v3
  v_cvt_pk_bf16_f32 v1, v12, v13
  v_lshlrev_b32 v12, 16, v1
  v_and_b32 v13, 0xffff0000, v1
  v_mul_f32 v12, v12, v4
  v_mul_f32 v13, v13, v4
  v_cvt_pk_bf16_f32 v1, v12, v13
  v_lshlrev_b32 v12, 16, v1
  v_and_b32 v13, 0xffff0000, v1
  v_add_f32 v1, v18, v19
  v_add_f32 v3, v20, v21
  v_add_f32 v4, v16, v17
  v_add_f32 v5, v22, v23
  v_add_f32 v26, v6, v7
  v_add_f32 v27, v1, v3
  v_add_f32 v1, v4, v5
  v_add_f32 v3, v27, v1
  v_add_f32 v1, v3, v26
  v_add_f32 v3, v14, v15
  v_add_f32 v4, v8, v9
  v_add_f32 v5, v24, v25
  v_add_f32 v26, v10, v11
  v_add_f32 v27, v12, v13
  v_add_f32 v28, v3, v4
  v_add_f32 v3, v5, v26
  v_add_f32 v4, v28, v3
  v_add_f32 v3, v4, v27
  v_add_f32_dpp v1, v1, v1 quad_perm:[1,0,3,2] row_mask:0xf bank_mask:0xf
  s_nop 0
  v_add_f32_dpp v3, v3, v3 quad_perm:[1,0,3,2] row_mask:0xf bank_mask:0xf
  v_add_f32_dpp v1, v1, v1 quad_perm:[2,3,0,1] row_mask:0xf bank_mask:0xf
  s_nop 0
  v_add_f32_dpp v3, v3, v3 quad_perm:[2,3,0,1] row_mask:0xf bank_mask:0xf
  v_add_f32_dpp v1, v1, v1 row_half_mirror row_mask:0xf bank_mask:0xf
  s_nop 0
  v_add_f32_dpp v3, v3, v3 row_half_mirror row_mask:0xf bank_mask:0xf
  v_add_f32_dpp v1, v1, v1 row_mirror row_mask:0xf bank_mask:0xf
  s_nop 0
  v_add_f32_dpp v3, v3, v3 row_mirror row_mask:0xf bank_mask:0xf
  v_add_f32_dpp v1, v1, v1 row_bcast:15 row_mask:0xa bank_mask:0xf
  s_nop 0
  v_add_f32_dpp v3, v3, v3 row_bcast:15 row_mask:0xa bank_mask:0xf
  v_add_f32_dpp v1, v1, v1 row_bcast:31 row_mask:0xc bank_mask:0xf
  s_nop 0
  v_add_f32_dpp v3, v3, v3 row_bcast:31 row_mask:0xc bank_mask:0xf
  v_readlane_b32 s28, v1, 63
  v_readlane_b32 s29, v3, 63
  s_nop 0
  v_mov_b32 v1, s28
  v_mul_f32 v1, 0x3acccccd, v1
  v_mov_b32 v3, s29
  v_mul_f32 v3, 0x3acccccd, v3
  v_sub_f32 v4, v18, v1
  v_mul_f32 v5, v4, v4
  v_sub_f32 v4, v19, v1
  v_fma_f32 v5, v4, v4, v5
  v_sub_f32 v4, v20, v1
  v_fma_f32 v5, v4, v4, v5
  v_sub_f32 v4, v21, v1
  v_fma_f32 v5, v4, v4, v5
  v_sub_f32 v4, v16, v1
  v_fma_f32 v5, v4, v4, v5
  v_sub_f32 v4, v17, v1
  v_fma_f32 v5, v4, v4, v5
  v_sub_f32 v4, v22, v1
  v_fma_f32 v5, v4, v4, v5
  v_sub_f32 v4, v23, v1
  v_fma_f32 v5, v4, v4, v5
  v_sub_f32 v4, v6, v1
  v_fma_f32 v5, v4, v4, v5
  v_sub_f32 v4, v7, v1
  v_fma_f32 v5, v4, v4, v5
  v_sub_f32 v4, v14, v3
  v_mul_f32 v26, v4, v4
  v_sub_f32 v4, v15, v3
  v_fma_f32 v26, v4, v4, v26
  v_sub_f32 v4, v8, v3
  v_fma_f32 v26, v4, v4, v26
  v_sub_f32 v4, v9, v3
  v_fma_f32 v26, v4, v4, v26
  v_sub_f32 v4, v24, v3
  v_fma_f32 v26, v4, v4, v26
  v_sub_f32 v4, v25, v3
  v_fma_f32 v26, v4, v4, v26
  v_sub_f32 v4, v10, v3
  v_fma_f32 v26, v4, v4, v26
  v_sub_f32 v4, v11, v3
  v_fma_f32 v26, v4, v4, v26
  v_sub_f32 v4, v12, v3
  v_fma_f32 v26, v4, v4, v26
  v_sub_f32 v4, v13, v3
  v_fma_f32 v26, v4, v4, v26
  v_add_f32_dpp v5, v5, v5 quad_perm:[1,0,3,2] row_mask:0xf bank_mask:0xf
  s_nop 0
  v_add_f32_dpp v26, v26, v26 quad_perm:[1,0,3,2] row_mask:0xf bank_mask:0xf
  v_add_f32_dpp v5, v5, v5 quad_perm:[2,3,0,1] row_mask:0xf bank_mask:0xf
  s_nop 0
  v_add_f32_dpp v26, v26, v26 quad_perm:[2,3,0,1] row_mask:0xf bank_mask:0xf
  v_add_f32_dpp v5, v5, v5 row_half_mirror row_mask:0xf bank_mask:0xf
  s_nop 0
  v_add_f32_dpp v26, v26, v26 row_half_mirror row_mask:0xf bank_mask:0xf
  v_add_f32_dpp v5, v5, v5 row_mirror row_mask:0xf bank_mask:0xf
  s_nop 0
  v_add_f32_dpp v26, v26, v26 row_mirror row_mask:0xf bank_mask:0xf
  v_add_f32_dpp v5, v5, v5 row_bcast:15 row_mask:0xa bank_mask:0xf
  s_nop 0
  v_add_f32_dpp v26, v26, v26 row_bcast:15 row_mask:0xa bank_mask:0xf
  v_add_f32_dpp v5, v5, v5 row_bcast:31 row_mask:0xc bank_mask:0xf
  s_nop 0
  v_add_f32_dpp v26, v26, v26 row_bcast:31 row_mask:0xc bank_mask:0xf
  v_readlane_b32 s28, v5, 63
  v_readlane_b32 s29, v26, 63
  s_nop 0
  v_mov_b32 v4, s28
  v_mul_f32 v4, 0x3acccccd, v4
  v_cvt_pk_bf16_f32 v5, v4, v1
  v_lshlrev_b32 v4, 16, v5
  v_and_b32 v1, 0xffff0000, v5
  v_add_f32 v4, 0x3727c5ac, v4
  v_cvt_pk_bf16_f32 v5, v4, v4
  v_lshlrev_b32 v4, 16, v5
  v_sqrt_f32 v4, v4
  s_nop 0
  v_cvt_pk_bf16_f32 v5, v4, v4
  v_lshlrev_b32 v4, 16, v5
  v_rcp_f32 v5, v4
  s_nop 0
  v_fma_f32 v26, -v4, v5, 1.0
  v_fma_f32 v5, v26, v5, v5
  v_sub_f32 v18, v18, v1
  v_sub_f32 v19, v19, v1
  v_cvt_pk_bf16_f32 v4, v18, v19
  v_lshlrev_b32 v18, 16, v4
  v_and_b32 v19, 0xffff0000, v4
  v_mul_f32 v18, v18, v5
  v_mul_f32 v19, v19, v5
  v_cvt_pk_bf16_f32 v4, v18, v19
  v_lshlrev_b32 v18, 16, v4
  v_and_b32 v19, 0xffff0000, v4
  v_sub_f32 v20, v20, v1
  v_sub_f32 v21, v21, v1
  v_cvt_pk_bf16_f32 v4, v20, v21
  v_lshlrev_b32 v20, 16, v4
  v_and_b32 v21, 0xffff0000, v4
  v_mul_f32 v20, v20, v5
  v_mul_f32 v21, v21, v5
  v_cvt_pk_bf16_f32 v4, v20, v21
  v_lshlrev_b32 v20, 16, v4
  v_and_b32 v21, 0xffff0000, v4
  v_sub_f32 v16, v16, v1
  v_sub_f32 v17, v17, v1
  v_cvt_pk_bf16_f32 v4, v16, v17
  v_lshlrev_b32 v16, 16, v4
  v_and_b32 v17, 0xffff0000, v4
  v_mul_f32 v16, v16, v5
  v_mul_f32 v17, v17, v5
  v_cvt_pk_bf16_f32 v4, v16, v17
  v_lshlrev_b32 v16, 16, v4
  v_and_b32 v17, 0xffff0000, v4
  v_sub_f32 v22, v22, v1
  v_sub_f32 v23, v23, v1
  v_cvt_pk_bf16_f32 v4, v22, v23
  v_lshlrev_b32 v22, 16, v4
  v_and_b32 v23, 0xffff0000, v4
  v_mul_f32 v22, v22, v5
  v_mul_f32 v23, v23, v5
  v_cvt_pk_bf16_f32 v4, v22, v23
  v_lshlrev_b32 v22, 16, v4
  v_and_b32 v23, 0xffff0000, v4
  v_sub_f32 v6, v6, v1
  v_sub_f32 v7, v7, v1
  v_cvt_pk_bf16_f32 v1, v6, v7
  v_lshlrev_b32 v6, 16, v1
  v_and_b32 v7, 0xffff0000, v1
  v_mul_f32 v6, v6, v5
  v_mul_f32 v7, v7, v5
  v_cvt_pk_bf16_f32 v1, v6, v7
  v_lshlrev_b32 v6, 16, v1
  v_and_b32 v7, 0xffff0000, v1
  v_mov_b32 v1, s29
  v_mul_f32 v1, 0x3acccccd, v1
  v_cvt_pk_bf16_f32 v4, v1, v3
  v_lshlrev_b32 v1, 16, v4
  v_and_b32 v3, 0xffff0000, v4
  v_add_f32 v1, 0x3727c5ac, v1
  v_cvt_pk_bf16_f32 v4, v1, v1
  v_lshlrev_b32 v1, 16, v4
  v_sqrt_f32 v1, v1
  s_nop 0
  v_cvt_pk_bf16_f32 v4, v1, v1
  v_lshlrev_b32 v1, 16, v4
  v_rcp_f32 v4, v1
  s_nop 0
  v_fma_f32 v5, -v1, v4, 1.0
  v_fma_f32 v4, v5, v4, v4
  v_sub_f32 v14, v14, v3
  v_sub_f32 v15, v15, v3
  v_cvt_pk_bf16_f32 v1, v14, v15
  v_lshlrev_b32 v14, 16, v1
  v_and_b32 v15, 0xffff0000, v1
  v_mul_f32 v14, v14, v4
  v_mul_f32 v15, v15, v4
  v_cvt_pk_bf16_f32 v1, v14, v15
  v_lshlrev_b32 v14, 16, v1
  v_and_b32 v15, 0xffff0000, v1
  v_sub_f32 v8, v8, v3
  v_sub_f32 v9, v9, v3
  v_cvt_pk_bf16_f32 v1, v8, v9
  v_lshlrev_b32 v8, 16, v1
  v_and_b32 v9, 0xffff0000, v1
  v_mul_f32 v8, v8, v4
  v_mul_f32 v9, v9, v4
  v_cvt_pk_bf16_f32 v1, v8, v9
  v_lshlrev_b32 v8, 16, v1
  v_and_b32 v9, 0xffff0000, v1
  v_sub_f32 v24, v24, v3
  v_sub_f32 v25, v25, v3
  v_cvt_pk_bf16_f32 v1, v24, v25
  v_lshlrev_b32 v24, 16, v1
  v_and_b32 v25, 0xffff0000, v1
  v_mul_f32 v24, v24, v4
  v_mul_f32 v25, v25, v4
  v_cvt_pk_bf16_f32 v1, v24, v25
  v_lshlrev_b32 v24, 16, v1
  v_and_b32 v25, 0xffff0000, v1
  v_sub_f32 v10, v10, v3
  v_sub_f32 v11, v11, v3
  v_cvt_pk_bf16_f32 v1, v10, v11
  v_lshlrev_b32 v10, 16, v1
  v_and_b32 v11, 0xffff0000, v1
  v_mul_f32 v10, v10, v4
  v_mul_f32 v11, v11, v4
  v_cvt_pk_bf16_f32 v1, v10, v11
  v_lshlrev_b32 v10, 16, v1
  v_and_b32 v11, 0xffff0000, v1
  v_sub_f32 v12, v12, v3
  v_sub_f32 v13, v13, v3
  v_cvt_pk_bf16_f32 v1, v12, v13
  v_lshlrev_b32 v12, 16, v1
  v_and_b32 v13, 0xffff0000, v1
  v_mul_f32 v12, v12, v4
  v_mul_f32 v13, v13, v4
  v_cvt_pk_bf16_f32 v1, v12, v13
  v_lshlrev_b32 v12, 16, v1
  v_and_b32 v13, 0xffff0000, v1
  v_cvt_pk_bf16_f32 v1, v18, v19
  buffer_store_dword v1, v2, s[20:23], s25 offen offset:0
  v_cvt_pk_bf16_f32 v1, v20, v21
  buffer_store_dword v1, v2, s[20:23], s25 offen offset:256
  v_cvt_pk_bf16_f32 v1, v16, v17
  buffer_store_dword v1, v2, s[20:23], s25 offen offset:512
  v_cvt_pk_bf16_f32 v1, v22, v23
  buffer_store_dword v1, v2, s[20:23], s25 offen offset:768
  v_cvt_pk_bf16_f32 v1, v6, v7
  buffer_store_dword v1, v2, s[20:23], s25 offen offset:1024
  v_cvt_pk_bf16_f32 v1, v14, v15
  buffer_store_dword v1, v2, s[20:23], s26 offen offset:0
  v_cvt_pk_bf16_f32 v1, v8, v9
  buffer_store_dword v1, v2, s[20:23], s26 offen offset:256
  v_cvt_pk_bf16_f32 v1, v24, v25
  buffer_store_dword v1, v2, s[20:23], s26 offen offset:512
  v_cvt_pk_bf16_f32 v1, v10, v11
  buffer_store_dword v1, v2, s[20:23], s26 offen offset:768
  v_cvt_pk_bf16_f32 v1, v12, v13
  buffer_store_dword v1, v2, s[20:23], s26 offen offset:1024
L_k3_done:
  s_endpgm
.globl k4_kernel
.p2align 8
.type k4_kernel,@function
k4_kernel:
  s_cmp_ge_u32 s2, 256
  s_cbranch_scc1 L_k4_done
  s_load_dwordx2 s[4:5], s[0:1], 80
  s_load_dwordx2 s[6:7], s[0:1], 40
  v_readfirstlane_b32 s32, v0
  s_lshr_b32 s32, s32, 6
  s_and_b32 s45, s2, 7
  s_lshr_b32 s33, s45, 1
  s_lshl_b32 s33, s33, 2
  s_lshr_b32 s46, s2, 6
  s_add_u32 s33, s33, s46
  s_lshl_b32 s33, s33, 7
  s_and_b32 s34, s45, 1
  s_lshl_b32 s34, s34, 3
  s_lshr_b32 s46, s2, 3
  s_and_b32 s46, s46, 7
  s_add_u32 s34, s34, s46
  s_mul_i32 s34, s34, 108
  s_min_u32 s34, s34, 1616
  s_lshl_b32 s35, s32, 10
  s_lshl_b32 s46, s32, 3
  s_add_u32 s46, s46, 0
  s_add_u32 s47, s46, s33
  s_mul_i32 s36, s47, 1280
  s_add_u32 s47, s46, s34
  s_mul_i32 s40, s47, 1280
  s_lshl_b32 s46, s32, 3
  s_add_u32 s46, s46, 32
  s_add_u32 s47, s46, s33
  s_mul_i32 s37, s47, 1280
  s_add_u32 s47, s46, s34
  s_mul_i32 s41, s47, 1280
  s_lshl_b32 s46, s32, 3
  s_add_u32 s46, s46, 64
  s_add_u32 s47, s46, s33
  s_mul_i32 s38, s47, 1280
  s_add_u32 s47, s46, s34
  s_mul_i32 s42, s47, 1280
  s_lshl_b32 s46, s32, 3
  s_add_u32 s46, s46, 96
  s_add_u32 s47, s46, s33
  s_mul_i32 s39, s47, 1280
  s_add_u32 s47, s46, s34
  s_mul_i32 s43, s47, 1280
  s_waitcnt lgkmcnt(0)
  s_add_u32 s12, s4, 15728640
  s_addc_u32 s13, s5, 0
  s_mov_b32 s14, 2621440
  s_mov_b32 s15, 0x00020000
  s_add_u32 s16, s4, 6291456
  s_addc_u32 s17, s5, 0
  s_mov_b32 s18, 2211840
  s_mov_b32 s19, 0x00020000
  s_add_u32 s20, s4, 18874368
  s_addc_u32 s21, s5, 0
  s_mov_b32 s22, 7077888
  s_mov_b32 s23, 0x00020000
  s_mov_b32 s24, s6
  s_mov_b32 s25, s7
  s_mov_b32 s26, 3456
  s_mov_b32 s27, 0x00020000
  v_and_b32 v1, 63, v0
  s_and_b32 s46, s32, 1
  s_lshl_b32 s46, s46, 2
  v_lshrrev_b32 v4, 3, v1
  v_and_b32 v5, 7, v1
  v_lshrrev_b32 v6, 1, v4
  v_xor_b32 v5, v5, v6
  v_xor_b32 v5, s46, v5
  v_mul_u32_u24 v2, 1280, v4
  v_lshlrev_b32 v6, 4, v5
  v_add_u32 v2, v2, v6
  v_and_b32 v4, 15, v1
  v_lshrrev_b32 v5, 4, v1
  v_lshrrev_b32 v6, 1, v4
  v_xor_b32 v5, v5, v6
  v_lshlrev_b32 v6, 4, v5
  v_lshl_add_u32 v3, v4, 7, v6
  v_xor_b32 v5, 4, v5
  v_lshlrev_b32 v6, 4, v5
  v_lshl_add_u32 v14, v4, 7, v6
  s_lshl_b32 s46, s32, 12
  v_add_u32 v8, s46, v3
  v_add_u32 v9, s46, v14
  v_lshrrev_b32 v11, 4, v1
  v_lshlrev_b32 v11, 3, v11
  s_lshl_b32 s47, s34, 1
  buffer_load_dwordx2 v[144:145], v11, s[24:27], s47 offen offset:0
  buffer_load_dwordx2 v[146:147], v11, s[24:27], s47 offen offset:32
  buffer_load_dwordx2 v[148:149], v11, s[24:27], s47 offen offset:64
  buffer_load_dwordx2 v[150:151], v11, s[24:27], s47 offen offset:96
  buffer_load_dwordx2 v[152:153], v11, s[24:27], s47 offen offset:128
  buffer_load_dwordx2 v[154:155], v11, s[24:27], s47 offen offset:160
  buffer_load_dwordx2 v[156:157], v11, s[24:27], s47 offen offset:192
  v_mov_b32 v16, 0
  v_mov_b32 v17, 0
  v_mov_b32 v18, 0
  v_mov_b32 v19, 0
  v_mov_b32 v20, 0
  v_mov_b32 v21, 0
  v_mov_b32 v22, 0
  v_mov_b32 v23, 0
  v_mov_b32 v24, 0
  v_mov_b32 v25, 0
  v_mov_b32 v26, 0
  v_mov_b32 v27, 0
  v_mov_b32 v28, 0
  v_mov_b32 v29, 0
  v_mov_b32 v30, 0
  v_mov_b32 v31, 0
  v_mov_b32 v32, 0
  v_mov_b32 v33, 0
  v_mov_b32 v34, 0
  v_mov_b32 v35, 0
  v_mov_b32 v36, 0
  v_mov_b32 v37, 0
  v_mov_b32 v38, 0
  v_mov_b32 v39, 0
  v_mov_b32 v40, 0
  v_mov_b32 v41, 0
  v_mov_b32 v42, 0
  v_mov_b32 v43, 0
  v_mov_b32 v44, 0
  v_mov_b32 v45, 0
  v_mov_b32 v46, 0
  v_mov_b32 v47, 0
  v_mov_b32 v48, 0
  v_mov_b32 v49, 0
  v_mov_b32 v50, 0
  v_mov_b32 v51, 0
  v_mov_b32 v52, 0
  v_mov_b32 v53, 0
  v_mov_b32 v54, 0
  v_mov_b32 v55, 0
  v_mov_b32 v56, 0
  v_mov_b32 v57, 0
  v_mov_b32 v58, 0
  v_mov_b32 v59, 0
  v_mov_b32 v60, 0
  v_mov_b32 v61, 0
  v_mov_b32 v62, 0
  v_mov_b32 v63, 0
  v_mov_b32 v64, 0
  v_mov_b32 v65, 0
  v_mov_b32 v66, 0
  v_mov_b32 v67, 0
  v_mov_b32 v68, 0
  v_mov_b32 v69, 0
  v_mov_b32 v70, 0
  v_mov_b32 v71, 0
  s_cmp_lt_u32 s32, 2
  s_cbranch_scc0 L_k4_varB
  v_mov_b32 v7, v2
  s_add_u32 m0, s35, 0
  s_nop 0
  buffer_load_dwordx4 v7, s[12:15], s36 offen lds
  s_add_u32 m0, s35, 4096
  s_nop 0
  buffer_load_dwordx4 v7, s[12:15], s37 offen lds
  s_add_u32 m0, s35, 8192
  s_nop 0
  buffer_load_dwordx4 v7, s[12:15], s38 offen lds
  s_add_u32 m0, s35, 12288
  s_nop 0
  buffer_load_dwordx4 v7, s[12:15], s39 offen lds
  s_add_u32 m0, s35, 16384
  s_nop 0
  buffer_load_dwordx4 v7, s[16:19], s40 offen lds
  s_add_u32 m0, s35, 20480
  s_nop 0
  buffer_load_dwordx4 v7, s[16:19], s41 offen lds
  s_add_u32 m0, s35, 24576
  s_nop 0
  buffer_load_dwordx4 v7, s[16:19], s42 offen lds
  s_add_u32 m0, s35, 28672
  s_nop 0
  buffer_load_dwordx4 v7, s[16:19], s43 offen lds
  v_add_u32 v7, 128, v2
  s_add_u32 m0, s35, 30720
  s_nop 0
  buffer_load_dwordx4 v7, s[12:15], s36 offen lds
  s_add_u32 m0, s35, 34816
  s_nop 0
  buffer_load_dwordx4 v7, s[12:15], s37 offen lds
  s_add_u32 m0, s35, 38912
  s_nop 0
  buffer_load_dwordx4 v7, s[12:15], s38 offen lds
  s_add_u32 m0, s35, 43008
  s_nop 0
  buffer_load_dwordx4 v7, s[12:15], s39 offen lds
  s_add_u32 m0, s35, 47104
  s_nop 0
  buffer_load_dwordx4 v7, s[16:19], s40 offen lds
  s_add_u32 m0, s35, 51200
  s_nop 0
  buffer_load_dwordx4 v7, s[16:19], s41 offen lds
  s_add_u32 m0, s35, 55296
  s_nop 0
  buffer_load_dwordx4 v7, s[16:19], s42 offen lds
  s_add_u32 m0, s35, 59392
  s_nop 0
  buffer_load_dwordx4 v7, s[16:19], s43 offen lds
  v_add_u32 v7, 256, v2
  s_add_u32 m0, s35, 61440
  s_nop 0
  buffer_load_dwordx4 v7, s[12:15], s36 offen lds
  s_add_u32 m0, s35, 65536
  s_nop 0
  buffer_load_dwordx4 v7, s[12:15], s37 offen lds
  s_add_u32 m0, s35, 69632
  s_nop 0
  buffer_load_dwordx4 v7, s[12:15], s38 offen lds
  s_add_u32 m0, s35, 73728
  s_nop 0
  buffer_load_dwordx4 v7, s[12:15], s39 offen lds
  s_add_u32 m0, s35, 77824
  s_nop 0
  buffer_load_dwordx4 v7, s[16:19], s40 offen lds
  s_add_u32 m0, s35, 81920
  s_nop 0
  buffer_load_dwordx4 v7, s[16:19], s41 offen lds
  s_add_u32 m0, s35, 86016
  s_nop 0
  buffer_load_dwordx4 v7, s[16:19], s42 offen lds
  s_add_u32 m0, s35, 90112
  s_nop 0
  buffer_load_dwordx4 v7, s[16:19], s43 offen lds
  v_add_u32 v7, 384, v2
  s_add_u32 m0, s35, 92160
  s_nop 0
  buffer_load_dwordx4 v7, s[12:15], s36 offen lds
  s_add_u32 m0, s35, 96256
  s_nop 0
  buffer_load_dwordx4 v7, s[12:15], s37 offen lds
  s_add_u32 m0, s35, 100352
  s_nop 0
  buffer_load_dwordx4 v7, s[12:15], s38 offen lds
  s_add_u32 m0, s35, 104448
  s_nop 0
  buffer_load_dwordx4 v7, s[12:15], s39 offen lds
  s_add_u32 m0, s35, 108544
  s_nop 0
  buffer_load_dwordx4 v7, s[16:19], s40 offen lds
  s_add_u32 m0, s35, 112640
  s_nop 0
  buffer_load_dwordx4 v7, s[16:19], s41 offen lds
  s_add_u32 m0, s35, 116736
  s_nop 0
  buffer_load_dwordx4 v7, s[16:19], s42 offen lds
  s_add_u32 m0, s35, 120832
  s_nop 0
  buffer_load_dwordx4 v7, s[16:19], s43 offen lds
  s_waitcnt vmcnt(24)
  s_barrier
  v_add_u32 v10, 0, v3
  v_add_u32 v11, 0, v8
  ds_read_b128 v[100:103], v11 offset:0
  ds_read_b128 v[104:107], v11 offset:2048
  ds_read_b128 v[72:75], v10 offset:16384
  ds_read_b128 v[76:79], v10 offset:18432
  ds_read_b128 v[80:83], v10 offset:20480
  ds_read_b128 v[84:87], v10 offset:22528
  ds_read_b128 v[88:91], v10 offset:24576
  ds_read_b128 v[92:95], v10 offset:26624
  ds_read_b128 v[96:99], v10 offset:28672
  v_add_u32 v10, 0, v14
  v_add_u32 v11, 0, v9
  ds_read_b128 v[136:139], v11 offset:0
  ds_read_b128 v[140:143], v11 offset:2048
  ds_read_b128 v[108:111], v10 offset:16384
  ds_read_b128 v[112:115], v10 offset:18432
  ds_read_b128 v[116:119], v10 offset:20480
  ds_read_b128 v[120:123], v10 offset:22528
  ds_read_b128 v[124:127], v10 offset:24576
  ds_read_b128 v[128:131], v10 offset:26624
  ds_read_b128 v[132:135], v10 offset:28672
  s_waitcnt lgkmcnt(9)
  v_mfma_f32_16x16x32_bf16 v[16:19], v[72:75], v[100:103], v[16:19]
  v_mfma_f32_16x16x32_bf16 v[44:47], v[72:75], v[104:107], v[44:47]
  v_mfma_f32_16x16x32_bf16 v[20:23], v[76:79], v[100:103], v[20:23]
  v_mfma_f32_16x16x32_bf16 v[48:51], v[76:79], v[104:107], v[48:51]
  v_mfma_f32_16x16x32_bf16 v[24:27], v[80:83], v[100:103], v[24:27]
  v_mfma_f32_16x16x32_bf16 v[52:55], v[80:83], v[104:107], v[52:55]
  v_mfma_f32_16x16x32_bf16 v[28:31], v[84:87], v[100:103], v[28:31]
  v_mfma_f32_16x16x32_bf16 v[56:59], v[84:87], v[104:107], v[56:59]
  v_mfma_f32_16x16x32_bf16 v[32:35], v[88:91], v[100:103], v[32:35]
  v_mfma_f32_16x16x32_bf16 v[60:63], v[88:91], v[104:107], v[60:63]
  v_mfma_f32_16x16x32_bf16 v[36:39], v[92:95], v[100:103], v[36:39]
  v_mfma_f32_16x16x32_bf16 v[64:67], v[92:95], v[104:107], v[64:67]
  v_mfma_f32_16x16x32_bf16 v[40:43], v[96:99], v[100:103], v[40:43]
  v_mfma_f32_16x16x32_bf16 v[68:71], v[96:99], v[104:107], v[68:71]
  s_waitcnt vmcnt(16) lgkmcnt(0)
  s_barrier
  v_add_u32 v7, 512, v2
  s_add_u32 m0, s35, 0
  s_nop 0
  buffer_load_dwordx4 v7, s[12:15], s36 offen lds
  s_add_u32 m0, s35, 4096
  s_nop 0
  buffer_load_dwordx4 v7, s[12:15], s37 offen lds
  s_add_u32 m0, s35, 8192
  s_nop 0
  buffer_load_dwordx4 v7, s[12:15], s38 offen lds
  s_add_u32 m0, s35, 12288
  s_nop 0
  buffer_load_dwordx4 v7, s[12:15], s39 offen lds
  s_add_u32 m0, s35, 16384
  s_nop 0
  buffer_load_dwordx4 v7, s[16:19], s40 offen lds
  s_add_u32 m0, s35, 20480
  s_nop 0
  buffer_load_dwordx4 v7, s[16:19], s41 offen lds
  s_add_u32 m0, s35, 24576
  s_nop 0
  buffer_load_dwordx4 v7, s[16:19], s42 offen lds
  s_add_u32 m0, s35, 28672
  s_nop 0
  buffer_load_dwordx4 v7, s[16:19], s43 offen lds
  v_add_u32 v10, 30720, v3
  v_add_u32 v11, 30720, v8
  ds_read_b128 v[100:103], v11 offset:0
  ds_read_b128 v[104:107], v11 offset:2048
  ds_read_b128 v[72:75], v10 offset:16384
  ds_read_b128 v[76:79], v10 offset:18432
  ds_read_b128 v[80:83], v10 offset:20480
  ds_read_b128 v[84:87], v10 offset:22528
  ds_read_b128 v[88:91], v10 offset:24576
  ds_read_b128 v[92:95], v10 offset:26624
  ds_read_b128 v[96:99], v10 offset:28672
  v_mfma_f32_16x16x32_bf16 v[16:19], v[108:111], v[136:139], v[16:19]
  v_mfma_f32_16x16x32_bf16 v[44:47], v[108:111], v[140:143], v[44:47]
  v_mfma_f32_16x16x32_bf16 v[20:23], v[112:115], v[136:139], v[20:23]
  v_mfma_f32_16x16x32_bf16 v[48:51], v[112:115], v[140:143], v[48:51]
  v_mfma_f32_16x16x32_bf16 v[24:27], v[116:119], v[136:139], v[24:27]
  v_mfma_f32_16x16x32_bf16 v[52:55], v[116:119], v[140:143], v[52:55]
  v_mfma_f32_16x16x32_bf16 v[28:31], v[120:123], v[136:139], v[28:31]
  v_mfma_f32_16x16x32_bf16 v[56:59], v[120:123], v[140:143], v[56:59]
  v_mfma_f32_16x16x32_bf16 v[32:35], v[124:127], v[136:139], v[32:35]
  v_mfma_f32_16x16x32_bf16 v[60:63], v[124:127], v[140:143], v[60:63]
  v_mfma_f32_16x16x32_bf16 v[36:39], v[128:131], v[136:139], v[36:39]
  v_mfma_f32_16x16x32_bf16 v[64:67], v[128:131], v[140:143], v[64:67]
  v_mfma_f32_16x16x32_bf16 v[40:43], v[132:135], v[136:139], v[40:43]
  v_mfma_f32_16x16x32_bf16 v[68:71], v[132:135], v[140:143], v[68:71]
  v_add_u32 v10, 30720, v14
  v_add_u32 v11, 30720, v9
  ds_read_b128 v[136:139], v11 offset:0
  ds_read_b128 v[140:143], v11 offset:2048
  ds_read_b128 v[108:111], v10 offset:16384
  ds_read_b128 v[112:115], v10 offset:18432
  ds_read_b128 v[116:119], v10 offset:20480
  ds_read_b128 v[120:123], v10 offset:22528
  ds_read_b128 v[124:127], v10 offset:24576
  ds_read_b128 v[128:131], v10 offset:26624
  ds_read_b128 v[132:135], v10 offset:28672
  s_waitcnt lgkmcnt(9)
  v_mfma_f32_16x16x32_bf16 v[16:19], v[72:75], v[100:103], v[16:19]
  v_mfma_f32_16x16x32_bf16 v[44:47], v[72:75], v[104:107], v[44:47]
  v_mfma_f32_16x16x32_bf16 v[20:23], v[76:79], v[100:103], v[20:23]
  v_mfma_f32_16x16x32_bf16 v[48:51], v[76:79], v[104:107], v[48:51]
  v_mfma_f32_16x16x32_bf16 v[24:27], v[80:83], v[100:103], v[24:27]
  v_mfma_f32_16x16x32_bf16 v[52:55], v[80:83], v[104:107], v[52:55]
  v_mfma_f32_16x16x32_bf16 v[28:31], v[84:87], v[100:103], v[28:31]
  v_mfma_f32_16x16x32_bf16 v[56:59], v[84:87], v[104:107], v[56:59]
  v_mfma_f32_16x16x32_bf16 v[32:35], v[88:91], v[100:103], v[32:35]
  v_mfma_f32_16x16x32_bf16 v[60:63], v[88:91], v[104:107], v[60:63]
  v_mfma_f32_16x16x32_bf16 v[36:39], v[92:95], v[100:103], v[36:39]
  v_mfma_f32_16x16x32_bf16 v[64:67], v[92:95], v[104:107], v[64:67]
  v_mfma_f32_16x16x32_bf16 v[40:43], v[96:99], v[100:103], v[40:43]
  v_mfma_f32_16x16x32_bf16 v[68:71], v[96:99], v[104:107], v[68:71]
  s_waitcnt vmcnt(16) lgkmcnt(0)
  s_barrier
  v_add_u32 v7, 640, v2
  s_add_u32 m0, s35, 30720
  s_nop 0
  buffer_load_dwordx4 v7, s[12:15], s36 offen lds
  s_add_u32 m0, s35, 34816
  s_nop 0
  buffer_load_dwordx4 v7, s[12:15], s37 offen lds
  s_add_u32 m0, s35, 38912
  s_nop 0
  buffer_load_dwordx4 v7, s[12:15], s38 offen lds
  s_add_u32 m0, s35, 43008
  s_nop 0
  buffer_load_dwordx4 v7, s[12:15], s39 offen lds
  s_add_u32 m0, s35, 47104
  s_nop 0
  buffer_load_dwordx4 v7, s[16:19], s40 offen lds
  s_add_u32 m0, s35, 51200
  s_nop 0
  buffer_load_dwordx4 v7, s[16:19], s41 offen lds
  s_add_u32 m0, s35, 55296
  s_nop 0
  buffer_load_dwordx4 v7, s[16:19], s42 offen lds
  s_add_u32 m0, s35, 59392
  s_nop 0
  buffer_load_dwordx4 v7, s[16:19], s43 offen lds
  v_add_u32 v10, 61440, v3
  v_add_u32 v11, 61440, v8
  ds_read_b128 v[100:103], v11 offset:0
  ds_read_b128 v[104:107], v11 offset:2048
  ds_read_b128 v[72:75], v10 offset:16384
  ds_read_b128 v[76:79], v10 offset:18432
  ds_read_b128 v[80:83], v10 offset:20480
  ds_read_b128 v[84:87], v10 offset:22528
  ds_read_b128 v[88:91], v10 offset:24576
  ds_read_b128 v[92:95], v10 offset:26624
  ds_read_b128 v[96:99], v10 offset:28672
  v_mfma_f32_16x16x32_bf16 v[16:19], v[108:111], v[136:139], v[16:19]
  v_mfma_f32_16x16x32_bf16 v[44:47], v[108:111], v[140:143], v[44:47]
  v_mfma_f32_16x16x32_bf16 v[20:23], v[112:115], v[136:139], v[20:23]
  v_mfma_f32_16x16x32_bf16 v[48:51], v[112:115], v[140:143], v[48:51]
  v_mfma_f32_16x16x32_bf16 v[24:27], v[116:119], v[136:139], v[24:27]
  v_mfma_f32_16x16x32_bf16 v[52:55], v[116:119], v[140:143], v[52:55]
  v_mfma_f32_16x16x32_bf16 v[28:31], v[120:123], v[136:139], v[28:31]
  v_mfma_f32_16x16x32_bf16 v[56:59], v[120:123], v[140:143], v[56:59]
  v_mfma_f32_16x16x32_bf16 v[32:35], v[124:127], v[136:139], v[32:35]
  v_mfma_f32_16x16x32_bf16 v[60:63], v[124:127], v[140:143], v[60:63]
  v_mfma_f32_16x16x32_bf16 v[36:39], v[128:131], v[136:139], v[36:39]
  v_mfma_f32_16x16x32_bf16 v[64:67], v[128:131], v[140:143], v[64:67]
  v_mfma_f32_16x16x32_bf16 v[40:43], v[132:135], v[136:139], v[40:43]
  v_mfma_f32_16x16x32_bf16 v[68:71], v[132:135], v[140:143], v[68:71]
  v_add_u32 v10, 61440, v14
  v_add_u32 v11, 61440, v9
  ds_read_b128 v[136:139], v11 offset:0
  ds_read_b128 v[140:143], v11 offset:2048
  ds_read_b128 v[108:111], v10 offset:16384
  ds_read_b128 v[112:115], v10 offset:18432
  ds_read_b128 v[116:119], v10 offset:20480
  ds_read_b128 v[120:123], v10 offset:22528
  ds_read_b128 v[124:127], v10 offset:24576
  ds_read_b128 v[128:131], v10 offset:26624
  ds_read_b128 v[132:135], v10 offset:28672
  s_waitcnt lgkmcnt(9)
  v_mfma_f32_16x16x32_bf16 v[16:19], v[72:75], v[100:103], v[16:19]
  v_mfma_f32_16x16x32_bf16 v[44:47], v[72:75], v[104:107], v[44:47]
  v_mfma_f32_16x16x32_bf16 v[20:23], v[76:79], v[100:103], v[20:23]
  v_mfma_f32_16x16x32_bf16 v[48:51], v[76:79], v[104:107], v[48:51]
  v_mfma_f32_16x16x32_bf16 v[24:27], v[80:83], v[100:103], v[24:27]
  v_mfma_f32_16x16x32_bf16 v[52:55], v[80:83], v[104:107], v[52:55]
  v_mfma_f32_16x16x32_bf16 v[28:31], v[84:87], v[100:103], v[28:31]
  v_mfma_f32_16x16x32_bf16 v[56:59], v[84:87], v[104:107], v[56:59]
  v_mfma_f32_16x16x32_bf16 v[32:35], v[88:91], v[100:103], v[32:35]
  v_mfma_f32_16x16x32_bf16 v[60:63], v[88:91], v[104:107], v[60:63]
  v_mfma_f32_16x16x32_bf16 v[36:39], v[92:95], v[100:103], v[36:39]
  v_mfma_f32_16x16x32_bf16 v[64:67], v[92:95], v[104:107], v[64:67]
  v_mfma_f32_16x16x32_bf16 v[40:43], v[96:99], v[100:103], v[40:43]
  v_mfma_f32_16x16x32_bf16 v[68:71], v[96:99], v[104:107], v[68:71]
  s_waitcnt vmcnt(16) lgkmcnt(0)
  s_barrier
  v_add_u32 v7, 768, v2
  s_add_u32 m0, s35, 61440
  s_nop 0
  buffer_load_dwordx4 v7, s[12:15], s36 offen lds
  s_add_u32 m0, s35, 65536
  s_nop 0
  buffer_load_dwordx4 v7, s[12:15], s37 offen lds
  s_add_u32 m0, s35, 69632
  s_nop 0
  buffer_load_dwordx4 v7, s[12:15], s38 offen lds
  s_add_u32 m0, s35, 73728
  s_nop 0
  buffer_load_dwordx4 v7, s[12:15], s39 offen lds
  s_add_u32 m0, s35, 77824
  s_nop 0
  buffer_load_dwordx4 v7, s[16:19], s40 offen lds
  s_add_u32 m0, s35, 81920
  s_nop 0
  buffer_load_dwordx4 v7, s[16:19], s41 offen lds
  s_add_u32 m0, s35, 86016
  s_nop 0
  buffer_load_dwordx4 v7, s[16:19], s42 offen lds
  s_add_u32 m0, s35, 90112
  s_nop 0
  buffer_load_dwordx4 v7, s[16:19], s43 offen lds
  v_add_u32 v10, 92160, v3
  v_add_u32 v11, 92160, v8
  ds_read_b128 v[100:103], v11 offset:0
  ds_read_b128 v[104:107], v11 offset:2048
  ds_read_b128 v[72:75], v10 offset:16384
  ds_read_b128 v[76:79], v10 offset:18432
  ds_read_b128 v[80:83], v10 offset:20480
  ds_read_b128 v[84:87], v10 offset:22528
  ds_read_b128 v[88:91], v10 offset:24576
  ds_read_b128 v[92:95], v10 offset:26624
  ds_read_b128 v[96:99], v10 offset:28672
  v_mfma_f32_16x16x32_bf16 v[16:19], v[108:111], v[136:139], v[16:19]
  v_mfma_f32_16x16x32_bf16 v[44:47], v[108:111], v[140:143], v[44:47]
  v_mfma_f32_16x16x32_bf16 v[20:23], v[112:115], v[136:139], v[20:23]
  v_mfma_f32_16x16x32_bf16 v[48:51], v[112:115], v[140:143], v[48:51]
  v_mfma_f32_16x16x32_bf16 v[24:27], v[116:119], v[136:139], v[24:27]
  v_mfma_f32_16x16x32_bf16 v[52:55], v[116:119], v[140:143], v[52:55]
  v_mfma_f32_16x16x32_bf16 v[28:31], v[120:123], v[136:139], v[28:31]
  v_mfma_f32_16x16x32_bf16 v[56:59], v[120:123], v[140:143], v[56:59]
  v_mfma_f32_16x16x32_bf16 v[32:35], v[124:127], v[136:139], v[32:35]
  v_mfma_f32_16x16x32_bf16 v[60:63], v[124:127], v[140:143], v[60:63]
  v_mfma_f32_16x16x32_bf16 v[36:39], v[128:131], v[136:139], v[36:39]
  v_mfma_f32_16x16x32_bf16 v[64:67], v[128:131], v[140:143], v[64:67]
  v_mfma_f32_16x16x32_bf16 v[40:43], v[132:135], v[136:139], v[40:43]
  v_mfma_f32_16x16x32_bf16 v[68:71], v[132:135], v[140:143], v[68:71]
  v_add_u32 v10, 92160, v14
  v_add_u32 v11, 92160, v9
  ds_read_b128 v[136:139], v11 offset:0
  ds_read_b128 v[140:143], v11 offset:2048
  ds_read_b128 v[108:111], v10 offset:16384
  ds_read_b128 v[112:115], v10 offset:18432
  ds_read_b128 v[116:119], v10 offset:20480
  ds_read_b128 v[120:123], v10 offset:22528
  ds_read_b128 v[124:127], v10 offset:24576
  ds_read_b128 v[128:131], v10 offset:26624
  ds_read_b128 v[132:135], v10 offset:28672
  s_waitcnt lgkmcnt(9)
  v_mfma_f32_16x16x32_bf16 v[16:19], v[72:75], v[100:103], v[16:19]
  v_mfma_f32_16x16x32_bf16 v[44:47], v[72:75], v[104:107], v[44:47]
  v_mfma_f32_16x16x32_bf16 v[20:23], v[76:79], v[100:103], v[20:23]
  v_mfma_f32_16x16x32_bf16 v[48:51], v[76:79], v[104:107], v[48:51]
  v_mfma_f32_16x16x32_bf16 v[24:27], v[80:83], v[100:103], v[24:27]
  v_mfma_f32_16x16x32_bf16 v[52:55], v[80:83], v[104:107], v[52:55]
  v_mfma_f32_16x16x32_bf16 v[28:31], v[84:87], v[100:103], v[28:31]
  v_mfma_f32_16x16x32_bf16 v[56:59], v[84:87], v[104:107], v[56:59]
  v_mfma_f32_16x16x32_bf16 v[32:35], v[88:91], v[100:103], v[32:35]
  v_mfma_f32_16x16x32_bf16 v[60:63], v[88:91], v[104:107], v[60:63]
  v_mfma_f32_16x16x32_bf16 v[36:39], v[92:95], v[100:103], v[36:39]
  v_mfma_f32_16x16x32_bf16 v[64:67], v[92:95], v[104:107], v[64:67]
  v_mfma_f32_16x16x32_bf16 v[40:43], v[96:99], v[100:103], v[40:43]
  v_mfma_f32_16x16x32_bf16 v[68:71], v[96:99], v[104:107], v[68:71]
  s_waitcnt vmcnt(16) lgkmcnt(0)
  s_barrier
  v_add_u32 v7, 896, v2
  s_add_u32 m0, s35, 92160
  s_nop 0
  buffer_load_dwordx4 v7, s[12:15], s36 offen lds
  s_add_u32 m0, s35, 96256
  s_nop 0
  buffer_load_dwordx4 v7, s[12:15], s37 offen lds
  s_add_u32 m0, s35, 100352
  s_nop 0
  buffer_load_dwordx4 v7, s[12:15], s38 offen lds
  s_add_u32 m0, s35, 104448
  s_nop 0
  buffer_load_dwordx4 v7, s[12:15], s39 offen lds
  s_add_u32 m0, s35, 108544
  s_nop 0
  buffer_load_dwordx4 v7, s[16:19], s40 offen lds
  s_add_u32 m0, s35, 112640
  s_nop 0
  buffer_load_dwordx4 v7, s[16:19], s41 offen lds
  s_add_u32 m0, s35, 116736
  s_nop 0
  buffer_load_dwordx4 v7, s[16:19], s42 offen lds
  s_add_u32 m0, s35, 120832
  s_nop 0
  buffer_load_dwordx4 v7, s[16:19], s43 offen lds
  v_add_u32 v10, 0, v3
  v_add_u32 v11, 0, v8
  ds_read_b128 v[100:103], v11 offset:0
  ds_read_b128 v[104:107], v11 offset:2048
  ds_read_b128 v[72:75], v10 offset:16384
  ds_read_b128 v[76:79], v10 offset:18432
  ds_read_b128 v[80:83], v10 offset:20480
  ds_read_b128 v[84:87], v10 offset:22528
  ds_read_b128 v[88:91], v10 offset:24576
  ds_read_b128 v[92:95], v10 offset:26624
  ds_read_b128 v[96:99], v10 offset:28672
  v_mfma_f32_16x16x32_bf16 v[16:19], v[108:111], v[136:139], v[16:19]
  v_mfma_f32_16x16x32_bf16 v[44:47], v[108:111], v[140:143], v[44:47]
  v_mfma_f32_16x16x32_bf16 v[20:23], v[112:115], v[136:139], v[20:23]
  v_mfma_f32_16x16x32_bf16 v[48:51], v[112:115], v[140:143], v[48:51]
  v_mfma_f32_16x16x32_bf16 v[24:27], v[116:119], v[136:139], v[24:27]
  v_mfma_f32_16x16x32_bf16 v[52:55], v[116:119], v[140:143], v[52:55]
  v_mfma_f32_16x16x32_bf16 v[28:31], v[120:123], v[136:139], v[28:31]
  v_mfma_f32_16x16x32_bf16 v[56:59], v[120:123], v[140:143], v[56:59]
  v_mfma_f32_16x16x32_bf16 v[32:35], v[124:127], v[136:139], v[32:35]
  v_mfma_f32_16x16x32_bf16 v[60:63], v[124:127], v[140:143], v[60:63]
  v_mfma_f32_16x16x32_bf16 v[36:39], v[128:131], v[136:139], v[36:39]
  v_mfma_f32_16x16x32_bf16 v[64:67], v[128:131], v[140:143], v[64:67]
  v_mfma_f32_16x16x32_bf16 v[40:43], v[132:135], v[136:139], v[40:43]
  v_mfma_f32_16x16x32_bf16 v[68:71], v[132:135], v[140:143], v[68:71]
  v_add_u32 v10, 0, v14
  v_add_u32 v11, 0, v9
  ds_read_b128 v[136:139], v11 offset:0
  ds_read_b128 v[140:143], v11 offset:2048
  ds_read_b128 v[108:111], v10 offset:16384
  ds_read_b128 v[112:115], v10 offset:18432
  ds_read_b128 v[116:119], v10 offset:20480
  ds_read_b128 v[120:123], v10 offset:22528
  ds_read_b128 v[124:127], v10 offset:24576
  ds_read_b128 v[128:131], v10 offset:26624
  ds_read_b128 v[132:135], v10 offset:28672
  s_waitcnt lgkmcnt(9)
  v_mfma_f32_16x16x32_bf16 v[16:19], v[72:75], v[100:103], v[16:19]
  v_mfma_f32_16x16x32_bf16 v[44:47], v[72:75], v[104:107], v[44:47]
  v_mfma_f32_16x16x32_bf16 v[20:23], v[76:79], v[100:103], v[20:23]
  v_mfma_f32_16x16x32_bf16 v[48:51], v[76:79], v[104:107], v[48:51]
  v_mfma_f32_16x16x32_bf16 v[24:27], v[80:83], v[100:103], v[24:27]
  v_mfma_f32_16x16x32_bf16 v[52:55], v[80:83], v[104:107], v[52:55]
  v_mfma_f32_16x16x32_bf16 v[28:31], v[84:87], v[100:103], v[28:31]
  v_mfma_f32_16x16x32_bf16 v[56:59], v[84:87], v[104:107], v[56:59]
  v_mfma_f32_16x16x32_bf16 v[32:35], v[88:91], v[100:103], v[32:35]
  v_mfma_f32_16x16x32_bf16 v[60:63], v[88:91], v[104:107], v[60:63]
  v_mfma_f32_16x16x32_bf16 v[36:39], v[92:95], v[100:103], v[36:39]
  v_mfma_f32_16x16x32_bf16 v[64:67], v[92:95], v[104:107], v[64:67]
  v_mfma_f32_16x16x32_bf16 v[40:43], v[96:99], v[100:103], v[40:43]
  v_mfma_f32_16x16x32_bf16 v[68:71], v[96:99], v[104:107], v[68:71]
  s_waitcnt vmcnt(16) lgkmcnt(0)
  s_barrier
  v_add_u32 v7, 1024, v2
  s_add_u32 m0, s35, 0
  s_nop 0
  buffer_load_dwordx4 v7, s[12:15], s36 offen lds
  s_add_u32 m0, s35, 4096
  s_nop 0
  buffer_load_dwordx4 v7, s[12:15], s37 offen lds
  s_add_u32 m0, s35, 8192
  s_nop 0
  buffer_load_dwordx4 v7, s[12:15], s38 offen lds
  s_add_u32 m0, s35, 12288
  s_nop 0
  buffer_load_dwordx4 v7, s[12:15], s39 offen lds
  s_add_u32 m0, s35, 16384
  s_nop 0
  buffer_load_dwordx4 v7, s[16:19], s40 offen lds
  s_add_u32 m0, s35, 20480
  s_nop 0
  buffer_load_dwordx4 v7, s[16:19], s41 offen lds
  s_add_u32 m0, s35, 24576
  s_nop 0
  buffer_load_dwordx4 v7, s[16:19], s42 offen lds
  s_add_u32 m0, s35, 28672
  s_nop 0
  buffer_load_dwordx4 v7, s[16:19], s43 offen lds
  v_add_u32 v10, 30720, v3
  v_add_u32 v11, 30720, v8
  ds_read_b128 v[100:103], v11 offset:0
  ds_read_b128 v[104:107], v11 offset:2048
  ds_read_b128 v[72:75], v10 offset:16384
  ds_read_b128 v[76:79], v10 offset:18432
  ds_read_b128 v[80:83], v10 offset:20480
  ds_read_b128 v[84:87], v10 offset:22528
  ds_read_b128 v[88:91], v10 offset:24576
  ds_read_b128 v[92:95], v10 offset:26624
  ds_read_b128 v[96:99], v10 offset:28672
  v_mfma_f32_16x16x32_bf16 v[16:19], v[108:111], v[136:139], v[16:19]
  v_mfma_f32_16x16x32_bf16 v[44:47], v[108:111], v[140:143], v[44:47]
  v_mfma_f32_16x16x32_bf16 v[20:23], v[112:115], v[136:139], v[20:23]
  v_mfma_f32_16x16x32_bf16 v[48:51], v[112:115], v[140:143], v[48:51]
  v_mfma_f32_16x16x32_bf16 v[24:27], v[116:119], v[136:139], v[24:27]
  v_mfma_f32_16x16x32_bf16 v[52:55], v[116:119], v[140:143], v[52:55]
  v_mfma_f32_16x16x32_bf16 v[28:31], v[120:123], v[136:139], v[28:31]
  v_mfma_f32_16x16x32_bf16 v[56:59], v[120:123], v[140:143], v[56:59]
  v_mfma_f32_16x16x32_bf16 v[32:35], v[124:127], v[136:139], v[32:35]
  v_mfma_f32_16x16x32_bf16 v[60:63], v[124:127], v[140:143], v[60:63]
  v_mfma_f32_16x16x32_bf16 v[36:39], v[128:131], v[136:139], v[36:39]
  v_mfma_f32_16x16x32_bf16 v[64:67], v[128:131], v[140:143], v[64:67]
  v_mfma_f32_16x16x32_bf16 v[40:43], v[132:135], v[136:139], v[40:43]
  v_mfma_f32_16x16x32_bf16 v[68:71], v[132:135], v[140:143], v[68:71]
  v_add_u32 v10, 30720, v14
  v_add_u32 v11, 30720, v9
  ds_read_b128 v[136:139], v11 offset:0
  ds_read_b128 v[140:143], v11 offset:2048
  ds_read_b128 v[108:111], v10 offset:16384
  ds_read_b128 v[112:115], v10 offset:18432
  ds_read_b128 v[116:119], v10 offset:20480
  ds_read_b128 v[120:123], v10 offset:22528
  ds_read_b128 v[124:127], v10 offset:24576
  ds_read_b128 v[128:131], v10 offset:26624
  ds_read_b128 v[132:135], v10 offset:28672
  s_waitcnt lgkmcnt(9)
  v_mfma_f32_16x16x32_bf16 v[16:19], v[72:75], v[100:103], v[16:19]
  v_mfma_f32_16x16x32_bf16 v[44:47], v[72:75], v[104:107], v[44:47]
  v_mfma_f32_16x16x32_bf16 v[20:23], v[76:79], v[100:103], v[20:23]
  v_mfma_f32_16x16x32_bf16 v[48:51], v[76:79], v[104:107], v[48:51]
  v_mfma_f32_16x16x32_bf16 v[24:27], v[80:83], v[100:103], v[24:27]
  v_mfma_f32_16x16x32_bf16 v[52:55], v[80:83], v[104:107], v[52:55]
  v_mfma_f32_16x16x32_bf16 v[28:31], v[84:87], v[100:103], v[28:31]
  v_mfma_f32_16x16x32_bf16 v[56:59], v[84:87], v[104:107], v[56:59]
  v_mfma_f32_16x16x32_bf16 v[32:35], v[88:91], v[100:103], v[32:35]
  v_mfma_f32_16x16x32_bf16 v[60:63], v[88:91], v[104:107], v[60:63]
  v_mfma_f32_16x16x32_bf16 v[36:39], v[92:95], v[100:103], v[36:39]
  v_mfma_f32_16x16x32_bf16 v[64:67], v[92:95], v[104:107], v[64:67]
  v_mfma_f32_16x16x32_bf16 v[40:43], v[96:99], v[100:103], v[40:43]
  v_mfma_f32_16x16x32_bf16 v[68:71], v[96:99], v[104:107], v[68:71]
  s_waitcnt vmcnt(16) lgkmcnt(0)
  s_barrier
  v_add_u32 v7, 1152, v2
  s_add_u32 m0, s35, 30720
  s_nop 0
  buffer_load_dwordx4 v7, s[12:15], s36 offen lds
  s_add_u32 m0, s35, 34816
  s_nop 0
  buffer_load_dwordx4 v7, s[12:15], s37 offen lds
  s_add_u32 m0, s35, 38912
  s_nop 0
  buffer_load_dwordx4 v7, s[12:15], s38 offen lds
  s_add_u32 m0, s35, 43008
  s_nop 0
  buffer_load_dwordx4 v7, s[12:15], s39 offen lds
  s_add_u32 m0, s35, 47104
  s_nop 0
  buffer_load_dwordx4 v7, s[16:19], s40 offen lds
  s_add_u32 m0, s35, 51200
  s_nop 0
  buffer_load_dwordx4 v7, s[16:19], s41 offen lds
  s_add_u32 m0, s35, 55296
  s_nop 0
  buffer_load_dwordx4 v7, s[16:19], s42 offen lds
  s_add_u32 m0, s35, 59392
  s_nop 0
  buffer_load_dwordx4 v7, s[16:19], s43 offen lds
  v_add_u32 v10, 61440, v3
  v_add_u32 v11, 61440, v8
  ds_read_b128 v[100:103], v11 offset:0
  ds_read_b128 v[104:107], v11 offset:2048
  ds_read_b128 v[72:75], v10 offset:16384
  ds_read_b128 v[76:79], v10 offset:18432
  ds_read_b128 v[80:83], v10 offset:20480
  ds_read_b128 v[84:87], v10 offset:22528
  ds_read_b128 v[88:91], v10 offset:24576
  ds_read_b128 v[92:95], v10 offset:26624
  ds_read_b128 v[96:99], v10 offset:28672
  v_mfma_f32_16x16x32_bf16 v[16:19], v[108:111], v[136:139], v[16:19]
  v_mfma_f32_16x16x32_bf16 v[44:47], v[108:111], v[140:143], v[44:47]
  v_mfma_f32_16x16x32_bf16 v[20:23], v[112:115], v[136:139], v[20:23]
  v_mfma_f32_16x16x32_bf16 v[48:51], v[112:115], v[140:143], v[48:51]
  v_mfma_f32_16x16x32_bf16 v[24:27], v[116:119], v[136:139], v[24:27]
  v_mfma_f32_16x16x32_bf16 v[52:55], v[116:119], v[140:143], v[52:55]
  v_mfma_f32_16x16x32_bf16 v[28:31], v[120:123], v[136:139], v[28:31]
  v_mfma_f32_16x16x32_bf16 v[56:59], v[120:123], v[140:143], v[56:59]
  v_mfma_f32_16x16x32_bf16 v[32:35], v[124:127], v[136:139], v[32:35]
  v_mfma_f32_16x16x32_bf16 v[60:63], v[124:127], v[140:143], v[60:63]
  v_mfma_f32_16x16x32_bf16 v[36:39], v[128:131], v[136:139], v[36:39]
  v_mfma_f32_16x16x32_bf16 v[64:67], v[128:131], v[140:143], v[64:67]
  v_mfma_f32_16x16x32_bf16 v[40:43], v[132:135], v[136:139], v[40:43]
  v_mfma_f32_16x16x32_bf16 v[68:71], v[132:135], v[140:143], v[68:71]
  v_add_u32 v10, 61440, v14
  v_add_u32 v11, 61440, v9
  ds_read_b128 v[136:139], v11 offset:0
  ds_read_b128 v[140:143], v11 offset:2048
  ds_read_b128 v[108:111], v10 offset:16384
  ds_read_b128 v[112:115], v10 offset:18432
  ds_read_b128 v[116:119], v10 offset:20480
  ds_read_b128 v[120:123], v10 offset:22528
  ds_read_b128 v[124:127], v10 offset:24576
  ds_read_b128 v[128:131], v10 offset:26624
  ds_read_b128 v[132:135], v10 offset:28672
  s_waitcnt lgkmcnt(9)
  v_mfma_f32_16x16x32_bf16 v[16:19], v[72:75], v[100:103], v[16:19]
  v_mfma_f32_16x16x32_bf16 v[44:47], v[72:75], v[104:107], v[44:47]
  v_mfma_f32_16x16x32_bf16 v[20:23], v[76:79], v[100:103], v[20:23]
  v_mfma_f32_16x16x32_bf16 v[48:51], v[76:79], v[104:107], v[48:51]
  v_mfma_f32_16x16x32_bf16 v[24:27], v[80:83], v[100:103], v[24:27]
  v_mfma_f32_16x16x32_bf16 v[52:55], v[80:83], v[104:107], v[52:55]
  v_mfma_f32_16x16x32_bf16 v[28:31], v[84:87], v[100:103], v[28:31]
  v_mfma_f32_16x16x32_bf16 v[56:59], v[84:87], v[104:107], v[56:59]
  v_mfma_f32_16x16x32_bf16 v[32:35], v[88:91], v[100:103], v[32:35]
  v_mfma_f32_16x16x32_bf16 v[60:63], v[88:91], v[104:107], v[60:63]
  v_mfma_f32_16x16x32_bf16 v[36:39], v[92:95], v[100:103], v[36:39]
  v_mfma_f32_16x16x32_bf16 v[64:67], v[92:95], v[104:107], v[64:67]
  v_mfma_f32_16x16x32_bf16 v[40:43], v[96:99], v[100:103], v[40:43]
  v_mfma_f32_16x16x32_bf16 v[68:71], v[96:99], v[104:107], v[68:71]
  s_waitcnt vmcnt(16) lgkmcnt(0)
  s_barrier
  v_add_u32 v10, 92160, v3
  v_add_u32 v11, 92160, v8
  ds_read_b128 v[100:103], v11 offset:0
  ds_read_b128 v[104:107], v11 offset:2048
  ds_read_b128 v[72:75], v10 offset:16384
  ds_read_b128 v[76:79], v10 offset:18432
  ds_read_b128 v[80:83], v10 offset:20480
  ds_read_b128 v[84:87], v10 offset:22528
  ds_read_b128 v[88:91], v10 offset:24576
  ds_read_b128 v[92:95], v10 offset:26624
  ds_read_b128 v[96:99], v10 offset:28672
  v_mfma_f32_16x16x32_bf16 v[16:19], v[108:111], v[136:139], v[16:19]
  v_mfma_f32_16x16x32_bf16 v[44:47], v[108:111], v[140:143], v[44:47]
  v_mfma_f32_16x16x32_bf16 v[20:23], v[112:115], v[136:139], v[20:23]
  v_mfma_f32_16x16x32_bf16 v[48:51], v[112:115], v[140:143], v[48:51]
  v_mfma_f32_16x16x32_bf16 v[24:27], v[116:119], v[136:139], v[24:27]
  v_mfma_f32_16x16x32_bf16 v[52:55], v[116:119], v[140:143], v[52:55]
  v_mfma_f32_16x16x32_bf16 v[28:31], v[120:123], v[136:139], v[28:31]
  v_mfma_f32_16x16x32_bf16 v[56:59], v[120:123], v[140:143], v[56:59]
  v_mfma_f32_16x16x32_bf16 v[32:35], v[124:127], v[136:139], v[32:35]
  v_mfma_f32_16x16x32_bf16 v[60:63], v[124:127], v[140:143], v[60:63]
  v_mfma_f32_16x16x32_bf16 v[36:39], v[128:131], v[136:139], v[36:39]
  v_mfma_f32_16x16x32_bf16 v[64:67], v[128:131], v[140:143], v[64:67]
  v_mfma_f32_16x16x32_bf16 v[40:43], v[132:135], v[136:139], v[40:43]
  v_mfma_f32_16x16x32_bf16 v[68:71], v[132:135], v[140:143], v[68:71]
  v_add_u32 v10, 92160, v14
  v_add_u32 v11, 92160, v9
  ds_read_b128 v[136:139], v11 offset:0
  ds_read_b128 v[140:143], v11 offset:2048
  ds_read_b128 v[108:111], v10 offset:16384
  ds_read_b128 v[112:115], v10 offset:18432
  ds_read_b128 v[116:119], v10 offset:20480
  ds_read_b128 v[120:123], v10 offset:22528
  ds_read_b128 v[124:127], v10 offset:24576
  ds_read_b128 v[128:131], v10 offset:26624
  ds_read_b128 v[132:135], v10 offset:28672
  s_waitcnt lgkmcnt(9)
  v_mfma_f32_16x16x32_bf16 v[16:19], v[72:75], v[100:103], v[16:19]
  v_mfma_f32_16x16x32_bf16 v[44:47], v[72:75], v[104:107], v[44:47]
  v_mfma_f32_16x16x32_bf16 v[20:23], v[76:79], v[100:103], v[20:23]
  v_mfma_f32_16x16x32_bf16 v[48:51], v[76:79], v[104:107], v[48:51]
  v_mfma_f32_16x16x32_bf16 v[24:27], v[80:83], v[100:103], v[24:27]
  v_mfma_f32_16x16x32_bf16 v[52:55], v[80:83], v[104:107], v[52:55]
  v_mfma_f32_16x16x32_bf16 v[28:31], v[84:87], v[100:103], v[28:31]
  v_mfma_f32_16x16x32_bf16 v[56:59], v[84:87], v[104:107], v[56:59]
  v_mfma_f32_16x16x32_bf16 v[32:35], v[88:91], v[100:103], v[32:35]
  v_mfma_f32_16x16x32_bf16 v[60:63], v[88:91], v[104:107], v[60:63]
  v_mfma_f32_16x16x32_bf16 v[36:39], v[92:95], v[100:103], v[36:39]
  v_mfma_f32_16x16x32_bf16 v[64:67], v[92:95], v[104:107], v[64:67]
  v_mfma_f32_16x16x32_bf16 v[40:43], v[96:99], v[100:103], v[40:43]
  v_mfma_f32_16x16x32_bf16 v[68:71], v[96:99], v[104:107], v[68:71]
  s_waitcnt vmcnt(8) lgkmcnt(0)
  s_barrier
  v_add_u32 v10, 0, v3
  v_add_u32 v11, 0, v8
  ds_read_b128 v[100:103], v11 offset:0
  ds_read_b128 v[104:107], v11 offset:2048
  ds_read_b128 v[72:75], v10 offset:16384
  ds_read_b128 v[76:79], v10 offset:18432
  ds_read_b128 v[80:83], v10 offset:20480
  ds_read_b128 v[84:87], v10 offset:22528
  ds_read_b128 v[88:91], v10 offset:24576
  ds_read_b128 v[92:95], v10 offset:26624
  ds_read_b128 v[96:99], v10 offset:28672
  v_mfma_f32_16x16x32_bf16 v[16:19], v[108:111], v[136:139], v[16:19]
  v_mfma_f32_16x16x32_bf16 v[44:47], v[108:111], v[140:143], v[44:47]
  v_mfma_f32_16x16x32_bf16 v[20:23], v[112:115], v[136:139], v[20:23]
  v_mfma_f32_16x16x32_bf16 v[48:51], v[112:115], v[140:143], v[48:51]
  v_mfma_f32_16x16x32_bf16 v[24:27], v[116:119], v[136:139], v[24:27]
  v_mfma_f32_16x16x32_bf16 v[52:55], v[116:119], v[140:143], v[52:55]
  v_mfma_f32_16x16x32_bf16 v[28:31], v[120:123], v[136:139], v[28:31]
  v_mfma_f32_16x16x32_bf16 v[56:59], v[120:123], v[140:143], v[56:59]
  v_mfma_f32_16x16x32_bf16 v[32:35], v[124:127], v[136:139], v[32:35]
  v_mfma_f32_16x16x32_bf16 v[60:63], v[124:127], v[140:143], v[60:63]
  v_mfma_f32_16x16x32_bf16 v[36:39], v[128:131], v[136:139], v[36:39]
  v_mfma_f32_16x16x32_bf16 v[64:67], v[128:131], v[140:143], v[64:67]
  v_mfma_f32_16x16x32_bf16 v[40:43], v[132:135], v[136:139], v[40:43]
  v_mfma_f32_16x16x32_bf16 v[68:71], v[132:135], v[140:143], v[68:71]
  v_add_u32 v10, 0, v14
  v_add_u32 v11, 0, v9
  ds_read_b128 v[136:139], v11 offset:0
  ds_read_b128 v[140:143], v11 offset:2048
  ds_read_b128 v[108:111], v10 offset:16384
  ds_read_b128 v[112:115], v10 offset:18432
  ds_read_b128 v[116:119], v10 offset:20480
  ds_read_b128 v[120:123], v10 offset:22528
  ds_read_b128 v[124:127], v10 offset:24576
  ds_read_b128 v[128:131], v10 offset:26624
  ds_read_b128 v[132:135], v10 offset:28672
  s_waitcnt lgkmcnt(9)
  v_mfma_f32_16x16x32_bf16 v[16:19], v[72:75], v[100:103], v[16:19]
  v_mfma_f32_16x16x32_bf16 v[44:47], v[72:75], v[104:107], v[44:47]
  v_mfma_f32_16x16x32_bf16 v[20:23], v[76:79], v[100:103], v[20:23]
  v_mfma_f32_16x16x32_bf16 v[48:51], v[76:79], v[104:107], v[48:51]
  v_mfma_f32_16x16x32_bf16 v[24:27], v[80:83], v[100:103], v[24:27]
  v_mfma_f32_16x16x32_bf16 v[52:55], v[80:83], v[104:107], v[52:55]
  v_mfma_f32_16x16x32_bf16 v[28:31], v[84:87], v[100:103], v[28:31]
  v_mfma_f32_16x16x32_bf16 v[56:59], v[84:87], v[104:107], v[56:59]
  v_mfma_f32_16x16x32_bf16 v[32:35], v[88:91], v[100:103], v[32:35]
  v_mfma_f32_16x16x32_bf16 v[60:63], v[88:91], v[104:107], v[60:63]
  v_mfma_f32_16x16x32_bf16 v[36:39], v[92:95], v[100:103], v[36:39]
  v_mfma_f32_16x16x32_bf16 v[64:67], v[92:95], v[104:107], v[64:67]
  v_mfma_f32_16x16x32_bf16 v[40:43], v[96:99], v[100:103], v[40:43]
  v_mfma_f32_16x16x32_bf16 v[68:71], v[96:99], v[104:107], v[68:71]
  s_waitcnt vmcnt(0) lgkmcnt(0)
  s_barrier
  v_add_u32 v10, 30720, v3
  v_add_u32 v11, 30720, v8
  ds_read_b128 v[100:103], v11 offset:0
  ds_read_b128 v[104:107], v11 offset:2048
  ds_read_b128 v[72:75], v10 offset:16384
  ds_read_b128 v[76:79], v10 offset:18432
  ds_read_b128 v[80:83], v10 offset:20480
  ds_read_b128 v[84:87], v10 offset:22528
  ds_read_b128 v[88:91], v10 offset:24576
  ds_read_b128 v[92:95], v10 offset:26624
  ds_read_b128 v[96:99], v10 offset:28672
  v_mfma_f32_16x16x32_bf16 v[16:19], v[108:111], v[136:139], v[16:19]
  v_mfma_f32_16x16x32_bf16 v[44:47], v[108:111], v[140:143], v[44:47]
  v_mfma_f32_16x16x32_bf16 v[20:23], v[112:115], v[136:139], v[20:23]
  v_mfma_f32_16x16x32_bf16 v[48:51], v[112:115], v[140:143], v[48:51]
  v_mfma_f32_16x16x32_bf16 v[24:27], v[116:119], v[136:139], v[24:27]
  v_mfma_f32_16x16x32_bf16 v[52:55], v[116:119], v[140:143], v[52:55]
  v_mfma_f32_16x16x32_bf16 v[28:31], v[120:123], v[136:139], v[28:31]
  v_mfma_f32_16x16x32_bf16 v[56:59], v[120:123], v[140:143], v[56:59]
  v_mfma_f32_16x16x32_bf16 v[32:35], v[124:127], v[136:139], v[32:35]
  v_mfma_f32_16x16x32_bf16 v[60:63], v[124:127], v[140:143], v[60:63]
  v_mfma_f32_16x16x32_bf16 v[36:39], v[128:131], v[136:139], v[36:39]
  v_mfma_f32_16x16x32_bf16 v[64:67], v[128:131], v[140:143], v[64:67]
  v_mfma_f32_16x16x32_bf16 v[40:43], v[132:135], v[136:139], v[40:43]
  v_mfma_f32_16x16x32_bf16 v[68:71], v[132:135], v[140:143], v[68:71]
  v_add_u32 v10, 30720, v14
  v_add_u32 v11, 30720, v9
  ds_read_b128 v[136:139], v11 offset:0
  ds_read_b128 v[140:143], v11 offset:2048
  ds_read_b128 v[108:111], v10 offset:16384
  ds_read_b128 v[112:115], v10 offset:18432
  ds_read_b128 v[116:119], v10 offset:20480
  ds_read_b128 v[120:123], v10 offset:22528
  ds_read_b128 v[124:127], v10 offset:24576
  ds_read_b128 v[128:131], v10 offset:26624
  ds_read_b128 v[132:135], v10 offset:28672
  s_waitcnt lgkmcnt(9)
  v_mfma_f32_16x16x32_bf16 v[16:19], v[72:75], v[100:103], v[16:19]
  v_mfma_f32_16x16x32_bf16 v[44:47], v[72:75], v[104:107], v[44:47]
  v_mfma_f32_16x16x32_bf16 v[20:23], v[76:79], v[100:103], v[20:23]
  v_mfma_f32_16x16x32_bf16 v[48:51], v[76:79], v[104:107], v[48:51]
  v_mfma_f32_16x16x32_bf16 v[24:27], v[80:83], v[100:103], v[24:27]
  v_mfma_f32_16x16x32_bf16 v[52:55], v[80:83], v[104:107], v[52:55]
  v_mfma_f32_16x16x32_bf16 v[28:31], v[84:87], v[100:103], v[28:31]
  v_mfma_f32_16x16x32_bf16 v[56:59], v[84:87], v[104:107], v[56:59]
  v_mfma_f32_16x16x32_bf16 v[32:35], v[88:91], v[100:103], v[32:35]
  v_mfma_f32_16x16x32_bf16 v[60:63], v[88:91], v[104:107], v[60:63]
  v_mfma_f32_16x16x32_bf16 v[36:39], v[92:95], v[100:103], v[36:39]
  v_mfma_f32_16x16x32_bf16 v[64:67], v[92:95], v[104:107], v[64:67]
  v_mfma_f32_16x16x32_bf16 v[40:43], v[96:99], v[100:103], v[40:43]
  v_mfma_f32_16x16x32_bf16 v[68:71], v[96:99], v[104:107], v[68:71]
  s_waitcnt lgkmcnt(0)
  v_mfma_f32_16x16x32_bf16 v[16:19], v[108:111], v[136:139], v[16:19]
  v_mfma_f32_16x16x32_bf16 v[44:47], v[108:111], v[140:143], v[44:47]
  v_mfma_f32_16x16x32_bf16 v[20:23], v[112:115], v[136:139], v[20:23]
  v_mfma_f32_16x16x32_bf16 v[48:51], v[112:115], v[140:143], v[48:51]
  v_mfma_f32_16x16x32_bf16 v[24:27], v[116:119], v[136:139], v[24:27]
  v_mfma_f32_16x16x32_bf16 v[52:55], v[116:119], v[140:143], v[52:55]
  v_mfma_f32_16x16x32_bf16 v[28:31], v[120:123], v[136:139], v[28:31]
  v_mfma_f32_16x16x32_bf16 v[56:59], v[120:123], v[140:143], v[56:59]
  v_mfma_f32_16x16x32_bf16 v[32:35], v[124:127], v[136:139], v[32:35]
  v_mfma_f32_16x16x32_bf16 v[60:63], v[124:127], v[140:143], v[60:63]
  v_mfma_f32_16x16x32_bf16 v[36:39], v[128:131], v[136:139], v[36:39]
  v_mfma_f32_16x16x32_bf16 v[64:67], v[128:131], v[140:143], v[64:67]
  v_mfma_f32_16x16x32_bf16 v[40:43], v[132:135], v[136:139], v[40:43]
  v_mfma_f32_16x16x32_bf16 v[68:71], v[132:135], v[140:143], v[68:71]
  s_branch L_k4_join
L_k4_varB:
  v_mov_b32 v7, v2
  s_add_u32 m0, s35, 0
  s_nop 0
  buffer_load_dwordx4 v7, s[12:15], s36 offen lds
  s_add_u32 m0, s35, 4096
  s_nop 0
  buffer_load_dwordx4 v7, s[12:15], s37 offen lds
  s_add_u32 m0, s35, 8192
  s_nop 0
  buffer_load_dwordx4 v7, s[12:15], s38 offen lds
  s_add_u32 m0, s35, 12288
  s_nop 0
  buffer_load_dwordx4 v7, s[12:15], s39 offen lds
  s_add_u32 m0, s35, 16384
  s_nop 0
  buffer_load_dwordx4 v7, s[16:19], s40 offen lds
  s_add_u32 m0, s35, 20480
  s_nop 0
  buffer_load_dwordx4 v7, s[16:19], s41 offen lds
  s_add_u32 m0, s35, 24576
  s_nop 0
  buffer_load_dwordx4 v7, s[16:19], s42 offen lds
  v_add_u32 v7, 128, v2
  s_add_u32 m0, s35, 30720
  s_nop 0
  buffer_load_dwordx4 v7, s[12:15], s36 offen lds
  s_add_u32 m0, s35, 34816
  s_nop 0
  buffer_load_dwordx4 v7, s[12:15], s37 offen lds
  s_add_u32 m0, s35, 38912
  s_nop 0
  buffer_load_dwordx4 v7, s[12:15], s38 offen lds
  s_add_u32 m0, s35, 43008
  s_nop 0
  buffer_load_dwordx4 v7, s[12:15], s39 offen lds
  s_add_u32 m0, s35, 47104
  s_nop 0
  buffer_load_dwordx4 v7, s[16:19], s40 offen lds
  s_add_u32 m0, s35, 51200
  s_nop 0
  buffer_load_dwordx4 v7, s[16:19], s41 offen lds
  s_add_u32 m0, s35, 55296
  s_nop 0
  buffer_load_dwordx4 v7, s[16:19], s42 offen lds
  v_add_u32 v7, 256, v2
  s_add_u32 m0, s35, 61440
  s_nop 0
  buffer_load_dwordx4 v7, s[12:15], s36 offen lds
  s_add_u32 m0, s35, 65536
  s_nop 0
  buffer_load_dwordx4 v7, s[12:15], s37 offen lds
  s_add_u32 m0, s35, 69632
  s_nop 0
  buffer_load_dwordx4 v7, s[12:15], s38 offen lds
  s_add_u32 m0, s35, 73728
  s_nop 0
  buffer_load_dwordx4 v7, s[12:15], s39 offen lds
  s_add_u32 m0, s35, 77824
  s_nop 0
  buffer_load_dwordx4 v7, s[16:19], s40 offen lds
  s_add_u32 m0, s35, 81920
  s_nop 0
  buffer_load_dwordx4 v7, s[16:19], s41 offen lds
  s_add_u32 m0, s35, 86016
  s_nop 0
  buffer_load_dwordx4 v7, s[16:19], s42 offen lds
  v_add_u32 v7, 384, v2
  s_add_u32 m0, s35, 92160
  s_nop 0
  buffer_load_dwordx4 v7, s[12:15], s36 offen lds
  s_add_u32 m0, s35, 96256
  s_nop 0
  buffer_load_dwordx4 v7, s[12:15], s37 offen lds
  s_add_u32 m0, s35, 100352
  s_nop 0
  buffer_load_dwordx4 v7, s[12:15], s38 offen lds
  s_add_u32 m0, s35, 104448
  s_nop 0
  buffer_load_dwordx4 v7, s[12:15], s39 offen lds
  s_add_u32 m0, s35, 108544
  s_nop 0
  buffer_load_dwordx4 v7, s[16:19], s40 offen lds
  s_add_u32 m0, s35, 112640
  s_nop 0
  buffer_load_dwordx4 v7, s[16:19], s41 offen lds
  s_add_u32 m0, s35, 116736
  s_nop 0
  buffer_load_dwordx4 v7, s[16:19], s42 offen lds
  s_waitcnt vmcnt(21)
  s_barrier
  v_add_u32 v10, 0, v3
  v_add_u32 v11, 0, v8
  ds_read_b128 v[100:103], v11 offset:0
  ds_read_b128 v[104:107], v11 offset:2048
  ds_read_b128 v[72:75], v10 offset:16384
  ds_read_b128 v[76:79], v10 offset:18432
  ds_read_b128 v[80:83], v10 offset:20480
  ds_read_b128 v[84:87], v10 offset:22528
  ds_read_b128 v[88:91], v10 offset:24576
  ds_read_b128 v[92:95], v10 offset:26624
  ds_read_b128 v[96:99], v10 offset:28672
  v_add_u32 v10, 0, v14
  v_add_u32 v11, 0, v9
  ds_read_b128 v[136:139], v11 offset:0
  ds_read_b128 v[140:143], v11 offset:2048
  ds_read_b128 v[108:111], v10 offset:16384
  ds_read_b128 v[112:115], v10 offset:18432
  ds_read_b128 v[116:119], v10 offset:20480
  ds_read_b128 v[120:123], v10 offset:22528
  ds_read_b128 v[124:127], v10 offset:24576
  ds_read_b128 v[128:131], v10 offset:26624
  ds_read_b128 v[132:135], v10 offset:28672
  s_waitcnt lgkmcnt(9)
  v_mfma_f32_16x16x32_bf16 v[16:19], v[72:75], v[100:103], v[16:19]
  v_mfma_f32_16x16x32_bf16 v[44:47], v[72:75], v[104:107], v[44:47]
  v_mfma_f32_16x16x32_bf16 v[20:23], v[76:79], v[100:103], v[20:23]
  v_mfma_f32_16x16x32_bf16 v[48:51], v[76:79], v[104:107], v[48:51]
  v_mfma_f32_16x16x32_bf16 v[24:27], v[80:83], v[100:103], v[24:27]
  v_mfma_f32_16x16x32_bf16 v[52:55], v[80:83], v[104:107], v[52:55]
  v_mfma_f32_16x16x32_bf16 v[28:31], v[84:87], v[100:103], v[28:31]
  v_mfma_f32_16x16x32_bf16 v[56:59], v[84:87], v[104:107], v[56:59]
  v_mfma_f32_16x16x32_bf16 v[32:35], v[88:91], v[100:103], v[32:35]
  v_mfma_f32_16x16x32_bf16 v[60:63], v[88:91], v[104:107], v[60:63]
  v_mfma_f32_16x16x32_bf16 v[36:39], v[92:95], v[100:103], v[36:39]
  v_mfma_f32_16x16x32_bf16 v[64:67], v[92:95], v[104:107], v[64:67]
  v_mfma_f32_16x16x32_bf16 v[40:43], v[96:99], v[100:103], v[40:43]
  v_mfma_f32_16x16x32_bf16 v[68:71], v[96:99], v[104:107], v[68:71]
  s_waitcnt vmcnt(14) lgkmcnt(0)
  s_barrier
  v_add_u32 v7, 512, v2
  s_add_u32 m0, s35, 0
  s_nop 0
  buffer_load_dwordx4 v7, s[12:15], s36 offen lds
  s_add_u32 m0, s35, 4096
  s_nop 0
  buffer_load_dwordx4 v7, s[12:15], s37 offen lds
  s_add_u32 m0, s35, 8192
  s_nop 0
  buffer_load_dwordx4 v7, s[12:15], s38 offen lds
  s_add_u32 m0, s35, 12288
  s_nop 0
  buffer_load_dwordx4 v7, s[12:15], s39 offen lds
  s_add_u32 m0, s35, 16384
  s_nop 0
  buffer_load_dwordx4 v7, s[16:19], s40 offen lds
  s_add_u32 m0, s35, 20480
  s_nop 0
  buffer_load_dwordx4 v7, s[16:19], s41 offen lds
  s_add_u32 m0, s35, 24576
  s_nop 0
  buffer_load_dwordx4 v7, s[16:19], s42 offen lds
  v_add_u32 v10, 30720, v3
  v_add_u32 v11, 30720, v8
  ds_read_b128 v[100:103], v11 offset:0
  ds_read_b128 v[104:107], v11 offset:2048
  ds_read_b128 v[72:75], v10 offset:16384
  ds_read_b128 v[76:79], v10 offset:18432
  ds_read_b128 v[80:83], v10 offset:20480
  ds_read_b128 v[84:87], v10 offset:22528
  ds_read_b128 v[88:91], v10 offset:24576
  ds_read_b128 v[92:95], v10 offset:26624
  ds_read_b128 v[96:99], v10 offset:28672
  v_mfma_f32_16x16x32_bf16 v[16:19], v[108:111], v[136:139], v[16:19]
  v_mfma_f32_16x16x32_bf16 v[44:47], v[108:111], v[140:143], v[44:47]
  v_mfma_f32_16x16x32_bf16 v[20:23], v[112:115], v[136:139], v[20:23]
  v_mfma_f32_16x16x32_bf16 v[48:51], v[112:115], v[140:143], v[48:51]
  v_mfma_f32_16x16x32_bf16 v[24:27], v[116:119], v[136:139], v[24:27]
  v_mfma_f32_16x16x32_bf16 v[52:55], v[116:119], v[140:143], v[52:55]
  v_mfma_f32_16x16x32_bf16 v[28:31], v[120:123], v[136:139], v[28:31]
  v_mfma_f32_16x16x32_bf16 v[56:59], v[120:123], v[140:143], v[56:59]
  v_mfma_f32_16x16x32_bf16 v[32:35], v[124:127], v[136:139], v[32:35]
  v_mfma_f32_16x16x32_bf16 v[60:63], v[124:127], v[140:143], v[60:63]
  v_mfma_f32_16x16x32_bf16 v[36:39], v[128:131], v[136:139], v[36:39]
  v_mfma_f32_16x16x32_bf16 v[64:67], v[128:131], v[140:143], v[64:67]
  v_mfma_f32_16x16x32_bf16 v[40:43], v[132:135], v[136:139], v[40:43]
  v_mfma_f32_16x16x32_bf16 v[68:71], v[132:135], v[140:143], v[68:71]
  v_add_u32 v10, 30720, v14
  v_add_u32 v11, 30720, v9
  ds_read_b128 v[136:139], v11 offset:0
  ds_read_b128 v[140:143], v11 offset:2048
  ds_read_b128 v[108:111], v10 offset:16384
  ds_read_b128 v[112:115], v10 offset:18432
  ds_read_b128 v[116:119], v10 offset:20480
  ds_read_b128 v[120:123], v10 offset:22528
  ds_read_b128 v[124:127], v10 offset:24576
  ds_read_b128 v[128:131], v10 offset:26624
  ds_read_b128 v[132:135], v10 offset:28672
  s_waitcnt lgkmcnt(9)
  v_mfma_f32_16x16x32_bf16 v[16:19], v[72:75], v[100:103], v[16:19]
  v_mfma_f32_16x16x32_bf16 v[44:47], v[72:75], v[104:107], v[44:47]
  v_mfma_f32_16x16x32_bf16 v[20:23], v[76:79], v[100:103], v[20:23]
  v_mfma_f32_16x16x32_bf16 v[48:51], v[76:79], v[104:107], v[48:51]
  v_mfma_f32_16x16x32_bf16 v[24:27], v[80:83], v[100:103], v[24:27]
  v_mfma_f32_16x16x32_bf16 v[52:55], v[80:83], v[104:107], v[52:55]
  v_mfma_f32_16x16x32_bf16 v[28:31], v[84:87], v[100:103], v[28:31]
  v_mfma_f32_16x16x32_bf16 v[56:59], v[84:87], v[104:107], v[56:59]
  v_mfma_f32_16x16x32_bf16 v[32:35], v[88:91], v[100:103], v[32:35]
  v_mfma_f32_16x16x32_bf16 v[60:63], v[88:91], v[104:107], v[60:63]
  v_mfma_f32_16x16x32_bf16 v[36:39], v[92:95], v[100:103], v[36:39]
  v_mfma_f32_16x16x32_bf16 v[64:67], v[92:95], v[104:107], v[64:67]
  v_mfma_f32_16x16x32_bf16 v[40:43], v[96:99], v[100:103], v[40:43]
  v_mfma_f32_16x16x32_bf16 v[68:71], v[96:99], v[104:107], v[68:71]
  s_waitcnt vmcnt(14) lgkmcnt(0)
  s_barrier
  v_add_u32 v7, 640, v2
  s_add_u32 m0, s35, 30720
  s_nop 0
  buffer_load_dwordx4 v7, s[12:15], s36 offen lds
  s_add_u32 m0, s35, 34816
  s_nop 0
  buffer_load_dwordx4 v7, s[12:15], s37 offen lds
  s_add_u32 m0, s35, 38912
  s_nop 0
  buffer_load_dwordx4 v7, s[12:15], s38 offen lds
  s_add_u32 m0, s35, 43008
  s_nop 0
  buffer_load_dwordx4 v7, s[12:15], s39 offen lds
  s_add_u32 m0, s35, 47104
  s_nop 0
  buffer_load_dwordx4 v7, s[16:19], s40 offen lds
  s_add_u32 m0, s35, 51200
  s_nop 0
  buffer_load_dwordx4 v7, s[16:19], s41 offen lds
  s_add_u32 m0, s35, 55296
  s_nop 0
  buffer_load_dwordx4 v7, s[16:19], s42 offen lds
  v_add_u32 v10, 61440, v3
  v_add_u32 v11, 61440, v8
  ds_read_b128 v[100:103], v11 offset:0
  ds_read_b128 v[104:107], v11 offset:2048
  ds_read_b128 v[72:75], v10 offset:16384
  ds_read_b128 v[76:79], v10 offset:18432
  ds_read_b128 v[80:83], v10 offset:20480
  ds_read_b128 v[84:87], v10 offset:22528
  ds_read_b128 v[88:91], v10 offset:24576
  ds_read_b128 v[92:95], v10 offset:26624
  ds_read_b128 v[96:99], v10 offset:28672
  v_mfma_f32_16x16x32_bf16 v[16:19], v[108:111], v[136:139], v[16:19]
  v_mfma_f32_16x16x32_bf16 v[44:47], v[108:111], v[140:143], v[44:47]
  v_mfma_f32_16x16x32_bf16 v[20:23], v[112:115], v[136:139], v[20:23]
  v_mfma_f32_16x16x32_bf16 v[48:51], v[112:115], v[140:143], v[48:51]
  v_mfma_f32_16x16x32_bf16 v[24:27], v[116:119], v[136:139], v[24:27]
  v_mfma_f32_16x16x32_bf16 v[52:55], v[116:119], v[140:143], v[52:55]
  v_mfma_f32_16x16x32_bf16 v[28:31], v[120:123], v[136:139], v[28:31]
  v_mfma_f32_16x16x32_bf16 v[56:59], v[120:123], v[140:143], v[56:59]
  v_mfma_f32_16x16x32_bf16 v[32:35], v[124:127], v[136:139], v[32:35]
  v_mfma_f32_16x16x32_bf16 v[60:63], v[124:127], v[140:143], v[60:63]
  v_mfma_f32_16x16x32_bf16 v[36:39], v[128:131], v[136:139], v[36:39]
  v_mfma_f32_16x16x32_bf16 v[64:67], v[128:131], v[140:143], v[64:67]
  v_mfma_f32_16x16x32_bf16 v[40:43], v[132:135], v[136:139], v[40:43]
  v_mfma_f32_16x16x32_bf16 v[68:71], v[132:135], v[140:143], v[68:71]
  v_add_u32 v10, 61440, v14
  v_add_u32 v11, 61440, v9
  ds_read_b128 v[136:139], v11 offset:0
  ds_read_b128 v[140:143], v11 offset:2048
  ds_read_b128 v[108:111], v10 offset:16384
  ds_read_b128 v[112:115], v10 offset:18432
  ds_read_b128 v[116:119], v10 offset:20480
  ds_read_b128 v[120:123], v10 offset:22528
  ds_read_b128 v[124:127], v10 offset:24576
  ds_read_b128 v[128:131], v10 offset:26624
  ds_read_b128 v[132:135], v10 offset:28672
  s_waitcnt lgkmcnt(9)
  v_mfma_f32_16x16x32_bf16 v[16:19], v[72:75], v[100:103], v[16:19]
  v_mfma_f32_16x16x32_bf16 v[44:47], v[72:75], v[104:107], v[44:47]
  v_mfma_f32_16x16x32_bf16 v[20:23], v[76:79], v[100:103], v[20:23]
  v_mfma_f32_16x16x32_bf16 v[48:51], v[76:79], v[104:107], v[48:51]
  v_mfma_f32_16x16x32_bf16 v[24:27], v[80:83], v[100:103], v[24:27]
  v_mfma_f32_16x16x32_bf16 v[52:55], v[80:83], v[104:107], v[52:55]
  v_mfma_f32_16x16x32_bf16 v[28:31], v[84:87], v[100:103], v[28:31]
  v_mfma_f32_16x16x32_bf16 v[56:59], v[84:87], v[104:107], v[56:59]
  v_mfma_f32_16x16x32_bf16 v[32:35], v[88:91], v[100:103], v[32:35]
  v_mfma_f32_16x16x32_bf16 v[60:63], v[88:91], v[104:107], v[60:63]
  v_mfma_f32_16x16x32_bf16 v[36:39], v[92:95], v[100:103], v[36:39]
  v_mfma_f32_16x16x32_bf16 v[64:67], v[92:95], v[104:107], v[64:67]
  v_mfma_f32_16x16x32_bf16 v[40:43], v[96:99], v[100:103], v[40:43]
  v_mfma_f32_16x16x32_bf16 v[68:71], v[96:99], v[104:107], v[68:71]
  s_waitcnt vmcnt(14) lgkmcnt(0)
  s_barrier
  v_add_u32 v7, 768, v2
  s_add_u32 m0, s35, 61440
  s_nop 0
  buffer_load_dwordx4 v7, s[12:15], s36 offen lds
  s_add_u32 m0, s35, 65536
  s_nop 0
  buffer_load_dwordx4 v7, s[12:15], s37 offen lds
  s_add_u32 m0, s35, 69632
  s_nop 0
  buffer_load_dwordx4 v7, s[12:15], s38 offen lds
  s_add_u32 m0, s35, 73728
  s_nop 0
  buffer_load_dwordx4 v7, s[12:15], s39 offen lds
  s_add_u32 m0, s35, 77824
  s_nop 0
  buffer_load_dwordx4 v7, s[16:19], s40 offen lds
  s_add_u32 m0, s35, 81920
  s_nop 0
  buffer_load_dwordx4 v7, s[16:19], s41 offen lds
  s_add_u32 m0, s35, 86016
  s_nop 0
  buffer_load_dwordx4 v7, s[16:19], s42 offen lds
  v_add_u32 v10, 92160, v3
  v_add_u32 v11, 92160, v8
  ds_read_b128 v[100:103], v11 offset:0
  ds_read_b128 v[104:107], v11 offset:2048
  ds_read_b128 v[72:75], v10 offset:16384
  ds_read_b128 v[76:79], v10 offset:18432
  ds_read_b128 v[80:83], v10 offset:20480
  ds_read_b128 v[84:87], v10 offset:22528
  ds_read_b128 v[88:91], v10 offset:24576
  ds_read_b128 v[92:95], v10 offset:26624
  ds_read_b128 v[96:99], v10 offset:28672
  v_mfma_f32_16x16x32_bf16 v[16:19], v[108:111], v[136:139], v[16:19]
  v_mfma_f32_16x16x32_bf16 v[44:47], v[108:111], v[140:143], v[44:47]
  v_mfma_f32_16x16x32_bf16 v[20:23], v[112:115], v[136:139], v[20:23]
  v_mfma_f32_16x16x32_bf16 v[48:51], v[112:115], v[140:143], v[48:51]
  v_mfma_f32_16x16x32_bf16 v[24:27], v[116:119], v[136:139], v[24:27]
  v_mfma_f32_16x16x32_bf16 v[52:55], v[116:119], v[140:143], v[52:55]
  v_mfma_f32_16x16x32_bf16 v[28:31], v[120:123], v[136:139], v[28:31]
  v_mfma_f32_16x16x32_bf16 v[56:59], v[120:123], v[140:143], v[56:59]
  v_mfma_f32_16x16x32_bf16 v[32:35], v[124:127], v[136:139], v[32:35]
  v_mfma_f32_16x16x32_bf16 v[60:63], v[124:127], v[140:143], v[60:63]
  v_mfma_f32_16x16x32_bf16 v[36:39], v[128:131], v[136:139], v[36:39]
  v_mfma_f32_16x16x32_bf16 v[64:67], v[128:131], v[140:143], v[64:67]
  v_mfma_f32_16x16x32_bf16 v[40:43], v[132:135], v[136:139], v[40:43]
  v_mfma_f32_16x16x32_bf16 v[68:71], v[132:135], v[140:143], v[68:71]
  v_add_u32 v10, 92160, v14
  v_add_u32 v11, 92160, v9
  ds_read_b128 v[136:139], v11 offset:0
  ds_read_b128 v[140:143], v11 offset:2048
  ds_read_b128 v[108:111], v10 offset:16384
  ds_read_b128 v[112:115], v10 offset:18432
  ds_read_b128 v[116:119], v10 offset:20480
  ds_read_b128 v[120:123], v10 offset:22528
  ds_read_b128 v[124:127], v10 offset:24576
  ds_read_b128 v[128:131], v10 offset:26624
  ds_read_b128 v[132:135], v10 offset:28672
  s_waitcnt lgkmcnt(9)
  v_mfma_f32_16x16x32_bf16 v[16:19], v[72:75], v[100:103], v[16:19]
  v_mfma_f32_16x16x32_bf16 v[44:47], v[72:75], v[104:107], v[44:47]
  v_mfma_f32_16x16x32_bf16 v[20:23], v[76:79], v[100:103], v[20:23]
  v_mfma_f32_16x16x32_bf16 v[48:51], v[76:79], v[104:107], v[48:51]
  v_mfma_f32_16x16x32_bf16 v[24:27], v[80:83], v[100:103], v[24:27]
  v_mfma_f32_16x16x32_bf16 v[52:55], v[80:83], v[104:107], v[52:55]
  v_mfma_f32_16x16x32_bf16 v[28:31], v[84:87], v[100:103], v[28:31]
  v_mfma_f32_16x16x32_bf16 v[56:59], v[84:87], v[104:107], v[56:59]
  v_mfma_f32_16x16x32_bf16 v[32:35], v[88:91], v[100:103], v[32:35]
  v_mfma_f32_16x16x32_bf16 v[60:63], v[88:91], v[104:107], v[60:63]
  v_mfma_f32_16x16x32_bf16 v[36:39], v[92:95], v[100:103], v[36:39]
  v_mfma_f32_16x16x32_bf16 v[64:67], v[92:95], v[104:107], v[64:67]
  v_mfma_f32_16x16x32_bf16 v[40:43], v[96:99], v[100:103], v[40:43]
  v_mfma_f32_16x16x32_bf16 v[68:71], v[96:99], v[104:107], v[68:71]
  s_waitcnt vmcnt(14) lgkmcnt(0)
  s_barrier
  v_add_u32 v7, 896, v2
  s_add_u32 m0, s35, 92160
  s_nop 0
  buffer_load_dwordx4 v7, s[12:15], s36 offen lds
  s_add_u32 m0, s35, 96256
  s_nop 0
  buffer_load_dwordx4 v7, s[12:15], s37 offen lds
  s_add_u32 m0, s35, 100352
  s_nop 0
  buffer_load_dwordx4 v7, s[12:15], s38 offen lds
  s_add_u32 m0, s35, 104448
  s_nop 0
  buffer_load_dwordx4 v7, s[12:15], s39 offen lds
  s_add_u32 m0, s35, 108544
  s_nop 0
  buffer_load_dwordx4 v7, s[16:19], s40 offen lds
  s_add_u32 m0, s35, 112640
  s_nop 0
  buffer_load_dwordx4 v7, s[16:19], s41 offen lds
  s_add_u32 m0, s35, 116736
  s_nop 0
  buffer_load_dwordx4 v7, s[16:19], s42 offen lds
  v_add_u32 v10, 0, v3
  v_add_u32 v11, 0, v8
  ds_read_b128 v[100:103], v11 offset:0
  ds_read_b128 v[104:107], v11 offset:2048
  ds_read_b128 v[72:75], v10 offset:16384
  ds_read_b128 v[76:79], v10 offset:18432
  ds_read_b128 v[80:83], v10 offset:20480
  ds_read_b128 v[84:87], v10 offset:22528
  ds_read_b128 v[88:91], v10 offset:24576
  ds_read_b128 v[92:95], v10 offset:26624
  ds_read_b128 v[96:99], v10 offset:28672
  v_mfma_f32_16x16x32_bf16 v[16:19], v[108:111], v[136:139], v[16:19]
  v_mfma_f32_16x16x32_bf16 v[44:47], v[108:111], v[140:143], v[44:47]
  v_mfma_f32_16x16x32_bf16 v[20:23], v[112:115], v[136:139], v[20:23]
  v_mfma_f32_16x16x32_bf16 v[48:51], v[112:115], v[140:143], v[48:51]
  v_mfma_f32_16x16x32_bf16 v[24:27], v[116:119], v[136:139], v[24:27]
  v_mfma_f32_16x16x32_bf16 v[52:55], v[116:119], v[140:143], v[52:55]
  v_mfma_f32_16x16x32_bf16 v[28:31], v[120:123], v[136:139], v[28:31]
  v_mfma_f32_16x16x32_bf16 v[56:59], v[120:123], v[140:143], v[56:59]
  v_mfma_f32_16x16x32_bf16 v[32:35], v[124:127], v[136:139], v[32:35]
  v_mfma_f32_16x16x32_bf16 v[60:63], v[124:127], v[140:143], v[60:63]
  v_mfma_f32_16x16x32_bf16 v[36:39], v[128:131], v[136:139], v[36:39]
  v_mfma_f32_16x16x32_bf16 v[64:67], v[128:131], v[140:143], v[64:67]
  v_mfma_f32_16x16x32_bf16 v[40:43], v[132:135], v[136:139], v[40:43]
  v_mfma_f32_16x16x32_bf16 v[68:71], v[132:135], v[140:143], v[68:71]
  v_add_u32 v10, 0, v14
  v_add_u32 v11, 0, v9
  ds_read_b128 v[136:139], v11 offset:0
  ds_read_b128 v[140:143], v11 offset:2048
  ds_read_b128 v[108:111], v10 offset:16384
  ds_read_b128 v[112:115], v10 offset:18432
  ds_read_b128 v[116:119], v10 offset:20480
  ds_read_b128 v[120:123], v10 offset:22528
  ds_read_b128 v[124:127], v10 offset:24576
  ds_read_b128 v[128:131], v10 offset:26624
  ds_read_b128 v[132:135], v10 offset:28672
  s_waitcnt lgkmcnt(9)
  v_mfma_f32_16x16x32_bf16 v[16:19], v[72:75], v[100:103], v[16:19]
  v_mfma_f32_16x16x32_bf16 v[44:47], v[72:75], v[104:107], v[44:47]
  v_mfma_f32_16x16x32_bf16 v[20:23], v[76:79], v[100:103], v[20:23]
  v_mfma_f32_16x16x32_bf16 v[48:51], v[76:79], v[104:107], v[48:51]
  v_mfma_f32_16x16x32_bf16 v[24:27], v[80:83], v[100:103], v[24:27]
  v_mfma_f32_16x16x32_bf16 v[52:55], v[80:83], v[104:107], v[52:55]
  v_mfma_f32_16x16x32_bf16 v[28:31], v[84:87], v[100:103], v[28:31]
  v_mfma_f32_16x16x32_bf16 v[56:59], v[84:87], v[104:107], v[56:59]
  v_mfma_f32_16x16x32_bf16 v[32:35], v[88:91], v[100:103], v[32:35]
  v_mfma_f32_16x16x32_bf16 v[60:63], v[88:91], v[104:107], v[60:63]
  v_mfma_f32_16x16x32_bf16 v[36:39], v[92:95], v[100:103], v[36:39]
  v_mfma_f32_16x16x32_bf16 v[64:67], v[92:95], v[104:107], v[64:67]
  v_mfma_f32_16x16x32_bf16 v[40:43], v[96:99], v[100:103], v[40:43]
  v_mfma_f32_16x16x32_bf16 v[68:71], v[96:99], v[104:107], v[68:71]
  s_waitcnt vmcnt(14) lgkmcnt(0)
  s_barrier
  v_add_u32 v7, 1024, v2
  s_add_u32 m0, s35, 0
  s_nop 0
  buffer_load_dwordx4 v7, s[12:15], s36 offen lds
  s_add_u32 m0, s35, 4096
  s_nop 0
  buffer_load_dwordx4 v7, s[12:15], s37 offen lds
  s_add_u32 m0, s35, 8192
  s_nop 0
  buffer_load_dwordx4 v7, s[12:15], s38 offen lds
  s_add_u32 m0, s35, 12288
  s_nop 0
  buffer_load_dwordx4 v7, s[12:15], s39 offen lds
  s_add_u32 m0, s35, 16384
  s_nop 0
  buffer_load_dwordx4 v7, s[16:19], s40 offen lds
  s_add_u32 m0, s35, 20480
  s_nop 0
  buffer_load_dwordx4 v7, s[16:19], s41 offen lds
  s_add_u32 m0, s35, 24576
  s_nop 0
  buffer_load_dwordx4 v7, s[16:19], s42 offen lds
  v_add_u32 v10, 30720, v3
  v_add_u32 v11, 30720, v8
  ds_read_b128 v[100:103], v11 offset:0
  ds_read_b128 v[104:107], v11 offset:2048
  ds_read_b128 v[72:75], v10 offset:16384
  ds_read_b128 v[76:79], v10 offset:18432
  ds_read_b128 v[80:83], v10 offset:20480
  ds_read_b128 v[84:87], v10 offset:22528
  ds_read_b128 v[88:91], v10 offset:24576
  ds_read_b128 v[92:95], v10 offset:26624
  ds_read_b128 v[96:99], v10 offset:28672
  v_mfma_f32_16x16x32_bf16 v[16:19], v[108:111], v[136:139], v[16:19]
  v_mfma_f32_16x16x32_bf16 v[44:47], v[108:111], v[140:143], v[44:47]
  v_mfma_f32_16x16x32_bf16 v[20:23], v[112:115], v[136:139], v[20:23]
  v_mfma_f32_16x16x32_bf16 v[48:51], v[112:115], v[140:143], v[48:51]
  v_mfma_f32_16x16x32_bf16 v[24:27], v[116:119], v[136:139], v[24:27]
  v_mfma_f32_16x16x32_bf16 v[52:55], v[116:119], v[140:143], v[52:55]
  v_mfma_f32_16x16x32_bf16 v[28:31], v[120:123], v[136:139], v[28:31]
  v_mfma_f32_16x16x32_bf16 v[56:59], v[120:123], v[140:143], v[56:59]
  v_mfma_f32_16x16x32_bf16 v[32:35], v[124:127], v[136:139], v[32:35]
  v_mfma_f32_16x16x32_bf16 v[60:63], v[124:127], v[140:143], v[60:63]
  v_mfma_f32_16x16x32_bf16 v[36:39], v[128:131], v[136:139], v[36:39]
  v_mfma_f32_16x16x32_bf16 v[64:67], v[128:131], v[140:143], v[64:67]
  v_mfma_f32_16x16x32_bf16 v[40:43], v[132:135], v[136:139], v[40:43]
  v_mfma_f32_16x16x32_bf16 v[68:71], v[132:135], v[140:143], v[68:71]
  v_add_u32 v10, 30720, v14
  v_add_u32 v11, 30720, v9
  ds_read_b128 v[136:139], v11 offset:0
  ds_read_b128 v[140:143], v11 offset:2048
  ds_read_b128 v[108:111], v10 offset:16384
  ds_read_b128 v[112:115], v10 offset:18432
  ds_read_b128 v[116:119], v10 offset:20480
  ds_read_b128 v[120:123], v10 offset:22528
  ds_read_b128 v[124:127], v10 offset:24576
  ds_read_b128 v[128:131], v10 offset:26624
  ds_read_b128 v[132:135], v10 offset:28672
  s_waitcnt lgkmcnt(9)
  v_mfma_f32_16x16x32_bf16 v[16:19], v[72:75], v[100:103], v[16:19]
  v_mfma_f32_16x16x32_bf16 v[44:47], v[72:75], v[104:107], v[44:47]
  v_mfma_f32_16x16x32_bf16 v[20:23], v[76:79], v[100:103], v[20:23]
  v_mfma_f32_16x16x32_bf16 v[48:51], v[76:79], v[104:107], v[48:51]
  v_mfma_f32_16x16x32_bf16 v[24:27], v[80:83], v[100:103], v[24:27]
  v_mfma_f32_16x16x32_bf16 v[52:55], v[80:83], v[104:107], v[52:55]
  v_mfma_f32_16x16x32_bf16 v[28:31], v[84:87], v[100:103], v[28:31]
  v_mfma_f32_16x16x32_bf16 v[56:59], v[84:87], v[104:107], v[56:59]
  v_mfma_f32_16x16x32_bf16 v[32:35], v[88:91], v[100:103], v[32:35]
  v_mfma_f32_16x16x32_bf16 v[60:63], v[88:91], v[104:107], v[60:63]
  v_mfma_f32_16x16x32_bf16 v[36:39], v[92:95], v[100:103], v[36:39]
  v_mfma_f32_16x16x32_bf16 v[64:67], v[92:95], v[104:107], v[64:67]
  v_mfma_f32_16x16x32_bf16 v[40:43], v[96:99], v[100:103], v[40:43]
  v_mfma_f32_16x16x32_bf16 v[68:71], v[96:99], v[104:107], v[68:71]
  s_waitcnt vmcnt(14) lgkmcnt(0)
  s_barrier
  v_add_u32 v7, 1152, v2
  s_add_u32 m0, s35, 30720
  s_nop 0
  buffer_load_dwordx4 v7, s[12:15], s36 offen lds
  s_add_u32 m0, s35, 34816
  s_nop 0
  buffer_load_dwordx4 v7, s[12:15], s37 offen lds
  s_add_u32 m0, s35, 38912
  s_nop 0
  buffer_load_dwordx4 v7, s[12:15], s38 offen lds
  s_add_u32 m0, s35, 43008
  s_nop 0
  buffer_load_dwordx4 v7, s[12:15], s39 offen lds
  s_add_u32 m0, s35, 47104
  s_nop 0
  buffer_load_dwordx4 v7, s[16:19], s40 offen lds
  s_add_u32 m0, s35, 51200
  s_nop 0
  buffer_load_dwordx4 v7, s[16:19], s41 offen lds
  s_add_u32 m0, s35, 55296
  s_nop 0
  buffer_load_dwordx4 v7, s[16:19], s42 offen lds
  v_add_u32 v10, 61440, v3
  v_add_u32 v11, 61440, v8
  ds_read_b128 v[100:103], v11 offset:0
  ds_read_b128 v[104:107], v11 offset:2048
  ds_read_b128 v[72:75], v10 offset:16384
  ds_read_b128 v[76:79], v10 offset:18432
  ds_read_b128 v[80:83], v10 offset:20480
  ds_read_b128 v[84:87], v10 offset:22528
  ds_read_b128 v[88:91], v10 offset:24576
  ds_read_b128 v[92:95], v10 offset:26624
  ds_read_b128 v[96:99], v10 offset:28672
  v_mfma_f32_16x16x32_bf16 v[16:19], v[108:111], v[136:139], v[16:19]
  v_mfma_f32_16x16x32_bf16 v[44:47], v[108:111], v[140:143], v[44:47]
  v_mfma_f32_16x16x32_bf16 v[20:23], v[112:115], v[136:139], v[20:23]
  v_mfma_f32_16x16x32_bf16 v[48:51], v[112:115], v[140:143], v[48:51]
  v_mfma_f32_16x16x32_bf16 v[24:27], v[116:119], v[136:139], v[24:27]
  v_mfma_f32_16x16x32_bf16 v[52:55], v[116:119], v[140:143], v[52:55]
  v_mfma_f32_16x16x32_bf16 v[28:31], v[120:123], v[136:139], v[28:31]
  v_mfma_f32_16x16x32_bf16 v[56:59], v[120:123], v[140:143], v[56:59]
  v_mfma_f32_16x16x32_bf16 v[32:35], v[124:127], v[136:139], v[32:35]
  v_mfma_f32_16x16x32_bf16 v[60:63], v[124:127], v[140:143], v[60:63]
  v_mfma_f32_16x16x32_bf16 v[36:39], v[128:131], v[136:139], v[36:39]
  v_mfma_f32_16x16x32_bf16 v[64:67], v[128:131], v[140:143], v[64:67]
  v_mfma_f32_16x16x32_bf16 v[40:43], v[132:135], v[136:139], v[40:43]
  v_mfma_f32_16x16x32_bf16 v[68:71], v[132:135], v[140:143], v[68:71]
  v_add_u32 v10, 61440, v14
  v_add_u32 v11, 61440, v9
  ds_read_b128 v[136:139], v11 offset:0
  ds_read_b128 v[140:143], v11 offset:2048
  ds_read_b128 v[108:111], v10 offset:16384
  ds_read_b128 v[112:115], v10 offset:18432
  ds_read_b128 v[116:119], v10 offset:20480
  ds_read_b128 v[120:123], v10 offset:22528
  ds_read_b128 v[124:127], v10 offset:24576
  ds_read_b128 v[128:131], v10 offset:26624
  ds_read_b128 v[132:135], v10 offset:28672
  s_waitcnt lgkmcnt(9)
  v_mfma_f32_16x16x32_bf16 v[16:19], v[72:75], v[100:103], v[16:19]
  v_mfma_f32_16x16x32_bf16 v[44:47], v[72:75], v[104:107], v[44:47]
  v_mfma_f32_16x16x32_bf16 v[20:23], v[76:79], v[100:103], v[20:23]
  v_mfma_f32_16x16x32_bf16 v[48:51], v[76:79], v[104:107], v[48:51]
  v_mfma_f32_16x16x32_bf16 v[24:27], v[80:83], v[100:103], v[24:27]
  v_mfma_f32_16x16x32_bf16 v[52:55], v[80:83], v[104:107], v[52:55]
  v_mfma_f32_16x16x32_bf16 v[28:31], v[84:87], v[100:103], v[28:31]
  v_mfma_f32_16x16x32_bf16 v[56:59], v[84:87], v[104:107], v[56:59]
  v_mfma_f32_16x16x32_bf16 v[32:35], v[88:91], v[100:103], v[32:35]
  v_mfma_f32_16x16x32_bf16 v[60:63], v[88:91], v[104:107], v[60:63]
  v_mfma_f32_16x16x32_bf16 v[36:39], v[92:95], v[100:103], v[36:39]
  v_mfma_f32_16x16x32_bf16 v[64:67], v[92:95], v[104:107], v[64:67]
  v_mfma_f32_16x16x32_bf16 v[40:43], v[96:99], v[100:103], v[40:43]
  v_mfma_f32_16x16x32_bf16 v[68:71], v[96:99], v[104:107], v[68:71]
  s_waitcnt vmcnt(14) lgkmcnt(0)
  s_barrier
  v_add_u32 v10, 92160, v3
  v_add_u32 v11, 92160, v8
  ds_read_b128 v[100:103], v11 offset:0
  ds_read_b128 v[104:107], v11 offset:2048
  ds_read_b128 v[72:75], v10 offset:16384
  ds_read_b128 v[76:79], v10 offset:18432
  ds_read_b128 v[80:83], v10 offset:20480
  ds_read_b128 v[84:87], v10 offset:22528
  ds_read_b128 v[88:91], v10 offset:24576
  ds_read_b128 v[92:95], v10 offset:26624
  ds_read_b128 v[96:99], v10 offset:28672
  v_mfma_f32_16x16x32_bf16 v[16:19], v[108:111], v[136:139], v[16:19]
  v_mfma_f32_16x16x32_bf16 v[44:47], v[108:111], v[140:143], v[44:47]
  v_mfma_f32_16x16x32_bf16 v[20:23], v[112:115], v[136:139], v[20:23]
  v_mfma_f32_16x16x32_bf16 v[48:51], v[112:115], v[140:143], v[48:51]
  v_mfma_f32_16x16x32_bf16 v[24:27], v[116:119], v[136:139], v[24:27]
  v_mfma_f32_16x16x32_bf16 v[52:55], v[116:119], v[140:143], v[52:55]
  v_mfma_f32_16x16x32_bf16 v[28:31], v[120:123], v[136:139], v[28:31]
  v_mfma_f32_16x16x32_bf16 v[56:59], v[120:123], v[140:143], v[56:59]
  v_mfma_f32_16x16x32_bf16 v[32:35], v[124:127], v[136:139], v[32:35]
  v_mfma_f32_16x16x32_bf16 v[60:63], v[124:127], v[140:143], v[60:63]
  v_mfma_f32_16x16x32_bf16 v[36:39], v[128:131], v[136:139], v[36:39]
  v_mfma_f32_16x16x32_bf16 v[64:67], v[128:131], v[140:143], v[64:67]
  v_mfma_f32_16x16x32_bf16 v[40:43], v[132:135], v[136:139], v[40:43]
  v_mfma_f32_16x16x32_bf16 v[68:71], v[132:135], v[140:143], v[68:71]
  v_add_u32 v10, 92160, v14
  v_add_u32 v11, 92160, v9
  ds_read_b128 v[136:139], v11 offset:0
  ds_read_b128 v[140:143], v11 offset:2048
  ds_read_b128 v[108:111], v10 offset:16384
  ds_read_b128 v[112:115], v10 offset:18432
  ds_read_b128 v[116:119], v10 offset:20480
  ds_read_b128 v[120:123], v10 offset:22528
  ds_read_b128 v[124:127], v10 offset:24576
  ds_read_b128 v[128:131], v10 offset:26624
  ds_read_b128 v[132:135], v10 offset:28672
  s_waitcnt lgkmcnt(9)
  v_mfma_f32_16x16x32_bf16 v[16:19], v[72:75], v[100:103], v[16:19]
  v_mfma_f32_16x16x32_bf16 v[44:47], v[72:75], v[104:107], v[44:47]
  v_mfma_f32_16x16x32_bf16 v[20:23], v[76:79], v[100:103], v[20:23]
  v_mfma_f32_16x16x32_bf16 v[48:51], v[76:79], v[104:107], v[48:51]
  v_mfma_f32_16x16x32_bf16 v[24:27], v[80:83], v[100:103], v[24:27]
  v_mfma_f32_16x16x32_bf16 v[52:55], v[80:83], v[104:107], v[52:55]
  v_mfma_f32_16x16x32_bf16 v[28:31], v[84:87], v[100:103], v[28:31]
  v_mfma_f32_16x16x32_bf16 v[56:59], v[84:87], v[104:107], v[56:59]
  v_mfma_f32_16x16x32_bf16 v[32:35], v[88:91], v[100:103], v[32:35]
  v_mfma_f32_16x16x32_bf16 v[60:63], v[88:91], v[104:107], v[60:63]
  v_mfma_f32_16x16x32_bf16 v[36:39], v[92:95], v[100:103], v[36:39]
  v_mfma_f32_16x16x32_bf16 v[64:67], v[92:95], v[104:107], v[64:67]
  v_mfma_f32_16x16x32_bf16 v[40:43], v[96:99], v[100:103], v[40:43]
  v_mfma_f32_16x16x32_bf16 v[68:71], v[96:99], v[104:107], v[68:71]
  s_waitcnt vmcnt(7) lgkmcnt(0)
  s_barrier
  v_add_u32 v10, 0, v3
  v_add_u32 v11, 0, v8
  ds_read_b128 v[100:103], v11 offset:0
  ds_read_b128 v[104:107], v11 offset:2048
  ds_read_b128 v[72:75], v10 offset:16384
  ds_read_b128 v[76:79], v10 offset:18432
  ds_read_b128 v[80:83], v10 offset:20480
  ds_read_b128 v[84:87], v10 offset:22528
  ds_read_b128 v[88:91], v10 offset:24576
  ds_read_b128 v[92:95], v10 offset:26624
  ds_read_b128 v[96:99], v10 offset:28672
  v_mfma_f32_16x16x32_bf16 v[16:19], v[108:111], v[136:139], v[16:19]
  v_mfma_f32_16x16x32_bf16 v[44:47], v[108:111], v[140:143], v[44:47]
  v_mfma_f32_16x16x32_bf16 v[20:23], v[112:115], v[136:139], v[20:23]
  v_mfma_f32_16x16x32_bf16 v[48:51], v[112:115], v[140:143], v[48:51]
  v_mfma_f32_16x16x32_bf16 v[24:27], v[116:119], v[136:139], v[24:27]
  v_mfma_f32_16x16x32_bf16 v[52:55], v[116:119], v[140:143], v[52:55]
  v_mfma_f32_16x16x32_bf16 v[28:31], v[120:123], v[136:139], v[28:31]
  v_mfma_f32_16x16x32_bf16 v[56:59], v[120:123], v[140:143], v[56:59]
  v_mfma_f32_16x16x32_bf16 v[32:35], v[124:127], v[136:139], v[32:35]
  v_mfma_f32_16x16x32_bf16 v[60:63], v[124:127], v[140:143], v[60:63]
  v_mfma_f32_16x16x32_bf16 v[36:39], v[128:131], v[136:139], v[36:39]
  v_mfma_f32_16x16x32_bf16 v[64:67], v[128:131], v[140:143], v[64:67]
  v_mfma_f32_16x16x32_bf16 v[40:43], v[132:135], v[136:139], v[40:43]
  v_mfma_f32_16x16x32_bf16 v[68:71], v[132:135], v[140:143], v[68:71]
  v_add_u32 v10, 0, v14
  v_add_u32 v11, 0, v9
  ds_read_b128 v[136:139], v11 offset:0
  ds_read_b128 v[140:143], v11 offset:2048
  ds_read_b128 v[108:111], v10 offset:16384
  ds_read_b128 v[112:115], v10 offset:18432
  ds_read_b128 v[116:119], v10 offset:20480
  ds_read_b128 v[120:123], v10 offset:22528
  ds_read_b128 v[124:127], v10 offset:24576
  ds_read_b128 v[128:131], v10 offset:26624
  ds_read_b128 v[132:135], v10 offset:28672
  s_waitcnt lgkmcnt(9)
  v_mfma_f32_16x16x32_bf16 v[16:19], v[72:75], v[100:103], v[16:19]
  v_mfma_f32_16x16x32_bf16 v[44:47], v[72:75], v[104:107], v[44:47]
  v_mfma_f32_16x16x32_bf16 v[20:23], v[76:79], v[100:103], v[20:23]
  v_mfma_f32_16x16x32_bf16 v[48:51], v[76:79], v[104:107], v[48:51]
  v_mfma_f32_16x16x32_bf16 v[24:27], v[80:83], v[100:103], v[24:27]
  v_mfma_f32_16x16x32_bf16 v[52:55], v[80:83], v[104:107], v[52:55]
  v_mfma_f32_16x16x32_bf16 v[28:31], v[84:87], v[100:103], v[28:31]
  v_mfma_f32_16x16x32_bf16 v[56:59], v[84:87], v[104:107], v[56:59]
  v_mfma_f32_16x16x32_bf16 v[32:35], v[88:91], v[100:103], v[32:35]
  v_mfma_f32_16x16x32_bf16 v[60:63], v[88:91], v[104:107], v[60:63]
  v_mfma_f32_16x16x32_bf16 v[36:39], v[92:95], v[100:103], v[36:39]
  v_mfma_f32_16x16x32_bf16 v[64:67], v[92:95], v[104:107], v[64:67]
  v_mfma_f32_16x16x32_bf16 v[40:43], v[96:99], v[100:103], v[40:43]
  v_mfma_f32_16x16x32_bf16 v[68:71], v[96:99], v[104:107], v[68:71]
  s_waitcnt vmcnt(0) lgkmcnt(0)
  s_barrier
  v_add_u32 v10, 30720, v3
  v_add_u32 v11, 30720, v8
  ds_read_b128 v[100:103], v11 offset:0
  ds_read_b128 v[104:107], v11 offset:2048
  ds_read_b128 v[72:75], v10 offset:16384
  ds_read_b128 v[76:79], v10 offset:18432
  ds_read_b128 v[80:83], v10 offset:20480
  ds_read_b128 v[84:87], v10 offset:22528
  ds_read_b128 v[88:91], v10 offset:24576
  ds_read_b128 v[92:95], v10 offset:26624
  ds_read_b128 v[96:99], v10 offset:28672
  v_mfma_f32_16x16x32_bf16 v[16:19], v[108:111], v[136:139], v[16:19]
  v_mfma_f32_16x16x32_bf16 v[44:47], v[108:111], v[140:143], v[44:47]
  v_mfma_f32_16x16x32_bf16 v[20:23], v[112:115], v[136:139], v[20:23]
  v_mfma_f32_16x16x32_bf16 v[48:51], v[112:115], v[140:143], v[48:51]
  v_mfma_f32_16x16x32_bf16 v[24:27], v[116:119], v[136:139], v[24:27]
  v_mfma_f32_16x16x32_bf16 v[52:55], v[116:119], v[140:143], v[52:55]
  v_mfma_f32_16x16x32_bf16 v[28:31], v[120:123], v[136:139], v[28:31]
  v_mfma_f32_16x16x32_bf16 v[56:59], v[120:123], v[140:143], v[56:59]
  v_mfma_f32_16x16x32_bf16 v[32:35], v[124:127], v[136:139], v[32:35]
  v_mfma_f32_16x16x32_bf16 v[60:63], v[124:127], v[140:143], v[60:63]
  v_mfma_f32_16x16x32_bf16 v[36:39], v[128:131], v[136:139], v[36:39]
  v_mfma_f32_16x16x32_bf16 v[64:67], v[128:131], v[140:143], v[64:67]
  v_mfma_f32_16x16x32_bf16 v[40:43], v[132:135], v[136:139], v[40:43]
  v_mfma_f32_16x16x32_bf16 v[68:71], v[132:135], v[140:143], v[68:71]
  v_add_u32 v10, 30720, v14
  v_add_u32 v11, 30720, v9
  ds_read_b128 v[136:139], v11 offset:0
  ds_read_b128 v[140:143], v11 offset:2048
  ds_read_b128 v[108:111], v10 offset:16384
  ds_read_b128 v[112:115], v10 offset:18432
  ds_read_b128 v[116:119], v10 offset:20480
  ds_read_b128 v[120:123], v10 offset:22528
  ds_read_b128 v[124:127], v10 offset:24576
  ds_read_b128 v[128:131], v10 offset:26624
  ds_read_b128 v[132:135], v10 offset:28672
  s_waitcnt lgkmcnt(9)
  v_mfma_f32_16x16x32_bf16 v[16:19], v[72:75], v[100:103], v[16:19]
  v_mfma_f32_16x16x32_bf16 v[44:47], v[72:75], v[104:107], v[44:47]
  v_mfma_f32_16x16x32_bf16 v[20:23], v[76:79], v[100:103], v[20:23]
  v_mfma_f32_16x16x32_bf16 v[48:51], v[76:79], v[104:107], v[48:51]
  v_mfma_f32_16x16x32_bf16 v[24:27], v[80:83], v[100:103], v[24:27]
  v_mfma_f32_16x16x32_bf16 v[52:55], v[80:83], v[104:107], v[52:55]
  v_mfma_f32_16x16x32_bf16 v[28:31], v[84:87], v[100:103], v[28:31]
  v_mfma_f32_16x16x32_bf16 v[56:59], v[84:87], v[104:107], v[56:59]
  v_mfma_f32_16x16x32_bf16 v[32:35], v[88:91], v[100:103], v[32:35]
  v_mfma_f32_16x16x32_bf16 v[60:63], v[88:91], v[104:107], v[60:63]
  v_mfma_f32_16x16x32_bf16 v[36:39], v[92:95], v[100:103], v[36:39]
  v_mfma_f32_16x16x32_bf16 v[64:67], v[92:95], v[104:107], v[64:67]
  v_mfma_f32_16x16x32_bf16 v[40:43], v[96:99], v[100:103], v[40:43]
  v_mfma_f32_16x16x32_bf16 v[68:71], v[96:99], v[104:107], v[68:71]
  s_waitcnt lgkmcnt(0)
  v_mfma_f32_16x16x32_bf16 v[16:19], v[108:111], v[136:139], v[16:19]
  v_mfma_f32_16x16x32_bf16 v[44:47], v[108:111], v[140:143], v[44:47]
  v_mfma_f32_16x16x32_bf16 v[20:23], v[112:115], v[136:139], v[20:23]
  v_mfma_f32_16x16x32_bf16 v[48:51], v[112:115], v[140:143], v[48:51]
  v_mfma_f32_16x16x32_bf16 v[24:27], v[116:119], v[136:139], v[24:27]
  v_mfma_f32_16x16x32_bf16 v[52:55], v[116:119], v[140:143], v[52:55]
  v_mfma_f32_16x16x32_bf16 v[28:31], v[120:123], v[136:139], v[28:31]
  v_mfma_f32_16x16x32_bf16 v[56:59], v[120:123], v[140:143], v[56:59]
  v_mfma_f32_16x16x32_bf16 v[32:35], v[124:127], v[136:139], v[32:35]
  v_mfma_f32_16x16x32_bf16 v[60:63], v[124:127], v[140:143], v[60:63]
  v_mfma_f32_16x16x32_bf16 v[36:39], v[128:131], v[136:139], v[36:39]
  v_mfma_f32_16x16x32_bf16 v[64:67], v[128:131], v[140:143], v[64:67]
  v_mfma_f32_16x16x32_bf16 v[40:43], v[132:135], v[136:139], v[40:43]
  v_mfma_f32_16x16x32_bf16 v[68:71], v[132:135], v[140:143], v[68:71]
L_k4_join:
  v_and_b32 v10, 15, v1
  v_lshrrev_b32 v11, 4, v1
  v_lshlrev_b32 v11, 3, v11
  v_mul_u32_u24 v12, 3456, v10
  v_add_u32 v12, v12, v11
  s_lshl_b32 s46, s32, 5
  s_add_u32 s46, s46, s33
  s_mul_i32 s46, s46, 3456
  s_lshl_b32 s47, s34, 1
  s_add_u32 s46, s46, s47
  s_add_u32 s48, s46, 55296
  s_mov_b32 s50, 0x40135761
  s_mov_b32 s51, 0x40135761
  s_mov_b32 s52, 0x3dd2d3e8
  s_mov_b32 s53, 0x3dd2d3e8
  s_mov_b32 s54, 1.0
  s_mov_b32 s55, 1.0
  v_lshlrev_b32 v72, 16, v144
  v_and_b32 v73, 0xffff0000, v144
  v_lshlrev_b32 v74, 16, v145
  v_and_b32 v75, 0xffff0000, v145
  v_lshlrev_b32 v76, 16, v146
  v_and_b32 v77, 0xffff0000, v146
  v_lshlrev_b32 v78, 16, v147
  v_and_b32 v79, 0xffff0000, v147
  v_lshlrev_b32 v80, 16, v148
  v_and_b32 v81, 0xffff0000, v148
  v_lshlrev_b32 v82, 16, v149
  v_and_b32 v83, 0xffff0000, v149
  v_lshlrev_b32 v84, 16, v150
  v_and_b32 v85, 0xffff0000, v150
  v_lshlrev_b32 v86, 16, v151
  v_and_b32 v87, 0xffff0000, v151
  v_lshlrev_b32 v88, 16, v152
  v_and_b32 v89, 0xffff0000, v152
  v_lshlrev_b32 v90, 16, v153
  v_and_b32 v91, 0xffff0000, v153
  v_lshlrev_b32 v92, 16, v154
  v_and_b32 v93, 0xffff0000, v154
  v_lshlrev_b32 v94, 16, v155
  v_and_b32 v95, 0xffff0000, v155
  v_lshlrev_b32 v96, 16, v156
  v_and_b32 v97, 0xffff0000, v156
  v_lshlrev_b32 v98, 16, v157
  v_and_b32 v99, 0xffff0000, v157
  v_mov_b32 v114, s50
  v_mov_b32 v115, s50
  v_cvt_pk_bf16_f32 v108, v16, v17
  v_lshlrev_b32 v110, 16, v108
  v_and_b32 v111, 0xffff0000, v108
  v_pk_add_f32 v[110:111], v[110:111], v[72:73]
  v_cvt_pk_bf16_f32 v108, v110, v111
  v_lshlrev_b32 v110, 16, v108
  v_and_b32 v111, 0xffff0000, v108
  v_pk_mul_f32 v[112:113], v[110:111], v[110:111]
  v_pk_fma_f32 v[112:113], v[112:113], s[52:53], v[114:115]
  v_pk_mul_f32 v[112:113], v[112:113], v[110:111]
  v_exp_f32 v112, v112
  v_exp_f32 v113, v113
  s_nop 0
  v_pk_add_f32 v[112:113], v[112:113], s[54:55]
  v_rcp_f32 v112, v112
  v_rcp_f32 v113, v113
  s_nop 0
  v_pk_fma_f32 v[112:113], v[112:113], v[110:111], v[110:111] neg_lo:[1,0,0] neg_hi:[1,0,0]
  v_cvt_pk_bf16_f32 v124, v112, v113
  v_cvt_pk_bf16_f32 v108, v18, v19
  v_lshlrev_b32 v110, 16, v108
  v_and_b32 v111, 0xffff0000, v108
  v_pk_add_f32 v[110:111], v[110:111], v[74:75]
  v_cvt_pk_bf16_f32 v108, v110, v111
  v_lshlrev_b32 v110, 16, v108
  v_and_b32 v111, 0xffff0000, v108
  v_pk_mul_f32 v[112:113], v[110:111], v[110:111]
  v_pk_fma_f32 v[112:113], v[112:113], s[52:53], v[114:115]
  v_pk_mul_f32 v[112:113], v[112:113], v[110:111]
  v_exp_f32 v112, v112
  v_exp_f32 v113, v113
  s_nop 0
  v_pk_add_f32 v[112:113], v[112:113], s[54:55]
  v_rcp_f32 v112, v112
  v_rcp_f32 v113, v113
  s_nop 0
  v_pk_fma_f32 v[112:113], v[112:113], v[110:111], v[110:111] neg_lo:[1,0,0] neg_hi:[1,0,0]
  v_cvt_pk_bf16_f32 v125, v112, v113
  buffer_store_dwordx2 v[124:125], v12, s[20:23], s46 offen offset:0
  v_cvt_pk_bf16_f32 v108, v20, v21
  v_lshlrev_b32 v110, 16, v108
  v_and_b32 v111, 0xffff0000, v108
  v_pk_add_f32 v[110:111], v[110:111], v[76:77]
  v_cvt_pk_bf16_f32 v108, v110, v111
  v_lshlrev_b32 v110, 16, v108
  v_and_b32 v111, 0xffff0000, v108
  v_pk_mul_f32 v[112:113], v[110:111], v[110:111]
  v_pk_fma_f32 v[112:113], v[112:113], s[52:53], v[114:115]
  v_pk_mul_f32 v[112:113], v[112:113], v[110:111]
  v_exp_f32 v112, v112
  v_exp_f32 v113, v113
  s_nop 0
  v_pk_add_f32 v[112:113], v[112:113], s[54:55]
  v_rcp_f32 v112, v112
  v_rcp_f32 v113, v113
  s_nop 0
  v_pk_fma_f32 v[112:113], v[112:113], v[110:111], v[110:111] neg_lo:[1,0,0] neg_hi:[1,0,0]
  v_cvt_pk_bf16_f32 v126, v112, v113
  v_cvt_pk_bf16_f32 v108, v22, v23
  v_lshlrev_b32 v110, 16, v108
  v_and_b32 v111, 0xffff0000, v108
  v_pk_add_f32 v[110:111], v[110:111], v[78:79]
  v_cvt_pk_bf16_f32 v108, v110, v111
  v_lshlrev_b32 v110, 16, v108
  v_and_b32 v111, 0xffff0000, v108
  v_pk_mul_f32 v[112:113], v[110:111], v[110:111]
  v_pk_fma_f32 v[112:113], v[112:113], s[52:53], v[114:115]
  v_pk_mul_f32 v[112:113], v[112:113], v[110:111]
  v_exp_f32 v112, v112
  v_exp_f32 v113, v113
  s_nop 0
  v_pk_add_f32 v[112:113], v[112:113], s[54:55]
  v_rcp_f32 v112, v112
  v_rcp_f32 v113, v113
  s_nop 0
  v_pk_fma_f32 v[112:113], v[112:113], v[110:111], v[110:111] neg_lo:[1,0,0] neg_hi:[1,0,0]
  v_cvt_pk_bf16_f32 v127, v112, v113
  buffer_store_dwordx2 v[126:127], v12, s[20:23], s46 offen offset:32
  v_cvt_pk_bf16_f32 v108, v24, v25
  v_lshlrev_b32 v110, 16, v108
  v_and_b32 v111, 0xffff0000, v108
  v_pk_add_f32 v[110:111], v[110:111], v[80:81]
  v_cvt_pk_bf16_f32 v108, v110, v111
  v_lshlrev_b32 v110, 16, v108
  v_and_b32 v111, 0xffff0000, v108
  v_pk_mul_f32 v[112:113], v[110:111], v[110:111]
  v_pk_fma_f32 v[112:113], v[112:113], s[52:53], v[114:115]
  v_pk_mul_f32 v[112:113], v[112:113], v[110:111]
  v_exp_f32 v112, v112
  v_exp_f32 v113, v113
  s_nop 0
  v_pk_add_f32 v[112:113], v[112:113], s[54:55]
  v_rcp_f32 v112, v112
  v_rcp_f32 v113, v113
  s_nop 0
  v_pk_fma_f32 v[112:113], v[112:113], v[110:111], v[110:111] neg_lo:[1,0,0] neg_hi:[1,0,0]
  v_cvt_pk_bf16_f32 v124, v112, v113
  v_cvt_pk_bf16_f32 v108, v26, v27
  v_lshlrev_b32 v110, 16, v108
  v_and_b32 v111, 0xffff0000, v108
  v_pk_add_f32 v[110:111], v[110:111], v[82:83]
  v_cvt_pk_bf16_f32 v108, v110, v111
  v_lshlrev_b32 v110, 16, v108
  v_and_b32 v111, 0xffff0000, v108
  v_pk_mul_f32 v[112:113], v[110:111], v[110:111]
  v_pk_fma_f32 v[112:113], v[112:113], s[52:53], v[114:115]
  v_pk_mul_f32 v[112:113], v[112:113], v[110:111]
  v_exp_f32 v112, v112
  v_exp_f32 v113, v113
  s_nop 0
  v_pk_add_f32 v[112:113], v[112:113], s[54:55]
  v_rcp_f32 v112, v112
  v_rcp_f32 v113, v113
  s_nop 0
  v_pk_fma_f32 v[112:113], v[112:113], v[110:111], v[110:111] neg_lo:[1,0,0] neg_hi:[1,0,0]
  v_cvt_pk_bf16_f32 v125, v112, v113
  buffer_store_dwordx2 v[124:125], v12, s[20:23], s46 offen offset:64
  v_cvt_pk_bf16_f32 v108, v28, v29
  v_lshlrev_b32 v110, 16, v108
  v_and_b32 v111, 0xffff0000, v108
  v_pk_add_f32 v[110:111], v[110:111], v[84:85]
  v_cvt_pk_bf16_f32 v108, v110, v111
  v_lshlrev_b32 v110, 16, v108
  v_and_b32 v111, 0xffff0000, v108
  v_pk_mul_f32 v[112:113], v[110:111], v[110:111]
  v_pk_fma_f32 v[112:113], v[112:113], s[52:53], v[114:115]
  v_pk_mul_f32 v[112:113], v[112:113], v[110:111]
  v_exp_f32 v112, v112
  v_exp_f32 v113, v113
  s_nop 0
  v_pk_add_f32 v[112:113], v[112:113], s[54:55]
  v_rcp_f32 v112, v112
  v_rcp_f32 v113, v113
  s_nop 0
  v_pk_fma_f32 v[112:113], v[112:113], v[110:111], v[110:111] neg_lo:[1,0,0] neg_hi:[1,0,0]
  v_cvt_pk_bf16_f32 v126, v112, v113
  v_cvt_pk_bf16_f32 v108, v30, v31
  v_lshlrev_b32 v110, 16, v108
  v_and_b32 v111, 0xffff0000, v108
  v_pk_add_f32 v[110:111], v[110:111], v[86:87]
  v_cvt_pk_bf16_f32 v108, v110, v111
  v_lshlrev_b32 v110, 16, v108
  v_and_b32 v111, 0xffff0000, v108
  v_pk_mul_f32 v[112:113], v[110:111], v[110:111]
  v_pk_fma_f32 v[112:113], v[112:113], s[52:53], v[114:115]
  v_pk_mul_f32 v[112:113], v[112:113], v[110:111]
  v_exp_f32 v112, v112
  v_exp_f32 v113, v113
  s_nop 0
  v_pk_add_f32 v[112:113], v[112:113], s[54:55]
  v_rcp_f32 v112, v112
  v_rcp_f32 v113, v113
  s_nop 0
  v_pk_fma_f32 v[112:113], v[112:113], v[110:111], v[110:111] neg_lo:[1,0,0] neg_hi:[1,0,0]
  v_cvt_pk_bf16_f32 v127, v112, v113
  buffer_store_dwordx2 v[126:127], v12, s[20:23], s46 offen offset:96
  v_cvt_pk_bf16_f32 v108, v32, v33
  v_lshlrev_b32 v110, 16, v108
  v_and_b32 v111, 0xffff0000, v108
  v_pk_add_f32 v[110:111], v[110:111], v[88:89]
  v_cvt_pk_bf16_f32 v108, v110, v111
  v_lshlrev_b32 v110, 16, v108
  v_and_b32 v111, 0xffff0000, v108
  v_pk_mul_f32 v[112:113], v[110:111], v[110:111]
  v_pk_fma_f32 v[112:113], v[112:113], s[52:53], v[114:115]
  v_pk_mul_f32 v[112:113], v[112:113], v[110:111]
  v_exp_f32 v112, v112
  v_exp_f32 v113, v113
  s_nop 0
  v_pk_add_f32 v[112:113], v[112:113], s[54:55]
  v_rcp_f32 v112, v112
  v_rcp_f32 v113, v113
  s_nop 0
  v_pk_fma_f32 v[112:113], v[112:113], v[110:111], v[110:111] neg_lo:[1,0,0] neg_hi:[1,0,0]
  v_cvt_pk_bf16_f32 v124, v112, v113
  v_cvt_pk_bf16_f32 v108, v34, v35
  v_lshlrev_b32 v110, 16, v108
  v_and_b32 v111, 0xffff0000, v108
  v_pk_add_f32 v[110:111], v[110:111], v[90:91]
  v_cvt_pk_bf16_f32 v108, v110, v111
  v_lshlrev_b32 v110, 16, v108
  v_and_b32 v111, 0xffff0000, v108
  v_pk_mul_f32 v[112:113], v[110:111], v[110:111]
  v_pk_fma_f32 v[112:113], v[112:113], s[52:53], v[114:115]
  v_pk_mul_f32 v[112:113], v[112:113], v[110:111]
  v_exp_f32 v112, v112
  v_exp_f32 v113, v113
  s_nop 0
  v_pk_add_f32 v[112:113], v[112:113], s[54:55]
  v_rcp_f32 v112, v112
  v_rcp_f32 v113, v113
  s_nop 0
  v_pk_fma_f32 v[112:113], v[112:113], v[110:111], v[110:111] neg_lo:[1,0,0] neg_hi:[1,0,0]
  v_cvt_pk_bf16_f32 v125, v112, v113
  buffer_store_dwordx2 v[124:125], v12, s[20:23], s46 offen offset:128
  v_cvt_pk_bf16_f32 v108, v36, v37
  v_lshlrev_b32 v110, 16, v108
  v_and_b32 v111, 0xffff0000, v108
  v_pk_add_f32 v[110:111], v[110:111], v[92:93]
  v_cvt_pk_bf16_f32 v108, v110, v111
  v_lshlrev_b32 v110, 16, v108
  v_and_b32 v111, 0xffff0000, v108
  v_pk_mul_f32 v[112:113], v[110:111], v[110:111]
  v_pk_fma_f32 v[112:113], v[112:113], s[52:53], v[114:115]
  v_pk_mul_f32 v[112:113], v[112:113], v[110:111]
  v_exp_f32 v112, v112
  v_exp_f32 v113, v113
  s_nop 0
  v_pk_add_f32 v[112:113], v[112:113], s[54:55]
  v_rcp_f32 v112, v112
  v_rcp_f32 v113, v113
  s_nop 0
  v_pk_fma_f32 v[112:113], v[112:113], v[110:111], v[110:111] neg_lo:[1,0,0] neg_hi:[1,0,0]
  v_cvt_pk_bf16_f32 v126, v112, v113
  v_cvt_pk_bf16_f32 v108, v38, v39
  v_lshlrev_b32 v110, 16, v108
  v_and_b32 v111, 0xffff0000, v108
  v_pk_add_f32 v[110:111], v[110:111], v[94:95]
  v_cvt_pk_bf16_f32 v108, v110, v111
  v_lshlrev_b32 v110, 16, v108
  v_and_b32 v111, 0xffff0000, v108
  v_pk_mul_f32 v[112:113], v[110:111], v[110:111]
  v_pk_fma_f32 v[112:113], v[112:113], s[52:53], v[114:115]
  v_pk_mul_f32 v[112:113], v[112:113], v[110:111]
  v_exp_f32 v112, v112
  v_exp_f32 v113, v113
  s_nop 0
  v_pk_add_f32 v[112:113], v[112:113], s[54:55]
  v_rcp_f32 v112, v112
  v_rcp_f32 v113, v113
  s_nop 0
  v_pk_fma_f32 v[112:113], v[112:113], v[110:111], v[110:111] neg_lo:[1,0,0] neg_hi:[1,0,0]
  v_cvt_pk_bf16_f32 v127, v112, v113
  buffer_store_dwordx2 v[126:127], v12, s[20:23], s46 offen offset:160
  v_cvt_pk_bf16_f32 v108, v40, v41
  v_lshlrev_b32 v110, 16, v108
  v_and_b32 v111, 0xffff0000, v108
  v_pk_add_f32 v[110:111], v[110:111], v[96:97]
  v_cvt_pk_bf16_f32 v108, v110, v111
  v_lshlrev_b32 v110, 16, v108
  v_and_b32 v111, 0xffff0000, v108
  v_pk_mul_f32 v[112:113], v[110:111], v[110:111]
  v_pk_fma_f32 v[112:113], v[112:113], s[52:53], v[114:115]
  v_pk_mul_f32 v[112:113], v[112:113], v[110:111]
  v_exp_f32 v112, v112
  v_exp_f32 v113, v113
  s_nop 0
  v_pk_add_f32 v[112:113], v[112:113], s[54:55]
  v_rcp_f32 v112, v112
  v_rcp_f32 v113, v113
  s_nop 0
  v_pk_fma_f32 v[112:113], v[112:113], v[110:111], v[110:111] neg_lo:[1,0,0] neg_hi:[1,0,0]
  v_cvt_pk_bf16_f32 v124, v112, v113
  v_cvt_pk_bf16_f32 v108, v42, v43
  v_lshlrev_b32 v110, 16, v108
  v_and_b32 v111, 0xffff0000, v108
  v_pk_add_f32 v[110:111], v[110:111], v[98:99]
  v_cvt_pk_bf16_f32 v108, v110, v111
  v_lshlrev_b32 v110, 16, v108
  v_and_b32 v111, 0xffff0000, v108
  v_pk_mul_f32 v[112:113], v[110:111], v[110:111]
  v_pk_fma_f32 v[112:113], v[112:113], s[52:53], v[114:115]
  v_pk_mul_f32 v[112:113], v[112:113], v[110:111]
  v_exp_f32 v112, v112
  v_exp_f32 v113, v113
  s_nop 0
  v_pk_add_f32 v[112:113], v[112:113], s[54:55]
  v_rcp_f32 v112, v112
  v_rcp_f32 v113, v113
  s_nop 0
  v_pk_fma_f32 v[112:113], v[112:113], v[110:111], v[110:111] neg_lo:[1,0,0] neg_hi:[1,0,0]
  v_cvt_pk_bf16_f32 v125, v112, v113
  buffer_store_dwordx2 v[124:125], v12, s[20:23], s46 offen offset:192
  v_cvt_pk_bf16_f32 v108, v44, v45
  v_lshlrev_b32 v110, 16, v108
  v_and_b32 v111, 0xffff0000, v108
  v_pk_add_f32 v[110:111], v[110:111], v[72:73]
  v_cvt_pk_bf16_f32 v108, v110, v111
  v_lshlrev_b32 v110, 16, v108
  v_and_b32 v111, 0xffff0000, v108
  v_pk_mul_f32 v[112:113], v[110:111], v[110:111]
  v_pk_fma_f32 v[112:113], v[112:113], s[52:53], v[114:115]
  v_pk_mul_f32 v[112:113], v[112:113], v[110:111]
  v_exp_f32 v112, v112
  v_exp_f32 v113, v113
  s_nop 0
  v_pk_add_f32 v[112:113], v[112:113], s[54:55]
  v_rcp_f32 v112, v112
  v_rcp_f32 v113, v113
  s_nop 0
  v_pk_fma_f32 v[112:113], v[112:113], v[110:111], v[110:111] neg_lo:[1,0,0] neg_hi:[1,0,0]
  v_cvt_pk_bf16_f32 v126, v112, v113
  v_cvt_pk_bf16_f32 v108, v46, v47
  v_lshlrev_b32 v110, 16, v108
  v_and_b32 v111, 0xffff0000, v108
  v_pk_add_f32 v[110:111], v[110:111], v[74:75]
  v_cvt_pk_bf16_f32 v108, v110, v111
  v_lshlrev_b32 v110, 16, v108
  v_and_b32 v111, 0xffff0000, v108
  v_pk_mul_f32 v[112:113], v[110:111], v[110:111]
  v_pk_fma_f32 v[112:113], v[112:113], s[52:53], v[114:115]
  v_pk_mul_f32 v[112:113], v[112:113], v[110:111]
  v_exp_f32 v112, v112
  v_exp_f32 v113, v113
  s_nop 0
  v_pk_add_f32 v[112:113], v[112:113], s[54:55]
  v_rcp_f32 v112, v112
  v_rcp_f32 v113, v113
  s_nop 0
  v_pk_fma_f32 v[112:113], v[112:113], v[110:111], v[110:111] neg_lo:[1,0,0] neg_hi:[1,0,0]
  v_cvt_pk_bf16_f32 v127, v112, v113
  buffer_store_dwordx2 v[126:127], v12, s[20:23], s48 offen offset:0
  v_cvt_pk_bf16_f32 v108, v48, v49
  v_lshlrev_b32 v110, 16, v108
  v_and_b32 v111, 0xffff0000, v108
  v_pk_add_f32 v[110:111], v[110:111], v[76:77]
  v_cvt_pk_bf16_f32 v108, v110, v111
  v_lshlrev_b32 v110, 16, v108
  v_and_b32 v111, 0xffff0000, v108
  v_pk_mul_f32 v[112:113], v[110:111], v[110:111]
  v_pk_fma_f32 v[112:113], v[112:113], s[52:53], v[114:115]
  v_pk_mul_f32 v[112:113], v[112:113], v[110:111]
  v_exp_f32 v112, v112
  v_exp_f32 v113, v113
  s_nop 0
  v_pk_add_f32 v[112:113], v[112:113], s[54:55]
  v_rcp_f32 v112, v112
  v_rcp_f32 v113, v113
  s_nop 0
  v_pk_fma_f32 v[112:113], v[112:113], v[110:111], v[110:111] neg_lo:[1,0,0] neg_hi:[1,0,0]
  v_cvt_pk_bf16_f32 v124, v112, v113
  v_cvt_pk_bf16_f32 v108, v50, v51
  v_lshlrev_b32 v110, 16, v108
  v_and_b32 v111, 0xffff0000, v108
  v_pk_add_f32 v[110:111], v[110:111], v[78:79]
  v_cvt_pk_bf16_f32 v108, v110, v111
  v_lshlrev_b32 v110, 16, v108
  v_and_b32 v111, 0xffff0000, v108
  v_pk_mul_f32 v[112:113], v[110:111], v[110:111]
  v_pk_fma_f32 v[112:113], v[112:113], s[52:53], v[114:115]
  v_pk_mul_f32 v[112:113], v[112:113], v[110:111]
  v_exp_f32 v112, v112
  v_exp_f32 v113, v113
  s_nop 0
  v_pk_add_f32 v[112:113], v[112:113], s[54:55]
  v_rcp_f32 v112, v112
  v_rcp_f32 v113, v113
  s_nop 0
  v_pk_fma_f32 v[112:113], v[112:113], v[110:111], v[110:111] neg_lo:[1,0,0] neg_hi:[1,0,0]
  v_cvt_pk_bf16_f32 v125, v112, v113
  buffer_store_dwordx2 v[124:125], v12, s[20:23], s48 offen offset:32
  v_cvt_pk_bf16_f32 v108, v52, v53
  v_lshlrev_b32 v110, 16, v108
  v_and_b32 v111, 0xffff0000, v108
  v_pk_add_f32 v[110:111], v[110:111], v[80:81]
  v_cvt_pk_bf16_f32 v108, v110, v111
  v_lshlrev_b32 v110, 16, v108
  v_and_b32 v111, 0xffff0000, v108
  v_pk_mul_f32 v[112:113], v[110:111], v[110:111]
  v_pk_fma_f32 v[112:113], v[112:113], s[52:53], v[114:115]
  v_pk_mul_f32 v[112:113], v[112:113], v[110:111]
  v_exp_f32 v112, v112
  v_exp_f32 v113, v113
  s_nop 0
  v_pk_add_f32 v[112:113], v[112:113], s[54:55]
  v_rcp_f32 v112, v112
  v_rcp_f32 v113, v113
  s_nop 0
  v_pk_fma_f32 v[112:113], v[112:113], v[110:111], v[110:111] neg_lo:[1,0,0] neg_hi:[1,0,0]
  v_cvt_pk_bf16_f32 v126, v112, v113
  v_cvt_pk_bf16_f32 v108, v54, v55
  v_lshlrev_b32 v110, 16, v108
  v_and_b32 v111, 0xffff0000, v108
  v_pk_add_f32 v[110:111], v[110:111], v[82:83]
  v_cvt_pk_bf16_f32 v108, v110, v111
  v_lshlrev_b32 v110, 16, v108
  v_and_b32 v111, 0xffff0000, v108
  v_pk_mul_f32 v[112:113], v[110:111], v[110:111]
  v_pk_fma_f32 v[112:113], v[112:113], s[52:53], v[114:115]
  v_pk_mul_f32 v[112:113], v[112:113], v[110:111]
  v_exp_f32 v112, v112
  v_exp_f32 v113, v113
  s_nop 0
  v_pk_add_f32 v[112:113], v[112:113], s[54:55]
  v_rcp_f32 v112, v112
  v_rcp_f32 v113, v113
  s_nop 0
  v_pk_fma_f32 v[112:113], v[112:113], v[110:111], v[110:111] neg_lo:[1,0,0] neg_hi:[1,0,0]
  v_cvt_pk_bf16_f32 v127, v112, v113
  buffer_store_dwordx2 v[126:127], v12, s[20:23], s48 offen offset:64
  v_cvt_pk_bf16_f32 v108, v56, v57
  v_lshlrev_b32 v110, 16, v108
  v_and_b32 v111, 0xffff0000, v108
  v_pk_add_f32 v[110:111], v[110:111], v[84:85]
  v_cvt_pk_bf16_f32 v108, v110, v111
  v_lshlrev_b32 v110, 16, v108
  v_and_b32 v111, 0xffff0000, v108
  v_pk_mul_f32 v[112:113], v[110:111], v[110:111]
  v_pk_fma_f32 v[112:113], v[112:113], s[52:53], v[114:115]
  v_pk_mul_f32 v[112:113], v[112:113], v[110:111]
  v_exp_f32 v112, v112
  v_exp_f32 v113, v113
  s_nop 0
  v_pk_add_f32 v[112:113], v[112:113], s[54:55]
  v_rcp_f32 v112, v112
  v_rcp_f32 v113, v113
  s_nop 0
  v_pk_fma_f32 v[112:113], v[112:113], v[110:111], v[110:111] neg_lo:[1,0,0] neg_hi:[1,0,0]
  v_cvt_pk_bf16_f32 v124, v112, v113
  v_cvt_pk_bf16_f32 v108, v58, v59
  v_lshlrev_b32 v110, 16, v108
  v_and_b32 v111, 0xffff0000, v108
  v_pk_add_f32 v[110:111], v[110:111], v[86:87]
  v_cvt_pk_bf16_f32 v108, v110, v111
  v_lshlrev_b32 v110, 16, v108
  v_and_b32 v111, 0xffff0000, v108
  v_pk_mul_f32 v[112:113], v[110:111], v[110:111]
  v_pk_fma_f32 v[112:113], v[112:113], s[52:53], v[114:115]
  v_pk_mul_f32 v[112:113], v[112:113], v[110:111]
  v_exp_f32 v112, v112
  v_exp_f32 v113, v113
  s_nop 0
  v_pk_add_f32 v[112:113], v[112:113], s[54:55]
  v_rcp_f32 v112, v112
  v_rcp_f32 v113, v113
  s_nop 0
  v_pk_fma_f32 v[112:113], v[112:113], v[110:111], v[110:111] neg_lo:[1,0,0] neg_hi:[1,0,0]
  v_cvt_pk_bf16_f32 v125, v112, v113
  buffer_store_dwordx2 v[124:125], v12, s[20:23], s48 offen offset:96
  v_cvt_pk_bf16_f32 v108, v60, v61
  v_lshlrev_b32 v110, 16, v108
  v_and_b32 v111, 0xffff0000, v108
  v_pk_add_f32 v[110:111], v[110:111], v[88:89]
  v_cvt_pk_bf16_f32 v108, v110, v111
  v_lshlrev_b32 v110, 16, v108
  v_and_b32 v111, 0xffff0000, v108
  v_pk_mul_f32 v[112:113], v[110:111], v[110:111]
  v_pk_fma_f32 v[112:113], v[112:113], s[52:53], v[114:115]
  v_pk_mul_f32 v[112:113], v[112:113], v[110:111]
  v_exp_f32 v112, v112
  v_exp_f32 v113, v113
  s_nop 0
  v_pk_add_f32 v[112:113], v[112:113], s[54:55]
  v_rcp_f32 v112, v112
  v_rcp_f32 v113, v113
  s_nop 0
  v_pk_fma_f32 v[112:113], v[112:113], v[110:111], v[110:111] neg_lo:[1,0,0] neg_hi:[1,0,0]
  v_cvt_pk_bf16_f32 v126, v112, v113
  v_cvt_pk_bf16_f32 v108, v62, v63
  v_lshlrev_b32 v110, 16, v108
  v_and_b32 v111, 0xffff0000, v108
  v_pk_add_f32 v[110:111], v[110:111], v[90:91]
  v_cvt_pk_bf16_f32 v108, v110, v111
  v_lshlrev_b32 v110, 16, v108
  v_and_b32 v111, 0xffff0000, v108
  v_pk_mul_f32 v[112:113], v[110:111], v[110:111]
  v_pk_fma_f32 v[112:113], v[112:113], s[52:53], v[114:115]
  v_pk_mul_f32 v[112:113], v[112:113], v[110:111]
  v_exp_f32 v112, v112
  v_exp_f32 v113, v113
  s_nop 0
  v_pk_add_f32 v[112:113], v[112:113], s[54:55]
  v_rcp_f32 v112, v112
  v_rcp_f32 v113, v113
  s_nop 0
  v_pk_fma_f32 v[112:113], v[112:113], v[110:111], v[110:111] neg_lo:[1,0,0] neg_hi:[1,0,0]
  v_cvt_pk_bf16_f32 v127, v112, v113
  buffer_store_dwordx2 v[126:127], v12, s[20:23], s48 offen offset:128
  v_cvt_pk_bf16_f32 v108, v64, v65
  v_lshlrev_b32 v110, 16, v108
  v_and_b32 v111, 0xffff0000, v108
  v_pk_add_f32 v[110:111], v[110:111], v[92:93]
  v_cvt_pk_bf16_f32 v108, v110, v111
  v_lshlrev_b32 v110, 16, v108
  v_and_b32 v111, 0xffff0000, v108
  v_pk_mul_f32 v[112:113], v[110:111], v[110:111]
  v_pk_fma_f32 v[112:113], v[112:113], s[52:53], v[114:115]
  v_pk_mul_f32 v[112:113], v[112:113], v[110:111]
  v_exp_f32 v112, v112
  v_exp_f32 v113, v113
  s_nop 0
  v_pk_add_f32 v[112:113], v[112:113], s[54:55]
  v_rcp_f32 v112, v112
  v_rcp_f32 v113, v113
  s_nop 0
  v_pk_fma_f32 v[112:113], v[112:113], v[110:111], v[110:111] neg_lo:[1,0,0] neg_hi:[1,0,0]
  v_cvt_pk_bf16_f32 v124, v112, v113
  v_cvt_pk_bf16_f32 v108, v66, v67
  v_lshlrev_b32 v110, 16, v108
  v_and_b32 v111, 0xffff0000, v108
  v_pk_add_f32 v[110:111], v[110:111], v[94:95]
  v_cvt_pk_bf16_f32 v108, v110, v111
  v_lshlrev_b32 v110, 16, v108
  v_and_b32 v111, 0xffff0000, v108
  v_pk_mul_f32 v[112:113], v[110:111], v[110:111]
  v_pk_fma_f32 v[112:113], v[112:113], s[52:53], v[114:115]
  v_pk_mul_f32 v[112:113], v[112:113], v[110:111]
  v_exp_f32 v112, v112
  v_exp_f32 v113, v113
  s_nop 0
  v_pk_add_f32 v[112:113], v[112:113], s[54:55]
  v_rcp_f32 v112, v112
  v_rcp_f32 v113, v113
  s_nop 0
  v_pk_fma_f32 v[112:113], v[112:113], v[110:111], v[110:111] neg_lo:[1,0,0] neg_hi:[1,0,0]
  v_cvt_pk_bf16_f32 v125, v112, v113
  buffer_store_dwordx2 v[124:125], v12, s[20:23], s48 offen offset:160
  v_cvt_pk_bf16_f32 v108, v68, v69
  v_lshlrev_b32 v110, 16, v108
  v_and_b32 v111, 0xffff0000, v108
  v_pk_add_f32 v[110:111], v[110:111], v[96:97]
  v_cvt_pk_bf16_f32 v108, v110, v111
  v_lshlrev_b32 v110, 16, v108
  v_and_b32 v111, 0xffff0000, v108
  v_pk_mul_f32 v[112:113], v[110:111], v[110:111]
  v_pk_fma_f32 v[112:113], v[112:113], s[52:53], v[114:115]
  v_pk_mul_f32 v[112:113], v[112:113], v[110:111]
  v_exp_f32 v112, v112
  v_exp_f32 v113, v113
  s_nop 0
  v_pk_add_f32 v[112:113], v[112:113], s[54:55]
  v_rcp_f32 v112, v112
  v_rcp_f32 v113, v113
  s_nop 0
  v_pk_fma_f32 v[112:113], v[112:113], v[110:111], v[110:111] neg_lo:[1,0,0] neg_hi:[1,0,0]
  v_cvt_pk_bf16_f32 v126, v112, v113
  v_cvt_pk_bf16_f32 v108, v70, v71
  v_lshlrev_b32 v110, 16, v108
  v_and_b32 v111, 0xffff0000, v108
  v_pk_add_f32 v[110:111], v[110:111], v[98:99]
  v_cvt_pk_bf16_f32 v108, v110, v111
  v_lshlrev_b32 v110, 16, v108
  v_and_b32 v111, 0xffff0000, v108
  v_pk_mul_f32 v[112:113], v[110:111], v[110:111]
  v_pk_fma_f32 v[112:113], v[112:113], s[52:53], v[114:115]
  v_pk_mul_f32 v[112:113], v[112:113], v[110:111]
  v_exp_f32 v112, v112
  v_exp_f32 v113, v113
  s_nop 0
  v_pk_add_f32 v[112:113], v[112:113], s[54:55]
  v_rcp_f32 v112, v112
  v_rcp_f32 v113, v113
  s_nop 0
  v_pk_fma_f32 v[112:113], v[112:113], v[110:111], v[110:111] neg_lo:[1,0,0] neg_hi:[1,0,0]
  v_cvt_pk_bf16_f32 v127, v112, v113
  buffer_store_dwordx2 v[126:127], v12, s[20:23], s48 offen offset:192
L_k4_done:
  s_endpgm
.globl k5_kernel
.p2align 8
.type k5_kernel,@function
k5_kernel:
  s_cmp_ge_u32 s2, 256
  s_cbranch_scc1 L_k5_done
  s_load_dwordx2 s[4:5], s[0:1], 80
  s_load_dwordx2 s[6:7], s[0:1], 56
  s_load_dwordx2 s[8:9], s[0:1], 64
  v_readfirstlane_b32 s32, v0
  s_lshr_b32 s32, s32, 6
  s_and_b32 s33, s2, 7
  s_lshl_b32 s33, s33, 2
  s_lshr_b32 s45, s2, 6
  s_add_u32 s33, s33, s45
  s_lshl_b32 s33, s33, 6
  s_lshr_b32 s34, s2, 3
  s_and_b32 s34, s34, 7
  s_mul_i32 s34, s34, 80
  s_mul_i32 s35, s32, 36864
  s_mul_i32 s45, s32, 896
  s_add_u32 s46, s32, 0
  s_and_b32 s46, s46, 3
  s_lshl_b32 s46, s46, 4
  s_add_u32 s46, s46, s33
  s_mul_i32 s46, s46, 3456
  s_add_u32 s36, s46, s45
  s_add_u32 s46, s32, 1
  s_and_b32 s46, s46, 3
  s_lshl_b32 s46, s46, 4
  s_add_u32 s46, s46, s33
  s_mul_i32 s46, s46, 3456
  s_add_u32 s37, s46, s45
  s_add_u32 s46, s32, 2
  s_and_b32 s46, s46, 3
  s_lshl_b32 s46, s46, 4
  s_add_u32 s46, s46, s33
  s_mul_i32 s46, s46, 3456
  s_add_u32 s38, s46, s45
  s_add_u32 s46, s32, 3
  s_and_b32 s46, s46, 3
  s_lshl_b32 s46, s46, 4
  s_add_u32 s46, s46, s33
  s_mul_i32 s46, s46, 3456
  s_add_u32 s39, s46, s45
  s_add_u32 s46, s34, 0
  s_mul_i32 s46, s46, 3456
  s_add_u32 s40, s46, s45
  s_add_u32 s46, s34, 16
  s_mul_i32 s46, s46, 3456
  s_add_u32 s41, s46, s45
  s_add_u32 s46, s34, 32
  s_mul_i32 s46, s46, 3456
  s_add_u32 s42, s46, s45
  s_add_u32 s46, s34, 48
  s_mul_i32 s46, s46, 3456
  s_add_u32 s43, s46, s45
  s_add_u32 s46, s34, 64
  s_mul_i32 s46, s46, 3456
  s_add_u32 s44, s46, s45
  s_waitcnt lgkmcnt(0)
  s_add_u32 s12, s4, 18874368
  s_addc_u32 s13, s5, 0
  s_mov_b32 s14, 7077888
  s_mov_b32 s15, 0x00020000
  s_add_u32 s16, s4, 9437184
  s_addc_u32 s17, s5, 0
  s_mov_b32 s18, 2211840
  s_mov_b32 s19, 0x00020000
  s_add_u32 s20, s4, 12582912
  s_addc_u32 s21, s5, 0
  s_mov_b32 s22, 2621440
  s_mov_b32 s23, 0x00020000
  s_mov_b32 s24, s8
  s_mov_b32 s25, s9
  s_mov_b32 s26, 2621440
  s_mov_b32 s27, 0x00020000
  s_mov_b32 s28, s6
  s_mov_b32 s29, s7
  s_mov_b32 s30, 1280
  s_mov_b32 s31, 0x00020000
  v_and_b32 v1, 63, v0
  v_lshrrev_b32 v4, 3, v1
  v_and_b32 v5, 7, v1
  v_lshrrev_b32 v6, 1, v4
  v_xor_b32 v5, v5, v6
  v_mul_u32_u24 v2, 3456, v4
  v_lshlrev_b32 v6, 4, v5
  v_add_u32 v2, v2, v6
  v_xor_b32 v5, 4, v5
  v_lshlrev_b32 v6, 4, v5
  v_mul_u32_u24 v13, 3456, v4
  v_add_u32 v13, v13, v6
  v_add_u32 v13, 27648, v13
  v_and_b32 v4, 15, v1
  v_lshrrev_b32 v5, 4, v1
  v_lshrrev_b32 v6, 1, v4
  v_xor_b32 v5, v5, v6
  v_lshlrev_b32 v6, 4, v5
  v_lshl_add_u32 v3, v4, 7, v6
  v_add_u32 v3, s35, v3
  v_xor_b32 v5, 4, v5
  v_lshlrev_b32 v6, 4, v5
  v_lshl_add_u32 v14, v4, 7, v6
  v_add_u32 v14, s35, v14
  v_mov_b32 v16, 0
  v_mov_b32 v17, 0
  v_mov_b32 v18, 0
  v_mov_b32 v19, 0
  v_mov_b32 v20, 0
  v_mov_b32 v21, 0
  v_mov_b32 v22, 0
  v_mov_b32 v23, 0
  v_mov_b32 v24, 0
  v_mov_b32 v25, 0
  v_mov_b32 v26, 0
  v_mov_b32 v27, 0
  v_mov_b32 v28, 0
  v_mov_b32 v29, 0
  v_mov_b32 v30, 0
  v_mov_b32 v31, 0
  v_mov_b32 v32, 0
  v_mov_b32 v33, 0
  v_mov_b32 v34, 0
  v_mov_b32 v35, 0
  v_mov_b32 v36, 0
  v_mov_b32 v37, 0
  v_mov_b32 v38, 0
  v_mov_b32 v39, 0
  v_mov_b32 v40, 0
  v_mov_b32 v41, 0
  v_mov_b32 v42, 0
  v_mov_b32 v43, 0
  v_mov_b32 v44, 0
  v_mov_b32 v45, 0
  v_mov_b32 v46, 0
  v_mov_b32 v47, 0
  v_mov_b32 v48, 0
  v_mov_b32 v49, 0
  v_mov_b32 v50, 0
  v_mov_b32 v51, 0
  v_mov_b32 v52, 0
  v_mov_b32 v53, 0
  v_mov_b32 v54, 0
  v_mov_b32 v55, 0
  v_mov_b32 v56, 0
  v_mov_b32 v57, 0
  v_mov_b32 v58, 0
  v_mov_b32 v59, 0
  v_mov_b32 v60, 0
  v_mov_b32 v61, 0
  v_mov_b32 v62, 0
  v_mov_b32 v63, 0
  v_mov_b32 v64, 0
  v_mov_b32 v65, 0
  v_mov_b32 v66, 0
  v_mov_b32 v67, 0
  v_mov_b32 v68, 0
  v_mov_b32 v69, 0
  v_mov_b32 v70, 0
  v_mov_b32 v71, 0
  v_mov_b32 v72, 0
  v_mov_b32 v73, 0
  v_mov_b32 v74, 0
  v_mov_b32 v75, 0
  v_mov_b32 v76, 0
  v_mov_b32 v77, 0
  v_mov_b32 v78, 0
  v_mov_b32 v79, 0
  v_mov_b32 v80, 0
  v_mov_b32 v81, 0
  v_mov_b32 v82, 0
  v_mov_b32 v83, 0
  v_mov_b32 v84, 0
  v_mov_b32 v85, 0
  v_mov_b32 v86, 0
  v_mov_b32 v87, 0
  v_mov_b32 v88, 0
  v_mov_b32 v89, 0
  v_mov_b32 v90, 0
  v_mov_b32 v91, 0
  v_mov_b32 v92, 0
  v_mov_b32 v93, 0
  v_mov_b32 v94, 0
  v_mov_b32 v95, 0
  s_cmp_lt_u32 s32, 3
  s_cbranch_scc0 L_k5_varB
  v_mov_b32 v7, v2
  v_mov_b32 v15, v13
  s_add_u32 m0, s35, 0
  s_nop 0
  buffer_load_dwordx4 v7, s[16:19], s40 offen lds
  s_add_u32 m0, s35, 1024
  s_nop 0
  buffer_load_dwordx4 v15, s[16:19], s40 offen lds
  s_add_u32 m0, s35, 2048
  s_nop 0
  buffer_load_dwordx4 v7, s[16:19], s41 offen lds
  s_add_u32 m0, s35, 3072
  s_nop 0
  buffer_load_dwordx4 v15, s[16:19], s41 offen lds
  s_add_u32 m0, s35, 4096
  s_nop 0
  buffer_load_dwordx4 v7, s[16:19], s42 offen lds
  s_add_u32 m0, s35, 5120
  s_nop 0
  buffer_load_dwordx4 v15, s[16:19], s42 offen lds
  s_add_u32 m0, s35, 6144
  s_nop 0
  buffer_load_dwordx4 v7, s[16:19], s43 offen lds
  s_add_u32 m0, s35, 7168
  s_nop 0
  buffer_load_dwordx4 v15, s[16:19], s43 offen lds
  s_add_u32 m0, s35, 8192
  s_nop 0
  buffer_load_dwordx4 v7, s[16:19], s44 offen lds
  s_add_u32 m0, s35, 9216
  s_nop 0
  buffer_load_dwordx4 v15, s[16:19], s44 offen lds
  s_add_u32 m0, s35, 10240
  s_nop 0
  buffer_load_dwordx4 v7, s[12:15], s36 offen lds
  s_add_u32 m0, s35, 11264
  s_nop 0
  buffer_load_dwordx4 v15, s[12:15], s36 offen lds
  s_add_u32 m0, s35, 12288
  s_nop 0
  buffer_load_dwordx4 v7, s[12:15], s37 offen lds
  s_add_u32 m0, s35, 13312
  s_nop 0
  buffer_load_dwordx4 v15, s[12:15], s37 offen lds
  s_add_u32 m0, s35, 14336
  s_nop 0
  buffer_load_dwordx4 v7, s[12:15], s38 offen lds
  s_add_u32 m0, s35, 15360
  s_nop 0
  buffer_load_dwordx4 v15, s[12:15], s38 offen lds
  s_add_u32 m0, s35, 16384
  s_nop 0
  buffer_load_dwordx4 v7, s[12:15], s39 offen lds
  s_add_u32 m0, s35, 17408
  s_nop 0
  buffer_load_dwordx4 v15, s[12:15], s39 offen lds
  v_add_u32 v7, 128, v2
  v_add_u32 v15, 128, v13
  s_add_u32 m0, s35, 18432
  s_nop 0
  buffer_load_dwordx4 v7, s[16:19], s40 offen lds
  s_add_u32 m0, s35, 19456
  s_nop 0
  buffer_load_dwordx4 v15, s[16:19], s40 offen lds
  s_add_u32 m0, s35, 20480
  s_nop 0
  buffer_load_dwordx4 v7, s[16:19], s41 offen lds
  s_add_u32 m0, s35, 21504
  s_nop 0
  buffer_load_dwordx4 v15, s[16:19], s41 offen lds
  s_add_u32 m0, s35, 22528
  s_nop 0
  buffer_load_dwordx4 v7, s[16:19], s42 offen lds
  s_add_u32 m0, s35, 23552
  s_nop 0
  buffer_load_dwordx4 v15, s[16:19], s42 offen lds
  s_add_u32 m0, s35, 24576
  s_nop 0
  buffer_load_dwordx4 v7, s[16:19], s43 offen lds
  s_add_u32 m0, s35, 25600
  s_nop 0
  buffer_load_dwordx4 v15, s[16:19], s43 offen lds
  s_add_u32 m0, s35, 26624
  s_nop 0
  buffer_load_dwordx4 v7, s[16:19], s44 offen lds
  s_add_u32 m0, s35, 27648
  s_nop 0
  buffer_load_dwordx4 v15, s[16:19], s44 offen lds
  s_add_u32 m0, s35, 28672
  s_nop 0
  buffer_load_dwordx4 v7, s[12:15], s36 offen lds
  s_add_u32 m0, s35, 29696
  s_nop 0
  buffer_load_dwordx4 v15, s[12:15], s36 offen lds
  s_add_u32 m0, s35, 30720
  s_nop 0
  buffer_load_dwordx4 v7, s[12:15], s37 offen lds
  s_add_u32 m0, s35, 31744
  s_nop 0
  buffer_load_dwordx4 v15, s[12:15], s37 offen lds
  s_add_u32 m0, s35, 32768
  s_nop 0
  buffer_load_dwordx4 v7, s[12:15], s38 offen lds
  s_add_u32 m0, s35, 33792
  s_nop 0
  buffer_load_dwordx4 v15, s[12:15], s38 offen lds
  s_add_u32 m0, s35, 34816
  s_nop 0
  buffer_load_dwordx4 v7, s[12:15], s39 offen lds
  s_add_u32 m0, s35, 35840
  s_nop 0
  buffer_load_dwordx4 v15, s[12:15], s39 offen lds
  s_waitcnt vmcnt(18)
  ds_read_b128 v[96:99], v3 offset:0
  ds_read_b128 v[100:103], v3 offset:2048
  ds_read_b128 v[104:107], v3 offset:4096
  ds_read_b128 v[108:111], v3 offset:6144
  ds_read_b128 v[112:115], v3 offset:8192
  ds_read_b128 v[116:119], v3 offset:10240
  ds_read_b128 v[120:123], v3 offset:12288
  ds_read_b128 v[124:127], v3 offset:14336
  ds_read_b128 v[128:131], v3 offset:16384
  ds_read_b128 v[132:135], v14 offset:0
  ds_read_b128 v[136:139], v14 offset:2048
  ds_read_b128 v[140:143], v14 offset:4096
  ds_read_b128 v[144:147], v14 offset:6144
  ds_read_b128 v[148:151], v14 offset:8192
  ds_read_b128 v[152:155], v14 offset:10240
  ds_read_b128 v[156:159], v14 offset:12288
  ds_read_b128 v[160:163], v14 offset:14336
  ds_read_b128 v[164:167], v14 offset:16384
  s_waitcnt lgkmcnt(9)
  v_mfma_f32_16x16x32_bf16 v[16:19], v[96:99], v[116:119], v[16:19]
  v_mfma_f32_16x16x32_bf16 v[32:35], v[100:103], v[116:119], v[32:35]
  v_mfma_f32_16x16x32_bf16 v[48:51], v[104:107], v[116:119], v[48:51]
  v_mfma_f32_16x16x32_bf16 v[64:67], v[108:111], v[116:119], v[64:67]
  v_mfma_f32_16x16x32_bf16 v[80:83], v[112:115], v[116:119], v[80:83]
  v_mfma_f32_16x16x32_bf16 v[20:23], v[96:99], v[120:123], v[20:23]
  v_mfma_f32_16x16x32_bf16 v[36:39], v[100:103], v[120:123], v[36:39]
  v_mfma_f32_16x16x32_bf16 v[52:55], v[104:107], v[120:123], v[52:55]
  v_mfma_f32_16x16x32_bf16 v[68:71], v[108:111], v[120:123], v[68:71]
  v_mfma_f32_16x16x32_bf16 v[84:87], v[112:115], v[120:123], v[84:87]
  v_mfma_f32_16x16x32_bf16 v[24:27], v[96:99], v[124:127], v[24:27]
  v_mfma_f32_16x16x32_bf16 v[40:43], v[100:103], v[124:127], v[40:43]
  v_mfma_f32_16x16x32_bf16 v[56:59], v[104:107], v[124:127], v[56:59]
  v_mfma_f32_16x16x32_bf16 v[72:75], v[108:111], v[124:127], v[72:75]
  v_mfma_f32_16x16x32_bf16 v[88:91], v[112:115], v[124:127], v[88:91]
  v_mfma_f32_16x16x32_bf16 v[28:31], v[96:99], v[128:131], v[28:31]
  v_mfma_f32_16x16x32_bf16 v[44:47], v[100:103], v[128:131], v[44:47]
  v_mfma_f32_16x16x32_bf16 v[60:63], v[104:107], v[128:131], v[60:63]
  v_mfma_f32_16x16x32_bf16 v[76:79], v[108:111], v[128:131], v[76:79]
  v_mfma_f32_16x16x32_bf16 v[92:95], v[112:115], v[128:131], v[92:95]
  s_waitcnt vmcnt(0)
  ds_read_b128 v[96:99], v3 offset:18432
  ds_read_b128 v[100:103], v3 offset:20480
  ds_read_b128 v[104:107], v3 offset:22528
  ds_read_b128 v[108:111], v3 offset:24576
  ds_read_b128 v[112:115], v3 offset:26624
  ds_read_b128 v[116:119], v3 offset:28672
  ds_read_b128 v[120:123], v3 offset:30720
  ds_read_b128 v[124:127], v3 offset:32768
  ds_read_b128 v[128:131], v3 offset:34816
  s_waitcnt lgkmcnt(9)
  v_add_u32 v7, 256, v2
  v_add_u32 v15, 256, v13
  s_add_u32 m0, s35, 0
  s_nop 0
  buffer_load_dwordx4 v7, s[16:19], s40 offen lds
  s_add_u32 m0, s35, 1024
  s_nop 0
  buffer_load_dwordx4 v15, s[16:19], s40 offen lds
  s_add_u32 m0, s35, 2048
  s_nop 0
  buffer_load_dwordx4 v7, s[16:19], s41 offen lds
  s_add_u32 m0, s35, 3072
  s_nop 0
  buffer_load_dwordx4 v15, s[16:19], s41 offen lds
  s_add_u32 m0, s35, 4096
  s_nop 0
  buffer_load_dwordx4 v7, s[16:19], s42 offen lds
  s_add_u32 m0, s35, 5120
  s_nop 0
  buffer_load_dwordx4 v15, s[16:19], s42 offen lds
  s_add_u32 m0, s35, 6144
  s_nop 0
  buffer_load_dwordx4 v7, s[16:19], s43 offen lds
  s_add_u32 m0, s35, 7168
  s_nop 0
  buffer_load_dwordx4 v15, s[16:19], s43 offen lds
  s_add_u32 m0, s35, 8192
  s_nop 0
  buffer_load_dwordx4 v7, s[16:19], s44 offen lds
  s_add_u32 m0, s35, 9216
  s_nop 0
  buffer_load_dwordx4 v15, s[16:19], s44 offen lds
  s_add_u32 m0, s35, 10240
  s_nop 0
  buffer_load_dwordx4 v7, s[12:15], s36 offen lds
  s_add_u32 m0, s35, 11264
  s_nop 0
  buffer_load_dwordx4 v15, s[12:15], s36 offen lds
  s_add_u32 m0, s35, 12288
  s_nop 0
  buffer_load_dwordx4 v7, s[12:15], s37 offen lds
  s_add_u32 m0, s35, 13312
  s_nop 0
  buffer_load_dwordx4 v15, s[12:15], s37 offen lds
  s_add_u32 m0, s35, 14336
  s_nop 0
  buffer_load_dwordx4 v7, s[12:15], s38 offen lds
  s_add_u32 m0, s35, 15360
  s_nop 0
  buffer_load_dwordx4 v15, s[12:15], s38 offen lds
  s_add_u32 m0, s35, 16384
  s_nop 0
  buffer_load_dwordx4 v7, s[12:15], s39 offen lds
  s_add_u32 m0, s35, 17408
  s_nop 0
  buffer_load_dwordx4 v15, s[12:15], s39 offen lds
  v_mfma_f32_16x16x32_bf16 v[16:19], v[132:135], v[152:155], v[16:19]
  v_mfma_f32_16x16x32_bf16 v[32:35], v[136:139], v[152:155], v[32:35]
  v_mfma_f32_16x16x32_bf16 v[48:51], v[140:143], v[152:155], v[48:51]
  v_mfma_f32_16x16x32_bf16 v[64:67], v[144:147], v[152:155], v[64:67]
  v_mfma_f32_16x16x32_bf16 v[80:83], v[148:151], v[152:155], v[80:83]
  v_mfma_f32_16x16x32_bf16 v[20:23], v[132:135], v[156:159], v[20:23]
  v_mfma_f32_16x16x32_bf16 v[36:39], v[136:139], v[156:159], v[36:39]
  v_mfma_f32_16x16x32_bf16 v[52:55], v[140:143], v[156:159], v[52:55]
  v_mfma_f32_16x16x32_bf16 v[68:71], v[144:147], v[156:159], v[68:71]
  v_mfma_f32_16x16x32_bf16 v[84:87], v[148:151], v[156:159], v[84:87]
  v_mfma_f32_16x16x32_bf16 v[24:27], v[132:135], v[160:163], v[24:27]
  v_mfma_f32_16x16x32_bf16 v[40:43], v[136:139], v[160:163], v[40:43]
  v_mfma_f32_16x16x32_bf16 v[56:59], v[140:143], v[160:163], v[56:59]
  v_mfma_f32_16x16x32_bf16 v[72:75], v[144:147], v[160:163], v[72:75]
  v_mfma_f32_16x16x32_bf16 v[88:91], v[148:151], v[160:163], v[88:91]
  v_mfma_f32_16x16x32_bf16 v[28:31], v[132:135], v[164:167], v[28:31]
  v_mfma_f32_16x16x32_bf16 v[44:47], v[136:139], v[164:167], v[44:47]
  v_mfma_f32_16x16x32_bf16 v[60:63], v[140:143], v[164:167], v[60:63]
  v_mfma_f32_16x16x32_bf16 v[76:79], v[144:147], v[164:167], v[76:79]
  v_mfma_f32_16x16x32_bf16 v[92:95], v[148:151], v[164:167], v[92:95]
  ds_read_b128 v[132:135], v14 offset:18432
  ds_read_b128 v[136:139], v14 offset:20480
  ds_read_b128 v[140:143], v14 offset:22528
  ds_read_b128 v[144:147], v14 offset:24576
  ds_read_b128 v[148:151], v14 offset:26624
  ds_read_b128 v[152:155], v14 offset:28672
  ds_read_b128 v[156:159], v14 offset:30720
  ds_read_b128 v[160:163], v14 offset:32768
  ds_read_b128 v[164:167], v14 offset:34816
  s_waitcnt lgkmcnt(9)
  v_mfma_f32_16x16x32_bf16 v[16:19], v[96:99], v[116:119], v[16:19]
  v_mfma_f32_16x16x32_bf16 v[32:35], v[100:103], v[116:119], v[32:35]
  v_mfma_f32_16x16x32_bf16 v[48:51], v[104:107], v[116:119], v[48:51]
  v_mfma_f32_16x16x32_bf16 v[64:67], v[108:111], v[116:119], v[64:67]
  v_mfma_f32_16x16x32_bf16 v[80:83], v[112:115], v[116:119], v[80:83]
  v_mfma_f32_16x16x32_bf16 v[20:23], v[96:99], v[120:123], v[20:23]
  v_mfma_f32_16x16x32_bf16 v[36:39], v[100:103], v[120:123], v[36:39]
  v_mfma_f32_16x16x32_bf16 v[52:55], v[104:107], v[120:123], v[52:55]
  v_mfma_f32_16x16x32_bf16 v[68:71], v[108:111], v[120:123], v[68:71]
  v_mfma_f32_16x16x32_bf16 v[84:87], v[112:115], v[120:123], v[84:87]
  v_mfma_f32_16x16x32_bf16 v[24:27], v[96:99], v[124:127], v[24:27]
  v_mfma_f32_16x16x32_bf16 v[40:43], v[100:103], v[124:127], v[40:43]
  v_mfma_f32_16x16x32_bf16 v[56:59], v[104:107], v[124:127], v[56:59]
  v_mfma_f32_16x16x32_bf16 v[72:75], v[108:111], v[124:127], v[72:75]
  v_mfma_f32_16x16x32_bf16 v[88:91], v[112:115], v[124:127], v[88:91]
  v_mfma_f32_16x16x32_bf16 v[28:31], v[96:99], v[128:131], v[28:31]
  v_mfma_f32_16x16x32_bf16 v[44:47], v[100:103], v[128:131], v[44:47]
  v_mfma_f32_16x16x32_bf16 v[60:63], v[104:107], v[128:131], v[60:63]
  v_mfma_f32_16x16x32_bf16 v[76:79], v[108:111], v[128:131], v[76:79]
  v_mfma_f32_16x16x32_bf16 v[92:95], v[112:115], v[128:131], v[92:95]
  s_waitcnt vmcnt(0)
  ds_read_b128 v[96:99], v3 offset:0
  ds_read_b128 v[100:103], v3 offset:2048
  ds_read_b128 v[104:107], v3 offset:4096
  ds_read_b128 v[108:111], v3 offset:6144
  ds_read_b128 v[112:115], v3 offset:8192
  ds_read_b128 v[116:119], v3 offset:10240
  ds_read_b128 v[120:123], v3 offset:12288
  ds_read_b128 v[124:127], v3 offset:14336
  ds_read_b128 v[128:131], v3 offset:16384
  s_waitcnt lgkmcnt(9)
  v_add_u32 v7, 384, v2
  v_add_u32 v15, 384, v13
  s_add_u32 m0, s35, 18432
  s_nop 0
  buffer_load_dwordx4 v7, s[16:19], s40 offen lds
  s_add_u32 m0, s35, 19456
  s_nop 0
  buffer_load_dwordx4 v15, s[16:19], s40 offen lds
  s_add_u32 m0, s35, 20480
  s_nop 0
  buffer_load_dwordx4 v7, s[16:19], s41 offen lds
  s_add_u32 m0, s35, 21504
  s_nop 0
  buffer_load_dwordx4 v15, s[16:19], s41 offen lds
  s_add_u32 m0, s35, 22528
  s_nop 0
  buffer_load_dwordx4 v7, s[16:19], s42 offen lds
  s_add_u32 m0, s35, 23552
  s_nop 0
  buffer_load_dwordx4 v15, s[16:19], s42 offen lds
  s_add_u32 m0, s35, 24576
  s_nop 0
  buffer_load_dwordx4 v7, s[16:19], s43 offen lds
  s_add_u32 m0, s35, 25600
  s_nop 0
  buffer_load_dwordx4 v15, s[16:19], s43 offen lds
  s_add_u32 m0, s35, 26624
  s_nop 0
  buffer_load_dwordx4 v7, s[16:19], s44 offen lds
  s_add_u32 m0, s35, 27648
  s_nop 0
  buffer_load_dwordx4 v15, s[16:19], s44 offen lds
  s_add_u32 m0, s35, 28672
  s_nop 0
  buffer_load_dwordx4 v7, s[12:15], s36 offen lds
  s_add_u32 m0, s35, 29696
  s_nop 0
  buffer_load_dwordx4 v15, s[12:15], s36 offen lds
  s_add_u32 m0, s35, 30720
  s_nop 0
  buffer_load_dwordx4 v7, s[12:15], s37 offen lds
  s_add_u32 m0, s35, 31744
  s_nop 0
  buffer_load_dwordx4 v15, s[12:15], s37 offen lds
  s_add_u32 m0, s35, 32768
  s_nop 0
  buffer_load_dwordx4 v7, s[12:15], s38 offen lds
  s_add_u32 m0, s35, 33792
  s_nop 0
  buffer_load_dwordx4 v15, s[12:15], s38 offen lds
  s_add_u32 m0, s35, 34816
  s_nop 0
  buffer_load_dwordx4 v7, s[12:15], s39 offen lds
  s_add_u32 m0, s35, 35840
  s_nop 0
  buffer_load_dwordx4 v15, s[12:15], s39 offen lds
  v_mfma_f32_16x16x32_bf16 v[16:19], v[132:135], v[152:155], v[16:19]
  v_mfma_f32_16x16x32_bf16 v[32:35], v[136:139], v[152:155], v[32:35]
  v_mfma_f32_16x16x32_bf16 v[48:51], v[140:143], v[152:155], v[48:51]
  v_mfma_f32_16x16x32_bf16 v[64:67], v[144:147], v[152:155], v[64:67]
  v_mfma_f32_16x16x32_bf16 v[80:83], v[148:151], v[152:155], v[80:83]
  v_mfma_f32_16x16x32_bf16 v[20:23], v[132:135], v[156:159], v[20:23]
  v_mfma_f32_16x16x32_bf16 v[36:39], v[136:139], v[156:159], v[36:39]
  v_mfma_f32_16x16x32_bf16 v[52:55], v[140:143], v[156:159], v[52:55]
  v_mfma_f32_16x16x32_bf16 v[68:71], v[144:147], v[156:159], v[68:71]
  v_mfma_f32_16x16x32_bf16 v[84:87], v[148:151], v[156:159], v[84:87]
  v_mfma_f32_16x16x32_bf16 v[24:27], v[132:135], v[160:163], v[24:27]
  v_mfma_f32_16x16x32_bf16 v[40:43], v[136:139], v[160:163], v[40:43]
  v_mfma_f32_16x16x32_bf16 v[56:59], v[140:143], v[160:163], v[56:59]
  v_mfma_f32_16x16x32_bf16 v[72:75], v[144:147], v[160:163], v[72:75]
  v_mfma_f32_16x16x32_bf16 v[88:91], v[148:151], v[160:163], v[88:91]
  v_mfma_f32_16x16x32_bf16 v[28:31], v[132:135], v[164:167], v[28:31]
  v_mfma_f32_16x16x32_bf16 v[44:47], v[136:139], v[164:167], v[44:47]
  v_mfma_f32_16x16x32_bf16 v[60:63], v[140:143], v[164:167], v[60:63]
  v_mfma_f32_16x16x32_bf16 v[76:79], v[144:147], v[164:167], v[76:79]
  v_mfma_f32_16x16x32_bf16 v[92:95], v[148:151], v[164:167], v[92:95]
  ds_read_b128 v[132:135], v14 offset:0
  ds_read_b128 v[136:139], v14 offset:2048
  ds_read_b128 v[140:143], v14 offset:4096
  ds_read_b128 v[144:147], v14 offset:6144
  ds_read_b128 v[148:151], v14 offset:8192
  ds_read_b128 v[152:155], v14 offset:10240
  ds_read_b128 v[156:159], v14 offset:12288
  ds_read_b128 v[160:163], v14 offset:14336
  ds_read_b128 v[164:167], v14 offset:16384
  s_waitcnt lgkmcnt(9)
  v_mfma_f32_16x16x32_bf16 v[16:19], v[96:99], v[116:119], v[16:19]
  v_mfma_f32_16x16x32_bf16 v[32:35], v[100:103], v[116:119], v[32:35]
  v_mfma_f32_16x16x32_bf16 v[48:51], v[104:107], v[116:119], v[48:51]
  v_mfma_f32_16x16x32_bf16 v[64:67], v[108:111], v[116:119], v[64:67]
  v_mfma_f32_16x16x32_bf16 v[80:83], v[112:115], v[116:119], v[80:83]
  v_mfma_f32_16x16x32_bf16 v[20:23], v[96:99], v[120:123], v[20:23]
  v_mfma_f32_16x16x32_bf16 v[36:39], v[100:103], v[120:123], v[36:39]
  v_mfma_f32_16x16x32_bf16 v[52:55], v[104:107], v[120:123], v[52:55]
  v_mfma_f32_16x16x32_bf16 v[68:71], v[108:111], v[120:123], v[68:71]
  v_mfma_f32_16x16x32_bf16 v[84:87], v[112:115], v[120:123], v[84:87]
  v_mfma_f32_16x16x32_bf16 v[24:27], v[96:99], v[124:127], v[24:27]
  v_mfma_f32_16x16x32_bf16 v[40:43], v[100:103], v[124:127], v[40:43]
  v_mfma_f32_16x16x32_bf16 v[56:59], v[104:107], v[124:127], v[56:59]
  v_mfma_f32_16x16x32_bf16 v[72:75], v[108:111], v[124:127], v[72:75]
  v_mfma_f32_16x16x32_bf16 v[88:91], v[112:115], v[124:127], v[88:91]
  v_mfma_f32_16x16x32_bf16 v[28:31], v[96:99], v[128:131], v[28:31]
  v_mfma_f32_16x16x32_bf16 v[44:47], v[100:103], v[128:131], v[44:47]
  v_mfma_f32_16x16x32_bf16 v[60:63], v[104:107], v[128:131], v[60:63]
  v_mfma_f32_16x16x32_bf16 v[76:79], v[108:111], v[128:131], v[76:79]
  v_mfma_f32_16x16x32_bf16 v[92:95], v[112:115], v[128:131], v[92:95]
  s_waitcnt vmcnt(0)
  ds_read_b128 v[96:99], v3 offset:18432
  ds_read_b128 v[100:103], v3 offset:20480
  ds_read_b128 v[104:107], v3 offset:22528
  ds_read_b128 v[108:111], v3 offset:24576
  ds_read_b128 v[112:115], v3 offset:26624
  ds_read_b128 v[116:119], v3 offset:28672
  ds_read_b128 v[120:123], v3 offset:30720
  ds_read_b128 v[124:127], v3 offset:32768
  ds_read_b128 v[128:131], v3 offset:34816
  s_waitcnt lgkmcnt(9)
  v_add_u32 v7, 512, v2
  v_add_u32 v15, 512, v13
  s_add_u32 m0, s35, 0
  s_nop 0
  buffer_load_dwordx4 v7, s[16:19], s40 offen lds
  s_add_u32 m0, s35, 1024
  s_nop 0
  buffer_load_dwordx4 v15, s[16:19], s40 offen lds
  s_add_u32 m0, s35, 2048
  s_nop 0
  buffer_load_dwordx4 v7, s[16:19], s41 offen lds
  s_add_u32 m0, s35, 3072
  s_nop 0
  buffer_load_dwordx4 v15, s[16:19], s41 offen lds
  s_add_u32 m0, s35, 4096
  s_nop 0
  buffer_load_dwordx4 v7, s[16:19], s42 offen lds
  s_add_u32 m0, s35, 5120
  s_nop 0
  buffer_load_dwordx4 v15, s[16:19], s42 offen lds
  s_add_u32 m0, s35, 6144
  s_nop 0
  buffer_load_dwordx4 v7, s[16:19], s43 offen lds
  s_add_u32 m0, s35, 7168
  s_nop 0
  buffer_load_dwordx4 v15, s[16:19], s43 offen lds
  s_add_u32 m0, s35, 8192
  s_nop 0
  buffer_load_dwordx4 v7, s[16:19], s44 offen lds
  s_add_u32 m0, s35, 9216
  s_nop 0
  buffer_load_dwordx4 v15, s[16:19], s44 offen lds
  s_add_u32 m0, s35, 10240
  s_nop 0
  buffer_load_dwordx4 v7, s[12:15], s36 offen lds
  s_add_u32 m0, s35, 11264
  s_nop 0
  buffer_load_dwordx4 v15, s[12:15], s36 offen lds
  s_add_u32 m0, s35, 12288
  s_nop 0
  buffer_load_dwordx4 v7, s[12:15], s37 offen lds
  s_add_u32 m0, s35, 13312
  s_nop 0
  buffer_load_dwordx4 v15, s[12:15], s37 offen lds
  s_add_u32 m0, s35, 14336
  s_nop 0
  buffer_load_dwordx4 v7, s[12:15], s38 offen lds
  s_add_u32 m0, s35, 15360
  s_nop 0
  buffer_load_dwordx4 v15, s[12:15], s38 offen lds
  s_add_u32 m0, s35, 16384
  s_nop 0
  buffer_load_dwordx4 v7, s[12:15], s39 offen lds
  s_add_u32 m0, s35, 17408
  s_nop 0
  buffer_load_dwordx4 v15, s[12:15], s39 offen lds
  v_mfma_f32_16x16x32_bf16 v[16:19], v[132:135], v[152:155], v[16:19]
  v_mfma_f32_16x16x32_bf16 v[32:35], v[136:139], v[152:155], v[32:35]
  v_mfma_f32_16x16x32_bf16 v[48:51], v[140:143], v[152:155], v[48:51]
  v_mfma_f32_16x16x32_bf16 v[64:67], v[144:147], v[152:155], v[64:67]
  v_mfma_f32_16x16x32_bf16 v[80:83], v[148:151], v[152:155], v[80:83]
  v_mfma_f32_16x16x32_bf16 v[20:23], v[132:135], v[156:159], v[20:23]
  v_mfma_f32_16x16x32_bf16 v[36:39], v[136:139], v[156:159], v[36:39]
  v_mfma_f32_16x16x32_bf16 v[52:55], v[140:143], v[156:159], v[52:55]
  v_mfma_f32_16x16x32_bf16 v[68:71], v[144:147], v[156:159], v[68:71]
  v_mfma_f32_16x16x32_bf16 v[84:87], v[148:151], v[156:159], v[84:87]
  v_mfma_f32_16x16x32_bf16 v[24:27], v[132:135], v[160:163], v[24:27]
  v_mfma_f32_16x16x32_bf16 v[40:43], v[136:139], v[160:163], v[40:43]
  v_mfma_f32_16x16x32_bf16 v[56:59], v[140:143], v[160:163], v[56:59]
  v_mfma_f32_16x16x32_bf16 v[72:75], v[144:147], v[160:163], v[72:75]
  v_mfma_f32_16x16x32_bf16 v[88:91], v[148:151], v[160:163], v[88:91]
  v_mfma_f32_16x16x32_bf16 v[28:31], v[132:135], v[164:167], v[28:31]
  v_mfma_f32_16x16x32_bf16 v[44:47], v[136:139], v[164:167], v[44:47]
  v_mfma_f32_16x16x32_bf16 v[60:63], v[140:143], v[164:167], v[60:63]
  v_mfma_f32_16x16x32_bf16 v[76:79], v[144:147], v[164:167], v[76:79]
  v_mfma_f32_16x16x32_bf16 v[92:95], v[148:151], v[164:167], v[92:95]
  ds_read_b128 v[132:135], v14 offset:18432
  ds_read_b128 v[136:139], v14 offset:20480
  ds_read_b128 v[140:143], v14 offset:22528
  ds_read_b128 v[144:147], v14 offset:24576
  ds_read_b128 v[148:151], v14 offset:26624
  ds_read_b128 v[152:155], v14 offset:28672
  ds_read_b128 v[156:159], v14 offset:30720
  ds_read_b128 v[160:163], v14 offset:32768
  ds_read_b128 v[164:167], v14 offset:34816
  s_waitcnt lgkmcnt(9)
  v_mfma_f32_16x16x32_bf16 v[16:19], v[96:99], v[116:119], v[16:19]
  v_mfma_f32_16x16x32_bf16 v[32:35], v[100:103], v[116:119], v[32:35]
  v_mfma_f32_16x16x32_bf16 v[48:51], v[104:107], v[116:119], v[48:51]
  v_mfma_f32_16x16x32_bf16 v[64:67], v[108:111], v[116:119], v[64:67]
  v_mfma_f32_16x16x32_bf16 v[80:83], v[112:115], v[116:119], v[80:83]
  v_mfma_f32_16x16x32_bf16 v[20:23], v[96:99], v[120:123], v[20:23]
  v_mfma_f32_16x16x32_bf16 v[36:39], v[100:103], v[120:123], v[36:39]
  v_mfma_f32_16x16x32_bf16 v[52:55], v[104:107], v[120:123], v[52:55]
  v_mfma_f32_16x16x32_bf16 v[68:71], v[108:111], v[120:123], v[68:71]
  v_mfma_f32_16x16x32_bf16 v[84:87], v[112:115], v[120:123], v[84:87]
  v_mfma_f32_16x16x32_bf16 v[24:27], v[96:99], v[124:127], v[24:27]
  v_mfma_f32_16x16x32_bf16 v[40:43], v[100:103], v[124:127], v[40:43]
  v_mfma_f32_16x16x32_bf16 v[56:59], v[104:107], v[124:127], v[56:59]
  v_mfma_f32_16x16x32_bf16 v[72:75], v[108:111], v[124:127], v[72:75]
  v_mfma_f32_16x16x32_bf16 v[88:91], v[112:115], v[124:127], v[88:91]
  v_mfma_f32_16x16x32_bf16 v[28:31], v[96:99], v[128:131], v[28:31]
  v_mfma_f32_16x16x32_bf16 v[44:47], v[100:103], v[128:131], v[44:47]
  v_mfma_f32_16x16x32_bf16 v[60:63], v[104:107], v[128:131], v[60:63]
  v_mfma_f32_16x16x32_bf16 v[76:79], v[108:111], v[128:131], v[76:79]
  v_mfma_f32_16x16x32_bf16 v[92:95], v[112:115], v[128:131], v[92:95]
  s_waitcnt vmcnt(0)
  ds_read_b128 v[96:99], v3 offset:0
  ds_read_b128 v[100:103], v3 offset:2048
  ds_read_b128 v[104:107], v3 offset:4096
  ds_read_b128 v[108:111], v3 offset:6144
  ds_read_b128 v[112:115], v3 offset:8192
  ds_read_b128 v[116:119], v3 offset:10240
  ds_read_b128 v[120:123], v3 offset:12288
  ds_read_b128 v[124:127], v3 offset:14336
  ds_read_b128 v[128:131], v3 offset:16384
  s_waitcnt lgkmcnt(9)
  v_add_u32 v7, 640, v2
  v_add_u32 v15, 640, v13
  s_add_u32 m0, s35, 18432
  s_nop 0
  buffer_load_dwordx4 v7, s[16:19], s40 offen lds
  s_add_u32 m0, s35, 19456
  s_nop 0
  buffer_load_dwordx4 v15, s[16:19], s40 offen lds
  s_add_u32 m0, s35, 20480
  s_nop 0
  buffer_load_dwordx4 v7, s[16:19], s41 offen lds
  s_add_u32 m0, s35, 21504
  s_nop 0
  buffer_load_dwordx4 v15, s[16:19], s41 offen lds
  s_add_u32 m0, s35, 22528
  s_nop 0
  buffer_load_dwordx4 v7, s[16:19], s42 offen lds
  s_add_u32 m0, s35, 23552
  s_nop 0
  buffer_load_dwordx4 v15, s[16:19], s42 offen lds
  s_add_u32 m0, s35, 24576
  s_nop 0
  buffer_load_dwordx4 v7, s[16:19], s43 offen lds
  s_add_u32 m0, s35, 25600
  s_nop 0
  buffer_load_dwordx4 v15, s[16:19], s43 offen lds
  s_add_u32 m0, s35, 26624
  s_nop 0
  buffer_load_dwordx4 v7, s[16:19], s44 offen lds
  s_add_u32 m0, s35, 27648
  s_nop 0
  buffer_load_dwordx4 v15, s[16:19], s44 offen lds
  s_add_u32 m0, s35, 28672
  s_nop 0
  buffer_load_dwordx4 v7, s[12:15], s36 offen lds
  s_add_u32 m0, s35, 29696
  s_nop 0
  buffer_load_dwordx4 v15, s[12:15], s36 offen lds
  s_add_u32 m0, s35, 30720
  s_nop 0
  buffer_load_dwordx4 v7, s[12:15], s37 offen lds
  s_add_u32 m0, s35, 31744
  s_nop 0
  buffer_load_dwordx4 v15, s[12:15], s37 offen lds
  s_add_u32 m0, s35, 32768
  s_nop 0
  buffer_load_dwordx4 v7, s[12:15], s38 offen lds
  s_add_u32 m0, s35, 33792
  s_nop 0
  buffer_load_dwordx4 v15, s[12:15], s38 offen lds
  s_add_u32 m0, s35, 34816
  s_nop 0
  buffer_load_dwordx4 v7, s[12:15], s39 offen lds
  s_add_u32 m0, s35, 35840
  s_nop 0
  buffer_load_dwordx4 v15, s[12:15], s39 offen lds
  v_mfma_f32_16x16x32_bf16 v[16:19], v[132:135], v[152:155], v[16:19]
  v_mfma_f32_16x16x32_bf16 v[32:35], v[136:139], v[152:155], v[32:35]
  v_mfma_f32_16x16x32_bf16 v[48:51], v[140:143], v[152:155], v[48:51]
  v_mfma_f32_16x16x32_bf16 v[64:67], v[144:147], v[152:155], v[64:67]
  v_mfma_f32_16x16x32_bf16 v[80:83], v[148:151], v[152:155], v[80:83]
  v_mfma_f32_16x16x32_bf16 v[20:23], v[132:135], v[156:159], v[20:23]
  v_mfma_f32_16x16x32_bf16 v[36:39], v[136:139], v[156:159], v[36:39]
  v_mfma_f32_16x16x32_bf16 v[52:55], v[140:143], v[156:159], v[52:55]
  v_mfma_f32_16x16x32_bf16 v[68:71], v[144:147], v[156:159], v[68:71]
  v_mfma_f32_16x16x32_bf16 v[84:87], v[148:151], v[156:159], v[84:87]
  v_mfma_f32_16x16x32_bf16 v[24:27], v[132:135], v[160:163], v[24:27]
  v_mfma_f32_16x16x32_bf16 v[40:43], v[136:139], v[160:163], v[40:43]
  v_mfma_f32_16x16x32_bf16 v[56:59], v[140:143], v[160:163], v[56:59]
  v_mfma_f32_16x16x32_bf16 v[72:75], v[144:147], v[160:163], v[72:75]
  v_mfma_f32_16x16x32_bf16 v[88:91], v[148:151], v[160:163], v[88:91]
  v_mfma_f32_16x16x32_bf16 v[28:31], v[132:135], v[164:167], v[28:31]
  v_mfma_f32_16x16x32_bf16 v[44:47], v[136:139], v[164:167], v[44:47]
  v_mfma_f32_16x16x32_bf16 v[60:63], v[140:143], v[164:167], v[60:63]
  v_mfma_f32_16x16x32_bf16 v[76:79], v[144:147], v[164:167], v[76:79]
  v_mfma_f32_16x16x32_bf16 v[92:95], v[148:151], v[164:167], v[92:95]
  ds_read_b128 v[132:135], v14 offset:0
  ds_read_b128 v[136:139], v14 offset:2048
  ds_read_b128 v[140:143], v14 offset:4096
  ds_read_b128 v[144:147], v14 offset:6144
  ds_read_b128 v[148:151], v14 offset:8192
  ds_read_b128 v[152:155], v14 offset:10240
  ds_read_b128 v[156:159], v14 offset:12288
  ds_read_b128 v[160:163], v14 offset:14336
  ds_read_b128 v[164:167], v14 offset:16384
  s_waitcnt lgkmcnt(9)
  v_mfma_f32_16x16x32_bf16 v[16:19], v[96:99], v[116:119], v[16:19]
  v_mfma_f32_16x16x32_bf16 v[32:35], v[100:103], v[116:119], v[32:35]
  v_mfma_f32_16x16x32_bf16 v[48:51], v[104:107], v[116:119], v[48:51]
  v_mfma_f32_16x16x32_bf16 v[64:67], v[108:111], v[116:119], v[64:67]
  v_mfma_f32_16x16x32_bf16 v[80:83], v[112:115], v[116:119], v[80:83]
  v_mfma_f32_16x16x32_bf16 v[20:23], v[96:99], v[120:123], v[20:23]
  v_mfma_f32_16x16x32_bf16 v[36:39], v[100:103], v[120:123], v[36:39]
  v_mfma_f32_16x16x32_bf16 v[52:55], v[104:107], v[120:123], v[52:55]
  v_mfma_f32_16x16x32_bf16 v[68:71], v[108:111], v[120:123], v[68:71]
  v_mfma_f32_16x16x32_bf16 v[84:87], v[112:115], v[120:123], v[84:87]
  v_mfma_f32_16x16x32_bf16 v[24:27], v[96:99], v[124:127], v[24:27]
  v_mfma_f32_16x16x32_bf16 v[40:43], v[100:103], v[124:127], v[40:43]
  v_mfma_f32_16x16x32_bf16 v[56:59], v[104:107], v[124:127], v[56:59]
  v_mfma_f32_16x16x32_bf16 v[72:75], v[108:111], v[124:127], v[72:75]
  v_mfma_f32_16x16x32_bf16 v[88:91], v[112:115], v[124:127], v[88:91]
  v_mfma_f32_16x16x32_bf16 v[28:31], v[96:99], v[128:131], v[28:31]
  v_mfma_f32_16x16x32_bf16 v[44:47], v[100:103], v[128:131], v[44:47]
  v_mfma_f32_16x16x32_bf16 v[60:63], v[104:107], v[128:131], v[60:63]
  v_mfma_f32_16x16x32_bf16 v[76:79], v[108:111], v[128:131], v[76:79]
  v_mfma_f32_16x16x32_bf16 v[92:95], v[112:115], v[128:131], v[92:95]
  s_waitcnt vmcnt(0)
  ds_read_b128 v[96:99], v3 offset:18432
  ds_read_b128 v[100:103], v3 offset:20480
  ds_read_b128 v[104:107], v3 offset:22528
  ds_read_b128 v[108:111], v3 offset:24576
  ds_read_b128 v[112:115], v3 offset:26624
  ds_read_b128 v[116:119], v3 offset:28672
  ds_read_b128 v[120:123], v3 offset:30720
  ds_read_b128 v[124:127], v3 offset:32768
  ds_read_b128 v[128:131], v3 offset:34816
  s_waitcnt lgkmcnt(9)
  v_add_u32 v7, 768, v2
  v_add_u32 v15, 768, v13
  s_add_u32 m0, s35, 0
  s_nop 0
  buffer_load_dwordx4 v7, s[16:19], s40 offen lds
  s_add_u32 m0, s35, 1024
  s_nop 0
  buffer_load_dwordx4 v15, s[16:19], s40 offen lds
  s_add_u32 m0, s35, 2048
  s_nop 0
  buffer_load_dwordx4 v7, s[16:19], s41 offen lds
  s_add_u32 m0, s35, 3072
  s_nop 0
  buffer_load_dwordx4 v15, s[16:19], s41 offen lds
  s_add_u32 m0, s35, 4096
  s_nop 0
  buffer_load_dwordx4 v7, s[16:19], s42 offen lds
  s_add_u32 m0, s35, 5120
  s_nop 0
  buffer_load_dwordx4 v15, s[16:19], s42 offen lds
  s_add_u32 m0, s35, 6144
  s_nop 0
  buffer_load_dwordx4 v7, s[16:19], s43 offen lds
  s_add_u32 m0, s35, 7168
  s_nop 0
  buffer_load_dwordx4 v15, s[16:19], s43 offen lds
  s_add_u32 m0, s35, 8192
  s_nop 0
  buffer_load_dwordx4 v7, s[16:19], s44 offen lds
  s_add_u32 m0, s35, 9216
  s_nop 0
  buffer_load_dwordx4 v15, s[16:19], s44 offen lds
  s_add_u32 m0, s35, 10240
  s_nop 0
  buffer_load_dwordx4 v7, s[12:15], s36 offen lds
  s_add_u32 m0, s35, 11264
  s_nop 0
  buffer_load_dwordx4 v15, s[12:15], s36 offen lds
  s_add_u32 m0, s35, 12288
  s_nop 0
  buffer_load_dwordx4 v7, s[12:15], s37 offen lds
  s_add_u32 m0, s35, 13312
  s_nop 0
  buffer_load_dwordx4 v15, s[12:15], s37 offen lds
  s_add_u32 m0, s35, 14336
  s_nop 0
  buffer_load_dwordx4 v7, s[12:15], s38 offen lds
  s_add_u32 m0, s35, 15360
  s_nop 0
  buffer_load_dwordx4 v15, s[12:15], s38 offen lds
  s_add_u32 m0, s35, 16384
  s_nop 0
  buffer_load_dwordx4 v7, s[12:15], s39 offen lds
  s_add_u32 m0, s35, 17408
  s_nop 0
  buffer_load_dwordx4 v15, s[12:15], s39 offen lds
  v_mfma_f32_16x16x32_bf16 v[16:19], v[132:135], v[152:155], v[16:19]
  v_mfma_f32_16x16x32_bf16 v[32:35], v[136:139], v[152:155], v[32:35]
  v_mfma_f32_16x16x32_bf16 v[48:51], v[140:143], v[152:155], v[48:51]
  v_mfma_f32_16x16x32_bf16 v[64:67], v[144:147], v[152:155], v[64:67]
  v_mfma_f32_16x16x32_bf16 v[80:83], v[148:151], v[152:155], v[80:83]
  v_mfma_f32_16x16x32_bf16 v[20:23], v[132:135], v[156:159], v[20:23]
  v_mfma_f32_16x16x32_bf16 v[36:39], v[136:139], v[156:159], v[36:39]
  v_mfma_f32_16x16x32_bf16 v[52:55], v[140:143], v[156:159], v[52:55]
  v_mfma_f32_16x16x32_bf16 v[68:71], v[144:147], v[156:159], v[68:71]
  v_mfma_f32_16x16x32_bf16 v[84:87], v[148:151], v[156:159], v[84:87]
  v_mfma_f32_16x16x32_bf16 v[24:27], v[132:135], v[160:163], v[24:27]
  v_mfma_f32_16x16x32_bf16 v[40:43], v[136:139], v[160:163], v[40:43]
  v_mfma_f32_16x16x32_bf16 v[56:59], v[140:143], v[160:163], v[56:59]
  v_mfma_f32_16x16x32_bf16 v[72:75], v[144:147], v[160:163], v[72:75]
  v_mfma_f32_16x16x32_bf16 v[88:91], v[148:151], v[160:163], v[88:91]
  v_mfma_f32_16x16x32_bf16 v[28:31], v[132:135], v[164:167], v[28:31]
  v_mfma_f32_16x16x32_bf16 v[44:47], v[136:139], v[164:167], v[44:47]
  v_mfma_f32_16x16x32_bf16 v[60:63], v[140:143], v[164:167], v[60:63]
  v_mfma_f32_16x16x32_bf16 v[76:79], v[144:147], v[164:167], v[76:79]
  v_mfma_f32_16x16x32_bf16 v[92:95], v[148:151], v[164:167], v[92:95]
  ds_read_b128 v[132:135], v14 offset:18432
  ds_read_b128 v[136:139], v14 offset:20480
  ds_read_b128 v[140:143], v14 offset:22528
  ds_read_b128 v[144:147], v14 offset:24576
  ds_read_b128 v[148:151], v14 offset:26624
  ds_read_b128 v[152:155], v14 offset:28672
  ds_read_b128 v[156:159], v14 offset:30720
  ds_read_b128 v[160:163], v14 offset:32768
  ds_read_b128 v[164:167], v14 offset:34816
  s_waitcnt lgkmcnt(9)
  v_mfma_f32_16x16x32_bf16 v[16:19], v[96:99], v[116:119], v[16:19]
  v_mfma_f32_16x16x32_bf16 v[32:35], v[100:103], v[116:119], v[32:35]
  v_mfma_f32_16x16x32_bf16 v[48:51], v[104:107], v[116:119], v[48:51]
  v_mfma_f32_16x16x32_bf16 v[64:67], v[108:111], v[116:119], v[64:67]
  v_mfma_f32_16x16x32_bf16 v[80:83], v[112:115], v[116:119], v[80:83]
  v_mfma_f32_16x16x32_bf16 v[20:23], v[96:99], v[120:123], v[20:23]
  v_mfma_f32_16x16x32_bf16 v[36:39], v[100:103], v[120:123], v[36:39]
  v_mfma_f32_16x16x32_bf16 v[52:55], v[104:107], v[120:123], v[52:55]
  v_mfma_f32_16x16x32_bf16 v[68:71], v[108:111], v[120:123], v[68:71]
  v_mfma_f32_16x16x32_bf16 v[84:87], v[112:115], v[120:123], v[84:87]
  v_mfma_f32_16x16x32_bf16 v[24:27], v[96:99], v[124:127], v[24:27]
  v_mfma_f32_16x16x32_bf16 v[40:43], v[100:103], v[124:127], v[40:43]
  v_mfma_f32_16x16x32_bf16 v[56:59], v[104:107], v[124:127], v[56:59]
  v_mfma_f32_16x16x32_bf16 v[72:75], v[108:111], v[124:127], v[72:75]
  v_mfma_f32_16x16x32_bf16 v[88:91], v[112:115], v[124:127], v[88:91]
  v_mfma_f32_16x16x32_bf16 v[28:31], v[96:99], v[128:131], v[28:31]
  v_mfma_f32_16x16x32_bf16 v[44:47], v[100:103], v[128:131], v[44:47]
  v_mfma_f32_16x16x32_bf16 v[60:63], v[104:107], v[128:131], v[60:63]
  v_mfma_f32_16x16x32_bf16 v[76:79], v[108:111], v[128:131], v[76:79]
  v_mfma_f32_16x16x32_bf16 v[92:95], v[112:115], v[128:131], v[92:95]
  s_waitcnt vmcnt(0)
  ds_read_b128 v[96:99], v3 offset:0
  ds_read_b128 v[100:103], v3 offset:2048
  ds_read_b128 v[104:107], v3 offset:4096
  ds_read_b128 v[108:111], v3 offset:6144
  ds_read_b128 v[112:115], v3 offset:8192
  ds_read_b128 v[116:119], v3 offset:10240
  ds_read_b128 v[120:123], v3 offset:12288
  ds_read_b128 v[124:127], v3 offset:14336
  ds_read_b128 v[128:131], v3 offset:16384
  s_waitcnt lgkmcnt(9)
  v_mfma_f32_16x16x32_bf16 v[16:19], v[132:135], v[152:155], v[16:19]
  v_mfma_f32_16x16x32_bf16 v[32:35], v[136:139], v[152:155], v[32:35]
  v_mfma_f32_16x16x32_bf16 v[48:51], v[140:143], v[152:155], v[48:51]
  v_mfma_f32_16x16x32_bf16 v[64:67], v[144:147], v[152:155], v[64:67]
  v_mfma_f32_16x16x32_bf16 v[80:83], v[148:151], v[152:155], v[80:83]
  v_mfma_f32_16x16x32_bf16 v[20:23], v[132:135], v[156:159], v[20:23]
  v_mfma_f32_16x16x32_bf16 v[36:39], v[136:139], v[156:159], v[36:39]
  v_mfma_f32_16x16x32_bf16 v[52:55], v[140:143], v[156:159], v[52:55]
  v_mfma_f32_16x16x32_bf16 v[68:71], v[144:147], v[156:159], v[68:71]
  v_mfma_f32_16x16x32_bf16 v[84:87], v[148:151], v[156:159], v[84:87]
  v_mfma_f32_16x16x32_bf16 v[24:27], v[132:135], v[160:163], v[24:27]
  v_mfma_f32_16x16x32_bf16 v[40:43], v[136:139], v[160:163], v[40:43]
  v_mfma_f32_16x16x32_bf16 v[56:59], v[140:143], v[160:163], v[56:59]
  v_mfma_f32_16x16x32_bf16 v[72:75], v[144:147], v[160:163], v[72:75]
  v_mfma_f32_16x16x32_bf16 v[88:91], v[148:151], v[160:163], v[88:91]
  v_mfma_f32_16x16x32_bf16 v[28:31], v[132:135], v[164:167], v[28:31]
  v_mfma_f32_16x16x32_bf16 v[44:47], v[136:139], v[164:167], v[44:47]
  v_mfma_f32_16x16x32_bf16 v[60:63], v[140:143], v[164:167], v[60:63]
  v_mfma_f32_16x16x32_bf16 v[76:79], v[144:147], v[164:167], v[76:79]
  v_mfma_f32_16x16x32_bf16 v[92:95], v[148:151], v[164:167], v[92:95]
  ds_read_b128 v[132:135], v14 offset:0
  ds_read_b128 v[136:139], v14 offset:2048
  ds_read_b128 v[140:143], v14 offset:4096
  ds_read_b128 v[144:147], v14 offset:6144
  ds_read_b128 v[148:151], v14 offset:8192
  ds_read_b128 v[152:155], v14 offset:10240
  ds_read_b128 v[156:159], v14 offset:12288
  ds_read_b128 v[160:163], v14 offset:14336
  ds_read_b128 v[164:167], v14 offset:16384
  s_waitcnt lgkmcnt(9)
  v_mfma_f32_16x16x32_bf16 v[16:19], v[96:99], v[116:119], v[16:19]
  v_mfma_f32_16x16x32_bf16 v[32:35], v[100:103], v[116:119], v[32:35]
  v_mfma_f32_16x16x32_bf16 v[48:51], v[104:107], v[116:119], v[48:51]
  v_mfma_f32_16x16x32_bf16 v[64:67], v[108:111], v[116:119], v[64:67]
  v_mfma_f32_16x16x32_bf16 v[80:83], v[112:115], v[116:119], v[80:83]
  v_mfma_f32_16x16x32_bf16 v[20:23], v[96:99], v[120:123], v[20:23]
  v_mfma_f32_16x16x32_bf16 v[36:39], v[100:103], v[120:123], v[36:39]
  v_mfma_f32_16x16x32_bf16 v[52:55], v[104:107], v[120:123], v[52:55]
  v_mfma_f32_16x16x32_bf16 v[68:71], v[108:111], v[120:123], v[68:71]
  v_mfma_f32_16x16x32_bf16 v[84:87], v[112:115], v[120:123], v[84:87]
  v_mfma_f32_16x16x32_bf16 v[24:27], v[96:99], v[124:127], v[24:27]
  v_mfma_f32_16x16x32_bf16 v[40:43], v[100:103], v[124:127], v[40:43]
  v_mfma_f32_16x16x32_bf16 v[56:59], v[104:107], v[124:127], v[56:59]
  v_mfma_f32_16x16x32_bf16 v[72:75], v[108:111], v[124:127], v[72:75]
  v_mfma_f32_16x16x32_bf16 v[88:91], v[112:115], v[124:127], v[88:91]
  v_mfma_f32_16x16x32_bf16 v[28:31], v[96:99], v[128:131], v[28:31]
  v_mfma_f32_16x16x32_bf16 v[44:47], v[100:103], v[128:131], v[44:47]
  v_mfma_f32_16x16x32_bf16 v[60:63], v[104:107], v[128:131], v[60:63]
  v_mfma_f32_16x16x32_bf16 v[76:79], v[108:111], v[128:131], v[76:79]
  v_mfma_f32_16x16x32_bf16 v[92:95], v[112:115], v[128:131], v[92:95]
  s_waitcnt lgkmcnt(0)
  v_mfma_f32_16x16x32_bf16 v[16:19], v[132:135], v[152:155], v[16:19]
  v_mfma_f32_16x16x32_bf16 v[32:35], v[136:139], v[152:155], v[32:35]
  v_mfma_f32_16x16x32_bf16 v[48:51], v[140:143], v[152:155], v[48:51]
  v_mfma_f32_16x16x32_bf16 v[64:67], v[144:147], v[152:155], v[64:67]
  v_mfma_f32_16x16x32_bf16 v[80:83], v[148:151], v[152:155], v[80:83]
  v_mfma_f32_16x16x32_bf16 v[20:23], v[132:135], v[156:159], v[20:23]
  v_mfma_f32_16x16x32_bf16 v[36:39], v[136:139], v[156:159], v[36:39]
  v_mfma_f32_16x16x32_bf16 v[52:55], v[140:143], v[156:159], v[52:55]
  v_mfma_f32_16x16x32_bf16 v[68:71], v[144:147], v[156:159], v[68:71]
  v_mfma_f32_16x16x32_bf16 v[84:87], v[148:151], v[156:159], v[84:87]
  v_mfma_f32_16x16x32_bf16 v[24:27], v[132:135], v[160:163], v[24:27]
  v_mfma_f32_16x16x32_bf16 v[40:43], v[136:139], v[160:163], v[40:43]
  v_mfma_f32_16x16x32_bf16 v[56:59], v[140:143], v[160:163], v[56:59]
  v_mfma_f32_16x16x32_bf16 v[72:75], v[144:147], v[160:163], v[72:75]
  v_mfma_f32_16x16x32_bf16 v[88:91], v[148:151], v[160:163], v[88:91]
  v_mfma_f32_16x16x32_bf16 v[28:31], v[132:135], v[164:167], v[28:31]
  v_mfma_f32_16x16x32_bf16 v[44:47], v[136:139], v[164:167], v[44:47]
  v_mfma_f32_16x16x32_bf16 v[60:63], v[140:143], v[164:167], v[60:63]
  v_mfma_f32_16x16x32_bf16 v[76:79], v[144:147], v[164:167], v[76:79]
  v_mfma_f32_16x16x32_bf16 v[92:95], v[148:151], v[164:167], v[92:95]
  s_branch L_k5_join
L_k5_varB:
  v_mov_b32 v7, v2
  v_mov_b32 v15, v13
  s_add_u32 m0, s35, 0
  s_nop 0
  buffer_load_dwordx4 v7, s[16:19], s40 offen lds
  s_add_u32 m0, s35, 1024
  s_nop 0
  buffer_load_dwordx4 v15, s[16:19], s40 offen lds
  s_add_u32 m0, s35, 2048
  s_nop 0
  buffer_load_dwordx4 v7, s[16:19], s41 offen lds
  s_add_u32 m0, s35, 3072
  s_nop 0
  buffer_load_dwordx4 v15, s[16:19], s41 offen lds
  s_add_u32 m0, s35, 4096
  s_nop 0
  buffer_load_dwordx4 v7, s[16:19], s42 offen lds
  s_add_u32 m0, s35, 5120
  s_nop 0
  buffer_load_dwordx4 v15, s[16:19], s42 offen lds
  s_add_u32 m0, s35, 6144
  s_nop 0
  buffer_load_dwordx4 v7, s[16:19], s43 offen lds
  s_add_u32 m0, s35, 7168
  s_nop 0
  buffer_load_dwordx4 v15, s[16:19], s43 offen lds
  s_add_u32 m0, s35, 8192
  s_nop 0
  buffer_load_dwordx4 v7, s[16:19], s44 offen lds
  s_add_u32 m0, s35, 9216
  s_nop 0
  buffer_load_dwordx4 v15, s[16:19], s44 offen lds
  s_add_u32 m0, s35, 10240
  s_nop 0
  buffer_load_dwordx4 v7, s[12:15], s36 offen lds
  s_add_u32 m0, s35, 11264
  s_nop 0
  buffer_load_dwordx4 v15, s[12:15], s36 offen lds
  s_add_u32 m0, s35, 12288
  s_nop 0
  buffer_load_dwordx4 v7, s[12:15], s37 offen lds
  s_add_u32 m0, s35, 13312
  s_nop 0
  buffer_load_dwordx4 v15, s[12:15], s37 offen lds
  s_add_u32 m0, s35, 14336
  s_nop 0
  buffer_load_dwordx4 v7, s[12:15], s38 offen lds
  s_add_u32 m0, s35, 15360
  s_nop 0
  buffer_load_dwordx4 v15, s[12:15], s38 offen lds
  s_add_u32 m0, s35, 16384
  s_nop 0
  buffer_load_dwordx4 v7, s[12:15], s39 offen lds
  s_add_u32 m0, s35, 17408
  s_nop 0
  buffer_load_dwordx4 v15, s[12:15], s39 offen lds
  v_add_u32 v7, 128, v2
  v_add_u32 v15, 128, v13
  s_add_u32 m0, s35, 18432
  s_nop 0
  buffer_load_dwordx4 v7, s[16:19], s40 offen lds
  s_add_u32 m0, s35, 19456
  s_nop 0
  buffer_load_dwordx4 v15, s[16:19], s40 offen lds
  s_add_u32 m0, s35, 20480
  s_nop 0
  buffer_load_dwordx4 v7, s[16:19], s41 offen lds
  s_add_u32 m0, s35, 21504
  s_nop 0
  buffer_load_dwordx4 v15, s[16:19], s41 offen lds
  s_add_u32 m0, s35, 22528
  s_nop 0
  buffer_load_dwordx4 v7, s[16:19], s42 offen lds
  s_add_u32 m0, s35, 23552
  s_nop 0
  buffer_load_dwordx4 v15, s[16:19], s42 offen lds
  s_add_u32 m0, s35, 24576
  s_nop 0
  buffer_load_dwordx4 v7, s[16:19], s43 offen lds
  s_add_u32 m0, s35, 25600
  s_nop 0
  buffer_load_dwordx4 v15, s[16:19], s43 offen lds
  s_add_u32 m0, s35, 26624
  s_nop 0
  buffer_load_dwordx4 v7, s[16:19], s44 offen lds
  s_add_u32 m0, s35, 27648
  s_nop 0
  buffer_load_dwordx4 v15, s[16:19], s44 offen lds
  s_add_u32 m0, s35, 28672
  s_nop 0
  buffer_load_dwordx4 v7, s[12:15], s36 offen lds
  s_add_u32 m0, s35, 29696
  s_nop 0
  buffer_load_dwordx4 v15, s[12:15], s36 offen lds
  s_add_u32 m0, s35, 30720
  s_nop 0
  buffer_load_dwordx4 v7, s[12:15], s37 offen lds
  s_add_u32 m0, s35, 31744
  s_nop 0
  buffer_load_dwordx4 v15, s[12:15], s37 offen lds
  s_add_u32 m0, s35, 32768
  s_nop 0
  buffer_load_dwordx4 v7, s[12:15], s38 offen lds
  s_add_u32 m0, s35, 33792
  s_nop 0
  buffer_load_dwordx4 v15, s[12:15], s38 offen lds
  s_add_u32 m0, s35, 34816
  s_nop 0
  buffer_load_dwordx4 v7, s[12:15], s39 offen lds
  s_add_u32 m0, s35, 35840
  s_nop 0
  buffer_load_dwordx4 v15, s[12:15], s39 offen lds
  s_waitcnt vmcnt(18)
  ds_read_b128 v[96:99], v3 offset:0
  ds_read_b128 v[100:103], v3 offset:2048
  ds_read_b128 v[104:107], v3 offset:4096
  ds_read_b128 v[108:111], v3 offset:6144
  ds_read_b128 v[112:115], v3 offset:8192
  ds_read_b128 v[116:119], v3 offset:10240
  ds_read_b128 v[120:123], v3 offset:12288
  ds_read_b128 v[124:127], v3 offset:14336
  ds_read_b128 v[128:131], v3 offset:16384
  ds_read_b128 v[132:135], v14 offset:0
  ds_read_b128 v[136:139], v14 offset:2048
  ds_read_b128 v[140:143], v14 offset:4096
  ds_read_b128 v[144:147], v14 offset:6144
  ds_read_b128 v[148:151], v14 offset:8192
  ds_read_b128 v[152:155], v14 offset:10240
  ds_read_b128 v[156:159], v14 offset:12288
  ds_read_b128 v[160:163], v14 offset:14336
  ds_read_b128 v[164:167], v14 offset:16384
  s_waitcnt lgkmcnt(9)
  v_mfma_f32_16x16x32_bf16 v[16:19], v[96:99], v[116:119], v[16:19]
  v_mfma_f32_16x16x32_bf16 v[32:35], v[100:103], v[116:119], v[32:35]
  v_mfma_f32_16x16x32_bf16 v[48:51], v[104:107], v[116:119], v[48:51]
  v_mfma_f32_16x16x32_bf16 v[64:67], v[108:111], v[116:119], v[64:67]
  v_mfma_f32_16x16x32_bf16 v[80:83], v[112:115], v[116:119], v[80:83]
  v_mfma_f32_16x16x32_bf16 v[20:23], v[96:99], v[120:123], v[20:23]
  v_mfma_f32_16x16x32_bf16 v[36:39], v[100:103], v[120:123], v[36:39]
  v_mfma_f32_16x16x32_bf16 v[52:55], v[104:107], v[120:123], v[52:55]
  v_mfma_f32_16x16x32_bf16 v[68:71], v[108:111], v[120:123], v[68:71]
  v_mfma_f32_16x16x32_bf16 v[84:87], v[112:115], v[120:123], v[84:87]
  v_mfma_f32_16x16x32_bf16 v[24:27], v[96:99], v[124:127], v[24:27]
  v_mfma_f32_16x16x32_bf16 v[40:43], v[100:103], v[124:127], v[40:43]
  v_mfma_f32_16x16x32_bf16 v[56:59], v[104:107], v[124:127], v[56:59]
  v_mfma_f32_16x16x32_bf16 v[72:75], v[108:111], v[124:127], v[72:75]
  v_mfma_f32_16x16x32_bf16 v[88:91], v[112:115], v[124:127], v[88:91]
  v_mfma_f32_16x16x32_bf16 v[28:31], v[96:99], v[128:131], v[28:31]
  v_mfma_f32_16x16x32_bf16 v[44:47], v[100:103], v[128:131], v[44:47]
  v_mfma_f32_16x16x32_bf16 v[60:63], v[104:107], v[128:131], v[60:63]
  v_mfma_f32_16x16x32_bf16 v[76:79], v[108:111], v[128:131], v[76:79]
  v_mfma_f32_16x16x32_bf16 v[92:95], v[112:115], v[128:131], v[92:95]
  s_waitcnt vmcnt(0)
  ds_read_b128 v[96:99], v3 offset:18432
  ds_read_b128 v[100:103], v3 offset:20480
  ds_read_b128 v[104:107], v3 offset:22528
  ds_read_b128 v[108:111], v3 offset:24576
  ds_read_b128 v[112:115], v3 offset:26624
  ds_read_b128 v[116:119], v3 offset:28672
  ds_read_b128 v[120:123], v3 offset:30720
  ds_read_b128 v[124:127], v3 offset:32768
  ds_read_b128 v[128:131], v3 offset:34816
  s_waitcnt lgkmcnt(9)
  v_add_u32 v7, 256, v2
  v_add_u32 v15, 256, v13
  s_add_u32 m0, s35, 0
  s_nop 0
  buffer_load_dwordx4 v7, s[16:19], s40 offen lds
  s_add_u32 m0, s35, 1024
  s_nop 0
  buffer_load_dwordx4 v15, s[16:19], s40 offen lds
  s_add_u32 m0, s35, 2048
  s_nop 0
  buffer_load_dwordx4 v7, s[16:19], s41 offen lds
  s_add_u32 m0, s35, 3072
  s_nop 0
  buffer_load_dwordx4 v15, s[16:19], s41 offen lds
  s_add_u32 m0, s35, 4096
  s_nop 0
  buffer_load_dwordx4 v7, s[16:19], s42 offen lds
  s_add_u32 m0, s35, 5120
  s_nop 0
  buffer_load_dwordx4 v15, s[16:19], s42 offen lds
  s_add_u32 m0, s35, 6144
  s_nop 0
  buffer_load_dwordx4 v7, s[16:19], s43 offen lds
  s_add_u32 m0, s35, 7168
  s_nop 0
  buffer_load_dwordx4 v15, s[16:19], s43 offen lds
  s_add_u32 m0, s35, 8192
  s_nop 0
  buffer_load_dwordx4 v7, s[16:19], s44 offen lds
  s_add_u32 m0, s35, 9216
  s_nop 0
  buffer_load_dwordx4 v15, s[16:19], s44 offen lds
  s_add_u32 m0, s35, 10240
  s_nop 0
  buffer_load_dwordx4 v7, s[12:15], s36 offen lds
  s_add_u32 m0, s35, 11264
  s_nop 0
  buffer_load_dwordx4 v15, s[12:15], s36 offen lds
  s_add_u32 m0, s35, 12288
  s_nop 0
  buffer_load_dwordx4 v7, s[12:15], s37 offen lds
  s_add_u32 m0, s35, 13312
  s_nop 0
  buffer_load_dwordx4 v15, s[12:15], s37 offen lds
  s_add_u32 m0, s35, 14336
  s_nop 0
  buffer_load_dwordx4 v7, s[12:15], s38 offen lds
  s_add_u32 m0, s35, 15360
  s_nop 0
  buffer_load_dwordx4 v15, s[12:15], s38 offen lds
  s_add_u32 m0, s35, 16384
  s_nop 0
  buffer_load_dwordx4 v7, s[12:15], s39 offen lds
  s_add_u32 m0, s35, 17408
  s_nop 0
  buffer_load_dwordx4 v15, s[12:15], s39 offen lds
  v_mfma_f32_16x16x32_bf16 v[16:19], v[132:135], v[152:155], v[16:19]
  v_mfma_f32_16x16x32_bf16 v[32:35], v[136:139], v[152:155], v[32:35]
  v_mfma_f32_16x16x32_bf16 v[48:51], v[140:143], v[152:155], v[48:51]
  v_mfma_f32_16x16x32_bf16 v[64:67], v[144:147], v[152:155], v[64:67]
  v_mfma_f32_16x16x32_bf16 v[80:83], v[148:151], v[152:155], v[80:83]
  v_mfma_f32_16x16x32_bf16 v[20:23], v[132:135], v[156:159], v[20:23]
  v_mfma_f32_16x16x32_bf16 v[36:39], v[136:139], v[156:159], v[36:39]
  v_mfma_f32_16x16x32_bf16 v[52:55], v[140:143], v[156:159], v[52:55]
  v_mfma_f32_16x16x32_bf16 v[68:71], v[144:147], v[156:159], v[68:71]
  v_mfma_f32_16x16x32_bf16 v[84:87], v[148:151], v[156:159], v[84:87]
  v_mfma_f32_16x16x32_bf16 v[24:27], v[132:135], v[160:163], v[24:27]
  v_mfma_f32_16x16x32_bf16 v[40:43], v[136:139], v[160:163], v[40:43]
  v_mfma_f32_16x16x32_bf16 v[56:59], v[140:143], v[160:163], v[56:59]
  v_mfma_f32_16x16x32_bf16 v[72:75], v[144:147], v[160:163], v[72:75]
  v_mfma_f32_16x16x32_bf16 v[88:91], v[148:151], v[160:163], v[88:91]
  v_mfma_f32_16x16x32_bf16 v[28:31], v[132:135], v[164:167], v[28:31]
  v_mfma_f32_16x16x32_bf16 v[44:47], v[136:139], v[164:167], v[44:47]
  v_mfma_f32_16x16x32_bf16 v[60:63], v[140:143], v[164:167], v[60:63]
  v_mfma_f32_16x16x32_bf16 v[76:79], v[144:147], v[164:167], v[76:79]
  v_mfma_f32_16x16x32_bf16 v[92:95], v[148:151], v[164:167], v[92:95]
  ds_read_b128 v[132:135], v14 offset:18432
  ds_read_b128 v[136:139], v14 offset:20480
  ds_read_b128 v[140:143], v14 offset:22528
  ds_read_b128 v[144:147], v14 offset:24576
  ds_read_b128 v[148:151], v14 offset:26624
  ds_read_b128 v[152:155], v14 offset:28672
  ds_read_b128 v[156:159], v14 offset:30720
  ds_read_b128 v[160:163], v14 offset:32768
  ds_read_b128 v[164:167], v14 offset:34816
  s_waitcnt lgkmcnt(9)
  v_mfma_f32_16x16x32_bf16 v[16:19], v[96:99], v[116:119], v[16:19]
  v_mfma_f32_16x16x32_bf16 v[32:35], v[100:103], v[116:119], v[32:35]
  v_mfma_f32_16x16x32_bf16 v[48:51], v[104:107], v[116:119], v[48:51]
  v_mfma_f32_16x16x32_bf16 v[64:67], v[108:111], v[116:119], v[64:67]
  v_mfma_f32_16x16x32_bf16 v[80:83], v[112:115], v[116:119], v[80:83]
  v_mfma_f32_16x16x32_bf16 v[20:23], v[96:99], v[120:123], v[20:23]
  v_mfma_f32_16x16x32_bf16 v[36:39], v[100:103], v[120:123], v[36:39]
  v_mfma_f32_16x16x32_bf16 v[52:55], v[104:107], v[120:123], v[52:55]
  v_mfma_f32_16x16x32_bf16 v[68:71], v[108:111], v[120:123], v[68:71]
  v_mfma_f32_16x16x32_bf16 v[84:87], v[112:115], v[120:123], v[84:87]
  v_mfma_f32_16x16x32_bf16 v[24:27], v[96:99], v[124:127], v[24:27]
  v_mfma_f32_16x16x32_bf16 v[40:43], v[100:103], v[124:127], v[40:43]
  v_mfma_f32_16x16x32_bf16 v[56:59], v[104:107], v[124:127], v[56:59]
  v_mfma_f32_16x16x32_bf16 v[72:75], v[108:111], v[124:127], v[72:75]
  v_mfma_f32_16x16x32_bf16 v[88:91], v[112:115], v[124:127], v[88:91]
  v_mfma_f32_16x16x32_bf16 v[28:31], v[96:99], v[128:131], v[28:31]
  v_mfma_f32_16x16x32_bf16 v[44:47], v[100:103], v[128:131], v[44:47]
  v_mfma_f32_16x16x32_bf16 v[60:63], v[104:107], v[128:131], v[60:63]
  v_mfma_f32_16x16x32_bf16 v[76:79], v[108:111], v[128:131], v[76:79]
  v_mfma_f32_16x16x32_bf16 v[92:95], v[112:115], v[128:131], v[92:95]
  s_waitcnt vmcnt(0)
  ds_read_b128 v[96:99], v3 offset:0
  ds_read_b128 v[100:103], v3 offset:2048
  ds_read_b128 v[104:107], v3 offset:4096
  ds_read_b128 v[108:111], v3 offset:6144
  ds_read_b128 v[112:115], v3 offset:8192
  ds_read_b128 v[116:119], v3 offset:10240
  ds_read_b128 v[120:123], v3 offset:12288
  ds_read_b128 v[124:127], v3 offset:14336
  ds_read_b128 v[128:131], v3 offset:16384
  s_waitcnt lgkmcnt(9)
  v_add_u32 v7, 384, v2
  v_add_u32 v15, 384, v13
  s_add_u32 m0, s35, 18432
  s_nop 0
  buffer_load_dwordx4 v7, s[16:19], s40 offen lds
  s_add_u32 m0, s35, 19456
  s_nop 0
  buffer_load_dwordx4 v15, s[16:19], s40 offen lds
  s_add_u32 m0, s35, 20480
  s_nop 0
  buffer_load_dwordx4 v7, s[16:19], s41 offen lds
  s_add_u32 m0, s35, 21504
  s_nop 0
  buffer_load_dwordx4 v15, s[16:19], s41 offen lds
  s_add_u32 m0, s35, 22528
  s_nop 0
  buffer_load_dwordx4 v7, s[16:19], s42 offen lds
  s_add_u32 m0, s35, 23552
  s_nop 0
  buffer_load_dwordx4 v15, s[16:19], s42 offen lds
  s_add_u32 m0, s35, 24576
  s_nop 0
  buffer_load_dwordx4 v7, s[16:19], s43 offen lds
  s_add_u32 m0, s35, 25600
  s_nop 0
  buffer_load_dwordx4 v15, s[16:19], s43 offen lds
  s_add_u32 m0, s35, 26624
  s_nop 0
  buffer_load_dwordx4 v7, s[16:19], s44 offen lds
  s_add_u32 m0, s35, 27648
  s_nop 0
  buffer_load_dwordx4 v15, s[16:19], s44 offen lds
  s_add_u32 m0, s35, 28672
  s_nop 0
  buffer_load_dwordx4 v7, s[12:15], s36 offen lds
  s_add_u32 m0, s35, 29696
  s_nop 0
  buffer_load_dwordx4 v15, s[12:15], s36 offen lds
  s_add_u32 m0, s35, 30720
  s_nop 0
  buffer_load_dwordx4 v7, s[12:15], s37 offen lds
  s_add_u32 m0, s35, 31744
  s_nop 0
  buffer_load_dwordx4 v15, s[12:15], s37 offen lds
  s_add_u32 m0, s35, 32768
  s_nop 0
  buffer_load_dwordx4 v7, s[12:15], s38 offen lds
  s_add_u32 m0, s35, 33792
  s_nop 0
  buffer_load_dwordx4 v15, s[12:15], s38 offen lds
  s_add_u32 m0, s35, 34816
  s_nop 0
  buffer_load_dwordx4 v7, s[12:15], s39 offen lds
  s_add_u32 m0, s35, 35840
  s_nop 0
  buffer_load_dwordx4 v15, s[12:15], s39 offen lds
  v_mfma_f32_16x16x32_bf16 v[16:19], v[132:135], v[152:155], v[16:19]
  v_mfma_f32_16x16x32_bf16 v[32:35], v[136:139], v[152:155], v[32:35]
  v_mfma_f32_16x16x32_bf16 v[48:51], v[140:143], v[152:155], v[48:51]
  v_mfma_f32_16x16x32_bf16 v[64:67], v[144:147], v[152:155], v[64:67]
  v_mfma_f32_16x16x32_bf16 v[80:83], v[148:151], v[152:155], v[80:83]
  v_mfma_f32_16x16x32_bf16 v[20:23], v[132:135], v[156:159], v[20:23]
  v_mfma_f32_16x16x32_bf16 v[36:39], v[136:139], v[156:159], v[36:39]
  v_mfma_f32_16x16x32_bf16 v[52:55], v[140:143], v[156:159], v[52:55]
  v_mfma_f32_16x16x32_bf16 v[68:71], v[144:147], v[156:159], v[68:71]
  v_mfma_f32_16x16x32_bf16 v[84:87], v[148:151], v[156:159], v[84:87]
  v_mfma_f32_16x16x32_bf16 v[24:27], v[132:135], v[160:163], v[24:27]
  v_mfma_f32_16x16x32_bf16 v[40:43], v[136:139], v[160:163], v[40:43]
  v_mfma_f32_16x16x32_bf16 v[56:59], v[140:143], v[160:163], v[56:59]
  v_mfma_f32_16x16x32_bf16 v[72:75], v[144:147], v[160:163], v[72:75]
  v_mfma_f32_16x16x32_bf16 v[88:91], v[148:151], v[160:163], v[88:91]
  v_mfma_f32_16x16x32_bf16 v[28:31], v[132:135], v[164:167], v[28:31]
  v_mfma_f32_16x16x32_bf16 v[44:47], v[136:139], v[164:167], v[44:47]
  v_mfma_f32_16x16x32_bf16 v[60:63], v[140:143], v[164:167], v[60:63]
  v_mfma_f32_16x16x32_bf16 v[76:79], v[144:147], v[164:167], v[76:79]
  v_mfma_f32_16x16x32_bf16 v[92:95], v[148:151], v[164:167], v[92:95]
  ds_read_b128 v[132:135], v14 offset:0
  ds_read_b128 v[136:139], v14 offset:2048
  ds_read_b128 v[140:143], v14 offset:4096
  ds_read_b128 v[144:147], v14 offset:6144
  ds_read_b128 v[148:151], v14 offset:8192
  ds_read_b128 v[152:155], v14 offset:10240
  ds_read_b128 v[156:159], v14 offset:12288
  ds_read_b128 v[160:163], v14 offset:14336
  ds_read_b128 v[164:167], v14 offset:16384
  s_waitcnt lgkmcnt(9)
  v_mfma_f32_16x16x32_bf16 v[16:19], v[96:99], v[116:119], v[16:19]
  v_mfma_f32_16x16x32_bf16 v[32:35], v[100:103], v[116:119], v[32:35]
  v_mfma_f32_16x16x32_bf16 v[48:51], v[104:107], v[116:119], v[48:51]
  v_mfma_f32_16x16x32_bf16 v[64:67], v[108:111], v[116:119], v[64:67]
  v_mfma_f32_16x16x32_bf16 v[80:83], v[112:115], v[116:119], v[80:83]
  v_mfma_f32_16x16x32_bf16 v[20:23], v[96:99], v[120:123], v[20:23]
  v_mfma_f32_16x16x32_bf16 v[36:39], v[100:103], v[120:123], v[36:39]
  v_mfma_f32_16x16x32_bf16 v[52:55], v[104:107], v[120:123], v[52:55]
  v_mfma_f32_16x16x32_bf16 v[68:71], v[108:111], v[120:123], v[68:71]
  v_mfma_f32_16x16x32_bf16 v[84:87], v[112:115], v[120:123], v[84:87]
  v_mfma_f32_16x16x32_bf16 v[24:27], v[96:99], v[124:127], v[24:27]
  v_mfma_f32_16x16x32_bf16 v[40:43], v[100:103], v[124:127], v[40:43]
  v_mfma_f32_16x16x32_bf16 v[56:59], v[104:107], v[124:127], v[56:59]
  v_mfma_f32_16x16x32_bf16 v[72:75], v[108:111], v[124:127], v[72:75]
  v_mfma_f32_16x16x32_bf16 v[88:91], v[112:115], v[124:127], v[88:91]
  v_mfma_f32_16x16x32_bf16 v[28:31], v[96:99], v[128:131], v[28:31]
  v_mfma_f32_16x16x32_bf16 v[44:47], v[100:103], v[128:131], v[44:47]
  v_mfma_f32_16x16x32_bf16 v[60:63], v[104:107], v[128:131], v[60:63]
  v_mfma_f32_16x16x32_bf16 v[76:79], v[108:111], v[128:131], v[76:79]
  v_mfma_f32_16x16x32_bf16 v[92:95], v[112:115], v[128:131], v[92:95]
  s_waitcnt vmcnt(0)
  ds_read_b128 v[96:99], v3 offset:18432
  ds_read_b128 v[100:103], v3 offset:20480
  ds_read_b128 v[104:107], v3 offset:22528
  ds_read_b128 v[108:111], v3 offset:24576
  ds_read_b128 v[112:115], v3 offset:26624
  ds_read_b128 v[116:119], v3 offset:28672
  ds_read_b128 v[120:123], v3 offset:30720
  ds_read_b128 v[124:127], v3 offset:32768
  ds_read_b128 v[128:131], v3 offset:34816
  s_waitcnt lgkmcnt(9)
  v_add_u32 v7, 512, v2
  v_add_u32 v15, 512, v13
  s_add_u32 m0, s35, 0
  s_nop 0
  buffer_load_dwordx4 v7, s[16:19], s40 offen lds
  s_add_u32 m0, s35, 1024
  s_nop 0
  buffer_load_dwordx4 v15, s[16:19], s40 offen lds
  s_add_u32 m0, s35, 2048
  s_nop 0
  buffer_load_dwordx4 v7, s[16:19], s41 offen lds
  s_add_u32 m0, s35, 3072
  s_nop 0
  buffer_load_dwordx4 v15, s[16:19], s41 offen lds
  s_add_u32 m0, s35, 4096
  s_nop 0
  buffer_load_dwordx4 v7, s[16:19], s42 offen lds
  s_add_u32 m0, s35, 5120
  s_nop 0
  buffer_load_dwordx4 v15, s[16:19], s42 offen lds
  s_add_u32 m0, s35, 6144
  s_nop 0
  buffer_load_dwordx4 v7, s[16:19], s43 offen lds
  s_add_u32 m0, s35, 7168
  s_nop 0
  buffer_load_dwordx4 v15, s[16:19], s43 offen lds
  s_add_u32 m0, s35, 8192
  s_nop 0
  buffer_load_dwordx4 v7, s[16:19], s44 offen lds
  s_add_u32 m0, s35, 9216
  s_nop 0
  buffer_load_dwordx4 v15, s[16:19], s44 offen lds
  s_add_u32 m0, s35, 10240
  s_nop 0
  buffer_load_dwordx4 v7, s[12:15], s36 offen lds
  s_add_u32 m0, s35, 11264
  s_nop 0
  buffer_load_dwordx4 v15, s[12:15], s36 offen lds
  s_add_u32 m0, s35, 12288
  s_nop 0
  buffer_load_dwordx4 v7, s[12:15], s37 offen lds
  s_add_u32 m0, s35, 13312
  s_nop 0
  buffer_load_dwordx4 v15, s[12:15], s37 offen lds
  s_add_u32 m0, s35, 14336
  s_nop 0
  buffer_load_dwordx4 v7, s[12:15], s38 offen lds
  s_add_u32 m0, s35, 15360
  s_nop 0
  buffer_load_dwordx4 v15, s[12:15], s38 offen lds
  s_add_u32 m0, s35, 16384
  s_nop 0
  buffer_load_dwordx4 v7, s[12:15], s39 offen lds
  s_add_u32 m0, s35, 17408
  s_nop 0
  buffer_load_dwordx4 v15, s[12:15], s39 offen lds
  v_mfma_f32_16x16x32_bf16 v[16:19], v[132:135], v[152:155], v[16:19]
  v_mfma_f32_16x16x32_bf16 v[32:35], v[136:139], v[152:155], v[32:35]
  v_mfma_f32_16x16x32_bf16 v[48:51], v[140:143], v[152:155], v[48:51]
  v_mfma_f32_16x16x32_bf16 v[64:67], v[144:147], v[152:155], v[64:67]
  v_mfma_f32_16x16x32_bf16 v[80:83], v[148:151], v[152:155], v[80:83]
  v_mfma_f32_16x16x32_bf16 v[20:23], v[132:135], v[156:159], v[20:23]
  v_mfma_f32_16x16x32_bf16 v[36:39], v[136:139], v[156:159], v[36:39]
  v_mfma_f32_16x16x32_bf16 v[52:55], v[140:143], v[156:159], v[52:55]
  v_mfma_f32_16x16x32_bf16 v[68:71], v[144:147], v[156:159], v[68:71]
  v_mfma_f32_16x16x32_bf16 v[84:87], v[148:151], v[156:159], v[84:87]
  v_mfma_f32_16x16x32_bf16 v[24:27], v[132:135], v[160:163], v[24:27]
  v_mfma_f32_16x16x32_bf16 v[40:43], v[136:139], v[160:163], v[40:43]
  v_mfma_f32_16x16x32_bf16 v[56:59], v[140:143], v[160:163], v[56:59]
  v_mfma_f32_16x16x32_bf16 v[72:75], v[144:147], v[160:163], v[72:75]
  v_mfma_f32_16x16x32_bf16 v[88:91], v[148:151], v[160:163], v[88:91]
  v_mfma_f32_16x16x32_bf16 v[28:31], v[132:135], v[164:167], v[28:31]
  v_mfma_f32_16x16x32_bf16 v[44:47], v[136:139], v[164:167], v[44:47]
  v_mfma_f32_16x16x32_bf16 v[60:63], v[140:143], v[164:167], v[60:63]
  v_mfma_f32_16x16x32_bf16 v[76:79], v[144:147], v[164:167], v[76:79]
  v_mfma_f32_16x16x32_bf16 v[92:95], v[148:151], v[164:167], v[92:95]
  ds_read_b128 v[132:135], v14 offset:18432
  ds_read_b128 v[136:139], v14 offset:20480
  ds_read_b128 v[140:143], v14 offset:22528
  ds_read_b128 v[144:147], v14 offset:24576
  ds_read_b128 v[148:151], v14 offset:26624
  ds_read_b128 v[152:155], v14 offset:28672
  ds_read_b128 v[156:159], v14 offset:30720
  ds_read_b128 v[160:163], v14 offset:32768
  ds_read_b128 v[164:167], v14 offset:34816
  s_waitcnt lgkmcnt(9)
  v_mfma_f32_16x16x32_bf16 v[16:19], v[96:99], v[116:119], v[16:19]
  v_mfma_f32_16x16x32_bf16 v[32:35], v[100:103], v[116:119], v[32:35]
  v_mfma_f32_16x16x32_bf16 v[48:51], v[104:107], v[116:119], v[48:51]
  v_mfma_f32_16x16x32_bf16 v[64:67], v[108:111], v[116:119], v[64:67]
  v_mfma_f32_16x16x32_bf16 v[80:83], v[112:115], v[116:119], v[80:83]
  v_mfma_f32_16x16x32_bf16 v[20:23], v[96:99], v[120:123], v[20:23]
  v_mfma_f32_16x16x32_bf16 v[36:39], v[100:103], v[120:123], v[36:39]
  v_mfma_f32_16x16x32_bf16 v[52:55], v[104:107], v[120:123], v[52:55]
  v_mfma_f32_16x16x32_bf16 v[68:71], v[108:111], v[120:123], v[68:71]
  v_mfma_f32_16x16x32_bf16 v[84:87], v[112:115], v[120:123], v[84:87]
  v_mfma_f32_16x16x32_bf16 v[24:27], v[96:99], v[124:127], v[24:27]
  v_mfma_f32_16x16x32_bf16 v[40:43], v[100:103], v[124:127], v[40:43]
  v_mfma_f32_16x16x32_bf16 v[56:59], v[104:107], v[124:127], v[56:59]
  v_mfma_f32_16x16x32_bf16 v[72:75], v[108:111], v[124:127], v[72:75]
  v_mfma_f32_16x16x32_bf16 v[88:91], v[112:115], v[124:127], v[88:91]
  v_mfma_f32_16x16x32_bf16 v[28:31], v[96:99], v[128:131], v[28:31]
  v_mfma_f32_16x16x32_bf16 v[44:47], v[100:103], v[128:131], v[44:47]
  v_mfma_f32_16x16x32_bf16 v[60:63], v[104:107], v[128:131], v[60:63]
  v_mfma_f32_16x16x32_bf16 v[76:79], v[108:111], v[128:131], v[76:79]
  v_mfma_f32_16x16x32_bf16 v[92:95], v[112:115], v[128:131], v[92:95]
  s_waitcnt vmcnt(0)
  ds_read_b128 v[96:99], v3 offset:0
  ds_read_b128 v[100:103], v3 offset:2048
  ds_read_b128 v[104:107], v3 offset:4096
  ds_read_b128 v[108:111], v3 offset:6144
  ds_read_b128 v[112:115], v3 offset:8192
  ds_read_b128 v[116:119], v3 offset:10240
  ds_read_b128 v[120:123], v3 offset:12288
  ds_read_b128 v[124:127], v3 offset:14336
  ds_read_b128 v[128:131], v3 offset:16384
  s_waitcnt lgkmcnt(9)
  v_add_u32 v7, 640, v2
  v_add_u32 v15, 640, v13
  s_add_u32 m0, s35, 18432
  s_nop 0
  buffer_load_dwordx4 v7, s[16:19], s40 offen lds
  s_add_u32 m0, s35, 19456
  s_nop 0
  buffer_load_dwordx4 v15, s[16:19], s40 offen lds
  s_add_u32 m0, s35, 20480
  s_nop 0
  buffer_load_dwordx4 v7, s[16:19], s41 offen lds
  s_add_u32 m0, s35, 21504
  s_nop 0
  buffer_load_dwordx4 v15, s[16:19], s41 offen lds
  s_add_u32 m0, s35, 22528
  s_nop 0
  buffer_load_dwordx4 v7, s[16:19], s42 offen lds
  s_add_u32 m0, s35, 23552
  s_nop 0
  buffer_load_dwordx4 v15, s[16:19], s42 offen lds
  s_add_u32 m0, s35, 24576
  s_nop 0
  buffer_load_dwordx4 v7, s[16:19], s43 offen lds
  s_add_u32 m0, s35, 25600
  s_nop 0
  buffer_load_dwordx4 v15, s[16:19], s43 offen lds
  s_add_u32 m0, s35, 26624
  s_nop 0
  buffer_load_dwordx4 v7, s[16:19], s44 offen lds
  s_add_u32 m0, s35, 27648
  s_nop 0
  buffer_load_dwordx4 v15, s[16:19], s44 offen lds
  s_add_u32 m0, s35, 28672
  s_nop 0
  buffer_load_dwordx4 v7, s[12:15], s36 offen lds
  s_add_u32 m0, s35, 29696
  s_nop 0
  buffer_load_dwordx4 v15, s[12:15], s36 offen lds
  s_add_u32 m0, s35, 30720
  s_nop 0
  buffer_load_dwordx4 v7, s[12:15], s37 offen lds
  s_add_u32 m0, s35, 31744
  s_nop 0
  buffer_load_dwordx4 v15, s[12:15], s37 offen lds
  s_add_u32 m0, s35, 32768
  s_nop 0
  buffer_load_dwordx4 v7, s[12:15], s38 offen lds
  s_add_u32 m0, s35, 33792
  s_nop 0
  buffer_load_dwordx4 v15, s[12:15], s38 offen lds
  s_add_u32 m0, s35, 34816
  s_nop 0
  buffer_load_dwordx4 v7, s[12:15], s39 offen lds
  s_add_u32 m0, s35, 35840
  s_nop 0
  buffer_load_dwordx4 v15, s[12:15], s39 offen lds
  v_mfma_f32_16x16x32_bf16 v[16:19], v[132:135], v[152:155], v[16:19]
  v_mfma_f32_16x16x32_bf16 v[32:35], v[136:139], v[152:155], v[32:35]
  v_mfma_f32_16x16x32_bf16 v[48:51], v[140:143], v[152:155], v[48:51]
  v_mfma_f32_16x16x32_bf16 v[64:67], v[144:147], v[152:155], v[64:67]
  v_mfma_f32_16x16x32_bf16 v[80:83], v[148:151], v[152:155], v[80:83]
  v_mfma_f32_16x16x32_bf16 v[20:23], v[132:135], v[156:159], v[20:23]
  v_mfma_f32_16x16x32_bf16 v[36:39], v[136:139], v[156:159], v[36:39]
  v_mfma_f32_16x16x32_bf16 v[52:55], v[140:143], v[156:159], v[52:55]
  v_mfma_f32_16x16x32_bf16 v[68:71], v[144:147], v[156:159], v[68:71]
  v_mfma_f32_16x16x32_bf16 v[84:87], v[148:151], v[156:159], v[84:87]
  v_mfma_f32_16x16x32_bf16 v[24:27], v[132:135], v[160:163], v[24:27]
  v_mfma_f32_16x16x32_bf16 v[40:43], v[136:139], v[160:163], v[40:43]
  v_mfma_f32_16x16x32_bf16 v[56:59], v[140:143], v[160:163], v[56:59]
  v_mfma_f32_16x16x32_bf16 v[72:75], v[144:147], v[160:163], v[72:75]
  v_mfma_f32_16x16x32_bf16 v[88:91], v[148:151], v[160:163], v[88:91]
  v_mfma_f32_16x16x32_bf16 v[28:31], v[132:135], v[164:167], v[28:31]
  v_mfma_f32_16x16x32_bf16 v[44:47], v[136:139], v[164:167], v[44:47]
  v_mfma_f32_16x16x32_bf16 v[60:63], v[140:143], v[164:167], v[60:63]
  v_mfma_f32_16x16x32_bf16 v[76:79], v[144:147], v[164:167], v[76:79]
  v_mfma_f32_16x16x32_bf16 v[92:95], v[148:151], v[164:167], v[92:95]
  ds_read_b128 v[132:135], v14 offset:0
  ds_read_b128 v[136:139], v14 offset:2048
  ds_read_b128 v[140:143], v14 offset:4096
  ds_read_b128 v[144:147], v14 offset:6144
  ds_read_b128 v[148:151], v14 offset:8192
  ds_read_b128 v[152:155], v14 offset:10240
  ds_read_b128 v[156:159], v14 offset:12288
  ds_read_b128 v[160:163], v14 offset:14336
  ds_read_b128 v[164:167], v14 offset:16384
  s_waitcnt lgkmcnt(9)
  v_mfma_f32_16x16x32_bf16 v[16:19], v[96:99], v[116:119], v[16:19]
  v_mfma_f32_16x16x32_bf16 v[32:35], v[100:103], v[116:119], v[32:35]
  v_mfma_f32_16x16x32_bf16 v[48:51], v[104:107], v[116:119], v[48:51]
  v_mfma_f32_16x16x32_bf16 v[64:67], v[108:111], v[116:119], v[64:67]
  v_mfma_f32_16x16x32_bf16 v[80:83], v[112:115], v[116:119], v[80:83]
  v_mfma_f32_16x16x32_bf16 v[20:23], v[96:99], v[120:123], v[20:23]
  v_mfma_f32_16x16x32_bf16 v[36:39], v[100:103], v[120:123], v[36:39]
  v_mfma_f32_16x16x32_bf16 v[52:55], v[104:107], v[120:123], v[52:55]
  v_mfma_f32_16x16x32_bf16 v[68:71], v[108:111], v[120:123], v[68:71]
  v_mfma_f32_16x16x32_bf16 v[84:87], v[112:115], v[120:123], v[84:87]
  v_mfma_f32_16x16x32_bf16 v[24:27], v[96:99], v[124:127], v[24:27]
  v_mfma_f32_16x16x32_bf16 v[40:43], v[100:103], v[124:127], v[40:43]
  v_mfma_f32_16x16x32_bf16 v[56:59], v[104:107], v[124:127], v[56:59]
  v_mfma_f32_16x16x32_bf16 v[72:75], v[108:111], v[124:127], v[72:75]
  v_mfma_f32_16x16x32_bf16 v[88:91], v[112:115], v[124:127], v[88:91]
  v_mfma_f32_16x16x32_bf16 v[28:31], v[96:99], v[128:131], v[28:31]
  v_mfma_f32_16x16x32_bf16 v[44:47], v[100:103], v[128:131], v[44:47]
  v_mfma_f32_16x16x32_bf16 v[60:63], v[104:107], v[128:131], v[60:63]
  v_mfma_f32_16x16x32_bf16 v[76:79], v[108:111], v[128:131], v[76:79]
  v_mfma_f32_16x16x32_bf16 v[92:95], v[112:115], v[128:131], v[92:95]
  s_waitcnt vmcnt(0)
  ds_read_b128 v[96:99], v3 offset:18432
  ds_read_b128 v[100:103], v3 offset:20480
  ds_read_b128 v[104:107], v3 offset:22528
  ds_read_b128 v[108:111], v3 offset:24576
  ds_read_b128 v[112:115], v3 offset:26624
  ds_read_b128 v[116:119], v3 offset:28672
  ds_read_b128 v[120:123], v3 offset:30720
  ds_read_b128 v[124:127], v3 offset:32768
  ds_read_b128 v[128:131], v3 offset:34816
  s_waitcnt lgkmcnt(9)
  v_mfma_f32_16x16x32_bf16 v[16:19], v[132:135], v[152:155], v[16:19]
  v_mfma_f32_16x16x32_bf16 v[32:35], v[136:139], v[152:155], v[32:35]
  v_mfma_f32_16x16x32_bf16 v[48:51], v[140:143], v[152:155], v[48:51]
  v_mfma_f32_16x16x32_bf16 v[64:67], v[144:147], v[152:155], v[64:67]
  v_mfma_f32_16x16x32_bf16 v[80:83], v[148:151], v[152:155], v[80:83]
  v_mfma_f32_16x16x32_bf16 v[20:23], v[132:135], v[156:159], v[20:23]
  v_mfma_f32_16x16x32_bf16 v[36:39], v[136:139], v[156:159], v[36:39]
  v_mfma_f32_16x16x32_bf16 v[52:55], v[140:143], v[156:159], v[52:55]
  v_mfma_f32_16x16x32_bf16 v[68:71], v[144:147], v[156:159], v[68:71]
  v_mfma_f32_16x16x32_bf16 v[84:87], v[148:151], v[156:159], v[84:87]
  v_mfma_f32_16x16x32_bf16 v[24:27], v[132:135], v[160:163], v[24:27]
  v_mfma_f32_16x16x32_bf16 v[40:43], v[136:139], v[160:163], v[40:43]
  v_mfma_f32_16x16x32_bf16 v[56:59], v[140:143], v[160:163], v[56:59]
  v_mfma_f32_16x16x32_bf16 v[72:75], v[144:147], v[160:163], v[72:75]
  v_mfma_f32_16x16x32_bf16 v[88:91], v[148:151], v[160:163], v[88:91]
  v_mfma_f32_16x16x32_bf16 v[28:31], v[132:135], v[164:167], v[28:31]
  v_mfma_f32_16x16x32_bf16 v[44:47], v[136:139], v[164:167], v[44:47]
  v_mfma_f32_16x16x32_bf16 v[60:63], v[140:143], v[164:167], v[60:63]
  v_mfma_f32_16x16x32_bf16 v[76:79], v[144:147], v[164:167], v[76:79]
  v_mfma_f32_16x16x32_bf16 v[92:95], v[148:151], v[164:167], v[92:95]
  ds_read_b128 v[132:135], v14 offset:18432
  ds_read_b128 v[136:139], v14 offset:20480
  ds_read_b128 v[140:143], v14 offset:22528
  ds_read_b128 v[144:147], v14 offset:24576
  ds_read_b128 v[148:151], v14 offset:26624
  ds_read_b128 v[152:155], v14 offset:28672
  ds_read_b128 v[156:159], v14 offset:30720
  ds_read_b128 v[160:163], v14 offset:32768
  ds_read_b128 v[164:167], v14 offset:34816
  s_waitcnt lgkmcnt(9)
  v_mfma_f32_16x16x32_bf16 v[16:19], v[96:99], v[116:119], v[16:19]
  v_mfma_f32_16x16x32_bf16 v[32:35], v[100:103], v[116:119], v[32:35]
  v_mfma_f32_16x16x32_bf16 v[48:51], v[104:107], v[116:119], v[48:51]
  v_mfma_f32_16x16x32_bf16 v[64:67], v[108:111], v[116:119], v[64:67]
  v_mfma_f32_16x16x32_bf16 v[80:83], v[112:115], v[116:119], v[80:83]
  v_mfma_f32_16x16x32_bf16 v[20:23], v[96:99], v[120:123], v[20:23]
  v_mfma_f32_16x16x32_bf16 v[36:39], v[100:103], v[120:123], v[36:39]
  v_mfma_f32_16x16x32_bf16 v[52:55], v[104:107], v[120:123], v[52:55]
  v_mfma_f32_16x16x32_bf16 v[68:71], v[108:111], v[120:123], v[68:71]
  v_mfma_f32_16x16x32_bf16 v[84:87], v[112:115], v[120:123], v[84:87]
  v_mfma_f32_16x16x32_bf16 v[24:27], v[96:99], v[124:127], v[24:27]
  v_mfma_f32_16x16x32_bf16 v[40:43], v[100:103], v[124:127], v[40:43]
  v_mfma_f32_16x16x32_bf16 v[56:59], v[104:107], v[124:127], v[56:59]
  v_mfma_f32_16x16x32_bf16 v[72:75], v[108:111], v[124:127], v[72:75]
  v_mfma_f32_16x16x32_bf16 v[88:91], v[112:115], v[124:127], v[88:91]
  v_mfma_f32_16x16x32_bf16 v[28:31], v[96:99], v[128:131], v[28:31]
  v_mfma_f32_16x16x32_bf16 v[44:47], v[100:103], v[128:131], v[44:47]
  v_mfma_f32_16x16x32_bf16 v[60:63], v[104:107], v[128:131], v[60:63]
  v_mfma_f32_16x16x32_bf16 v[76:79], v[108:111], v[128:131], v[76:79]
  v_mfma_f32_16x16x32_bf16 v[92:95], v[112:115], v[128:131], v[92:95]
  s_waitcnt lgkmcnt(0)
  v_mfma_f32_16x16x32_bf16 v[16:19], v[132:135], v[152:155], v[16:19]
  v_mfma_f32_16x16x32_bf16 v[32:35], v[136:139], v[152:155], v[32:35]
  v_mfma_f32_16x16x32_bf16 v[48:51], v[140:143], v[152:155], v[48:51]
  v_mfma_f32_16x16x32_bf16 v[64:67], v[144:147], v[152:155], v[64:67]
  v_mfma_f32_16x16x32_bf16 v[80:83], v[148:151], v[152:155], v[80:83]
  v_mfma_f32_16x16x32_bf16 v[20:23], v[132:135], v[156:159], v[20:23]
  v_mfma_f32_16x16x32_bf16 v[36:39], v[136:139], v[156:159], v[36:39]
  v_mfma_f32_16x16x32_bf16 v[52:55], v[140:143], v[156:159], v[52:55]
  v_mfma_f32_16x16x32_bf16 v[68:71], v[144:147], v[156:159], v[68:71]
  v_mfma_f32_16x16x32_bf16 v[84:87], v[148:151], v[156:159], v[84:87]
  v_mfma_f32_16x16x32_bf16 v[24:27], v[132:135], v[160:163], v[24:27]
  v_mfma_f32_16x16x32_bf16 v[40:43], v[136:139], v[160:163], v[40:43]
  v_mfma_f32_16x16x32_bf16 v[56:59], v[140:143], v[160:163], v[56:59]
  v_mfma_f32_16x16x32_bf16 v[72:75], v[144:147], v[160:163], v[72:75]
  v_mfma_f32_16x16x32_bf16 v[88:91], v[148:151], v[160:163], v[88:91]
  v_mfma_f32_16x16x32_bf16 v[28:31], v[132:135], v[164:167], v[28:31]
  v_mfma_f32_16x16x32_bf16 v[44:47], v[136:139], v[164:167], v[44:47]
  v_mfma_f32_16x16x32_bf16 v[60:63], v[140:143], v[164:167], v[60:63]
  v_mfma_f32_16x16x32_bf16 v[76:79], v[144:147], v[164:167], v[76:79]
  v_mfma_f32_16x16x32_bf16 v[92:95], v[148:151], v[164:167], v[92:95]
L_k5_join:
  v_lshlrev_b32 v8, 4, v1
  v_add_u32 v9, s35, v8
  ds_write_b128 v9, v[20:23] offset:0
  ds_write_b128 v9, v[36:39] offset:1024
  ds_write_b128 v9, v[52:55] offset:2048
  ds_write_b128 v9, v[68:71] offset:3072
  ds_write_b128 v9, v[84:87] offset:4096
  ds_write_b128 v9, v[24:27] offset:5120
  ds_write_b128 v9, v[40:43] offset:6144
  ds_write_b128 v9, v[56:59] offset:7168
  ds_write_b128 v9, v[72:75] offset:8192
  ds_write_b128 v9, v[88:91] offset:9216
  ds_write_b128 v9, v[28:31] offset:10240
  ds_write_b128 v9, v[44:47] offset:11264
  ds_write_b128 v9, v[60:63] offset:12288
  ds_write_b128 v9, v[76:79] offset:13312
  ds_write_b128 v9, v[92:95] offset:14336
  v_and_b32 v10, 15, v1
  v_lshrrev_b32 v11, 4, v1
  v_lshlrev_b32 v11, 3, v11
  v_mul_u32_u24 v12, 1280, v10
  v_add_u32 v12, v12, v11
  s_lshl_b32 s46, s32, 4
  s_add_u32 s46, s46, s33
  s_mul_i32 s46, s46, 1280
  s_lshl_b32 s47, s34, 1
  s_add_u32 s46, s46, s47
  buffer_load_dwordx2 v[96:97], v12, s[20:23], s46 offen offset:0
  buffer_load_dwordx2 v[106:107], v11, s[28:31], s47 offen offset:0
  buffer_load_dwordx2 v[98:99], v12, s[20:23], s46 offen offset:32
  buffer_load_dwordx2 v[108:109], v11, s[28:31], s47 offen offset:32
  buffer_load_dwordx2 v[100:101], v12, s[20:23], s46 offen offset:64
  buffer_load_dwordx2 v[110:111], v11, s[28:31], s47 offen offset:64
  buffer_load_dwordx2 v[102:103], v12, s[20:23], s46 offen offset:96
  buffer_load_dwordx2 v[112:113], v11, s[28:31], s47 offen offset:96
  buffer_load_dwordx2 v[104:105], v12, s[20:23], s46 offen offset:128
  buffer_load_dwordx2 v[114:115], v11, s[28:31], s47 offen offset:128
  s_waitcnt lgkmcnt(0)
  s_barrier
  s_sub_u32 s48, s32, 1
  s_and_b32 s48, s48, 3
  s_mul_i32 s48, s48, 36864
  v_add_u32 v9, s48, v8
  ds_read_b128 v[132:135], v9 offset:0
  ds_read_b128 v[136:139], v9 offset:1024
  ds_read_b128 v[140:143], v9 offset:2048
  ds_read_b128 v[144:147], v9 offset:3072
  ds_read_b128 v[148:151], v9 offset:4096
  s_sub_u32 s48, s32, 2
  s_and_b32 s48, s48, 3
  s_mul_i32 s48, s48, 36864
  v_add_u32 v9, s48, v8
  ds_read_b128 v[152:155], v9 offset:5120
  ds_read_b128 v[156:159], v9 offset:6144
  ds_read_b128 v[160:163], v9 offset:7168
  ds_read_b128 v[164:167], v9 offset:8192
  ds_read_b128 v[168:171], v9 offset:9216
  s_sub_u32 s48, s32, 3
  s_and_b32 s48, s48, 3
  s_mul_i32 s48, s48, 36864
  v_add_u32 v9, s48, v8
  ds_read_b128 v[172:175], v9 offset:10240
  ds_read_b128 v[176:179], v9 offset:11264
  ds_read_b128 v[180:183], v9 offset:12288
  ds_read_b128 v[184:187], v9 offset:13312
  ds_read_b128 v[188:191], v9 offset:14336
  s_waitcnt lgkmcnt(0)
  v_pk_add_f32 v[16:17], v[16:17], v[132:133]
  v_pk_add_f32 v[18:19], v[18:19], v[134:135]
  v_pk_add_f32 v[32:33], v[32:33], v[136:137]
  v_pk_add_f32 v[34:35], v[34:35], v[138:139]
  v_pk_add_f32 v[48:49], v[48:49], v[140:141]
  v_pk_add_f32 v[50:51], v[50:51], v[142:143]
  v_pk_add_f32 v[64:65], v[64:65], v[144:145]
  v_pk_add_f32 v[66:67], v[66:67], v[146:147]
  v_pk_add_f32 v[80:81], v[80:81], v[148:149]
  v_pk_add_f32 v[82:83], v[82:83], v[150:151]
  v_pk_add_f32 v[16:17], v[16:17], v[152:153]
  v_pk_add_f32 v[18:19], v[18:19], v[154:155]
  v_pk_add_f32 v[32:33], v[32:33], v[156:157]
  v_pk_add_f32 v[34:35], v[34:35], v[158:159]
  v_pk_add_f32 v[48:49], v[48:49], v[160:161]
  v_pk_add_f32 v[50:51], v[50:51], v[162:163]
  v_pk_add_f32 v[64:65], v[64:65], v[164:165]
  v_pk_add_f32 v[66:67], v[66:67], v[166:167]
  v_pk_add_f32 v[80:81], v[80:81], v[168:169]
  v_pk_add_f32 v[82:83], v[82:83], v[170:171]
  v_pk_add_f32 v[16:17], v[16:17], v[172:173]
  v_pk_add_f32 v[18:19], v[18:19], v[174:175]
  v_pk_add_f32 v[32:33], v[32:33], v[176:177]
  v_pk_add_f32 v[34:35], v[34:35], v[178:179]
  v_pk_add_f32 v[48:49], v[48:49], v[180:181]
  v_pk_add_f32 v[50:51], v[50:51], v[182:183]
  v_pk_add_f32 v[64:65], v[64:65], v[184:185]
  v_pk_add_f32 v[66:67], v[66:67], v[186:187]
  v_pk_add_f32 v[80:81], v[80:81], v[188:189]
  v_pk_add_f32 v[82:83], v[82:83], v[190:191]
  s_waitcnt vmcnt(0)
  v_cvt_pk_bf16_f32 v192, v16, v17
  v_lshlrev_b32 v193, 16, v192
  v_and_b32 v194, 0xffff0000, v192
  v_lshlrev_b32 v195, 16, v106
  v_and_b32 v196, 0xffff0000, v106
  v_add_f32 v193, v193, v195
  v_add_f32 v194, v194, v196
  v_cvt_pk_bf16_f32 v192, v193, v194
  v_lshlrev_b32 v193, 16, v192
  v_and_b32 v194, 0xffff0000, v192
  v_lshlrev_b32 v195, 16, v96
  v_and_b32 v196, 0xffff0000, v96
  v_add_f32 v193, v193, v195
  v_add_f32 v194, v194, v196
  v_cvt_pk_bf16_f32 v198, v193, v194
  v_cvt_pk_bf16_f32 v192, v18, v19
  v_lshlrev_b32 v193, 16, v192
  v_and_b32 v194, 0xffff0000, v192
  v_lshlrev_b32 v195, 16, v107
  v_and_b32 v196, 0xffff0000, v107
  v_add_f32 v193, v193, v195
  v_add_f32 v194, v194, v196
  v_cvt_pk_bf16_f32 v192, v193, v194
  v_lshlrev_b32 v193, 16, v192
  v_and_b32 v194, 0xffff0000, v192
  v_lshlrev_b32 v195, 16, v97
  v_and_b32 v196, 0xffff0000, v97
  v_add_f32 v193, v193, v195
  v_add_f32 v194, v194, v196
  v_cvt_pk_bf16_f32 v199, v193, v194
  buffer_store_dwordx2 v[198:199], v12, s[24:27], s46 offen offset:0
  v_cvt_pk_bf16_f32 v192, v32, v33
  v_lshlrev_b32 v193, 16, v192
  v_and_b32 v194, 0xffff0000, v192
  v_lshlrev_b32 v195, 16, v108
  v_and_b32 v196, 0xffff0000, v108
  v_add_f32 v193, v193, v195
  v_add_f32 v194, v194, v196
  v_cvt_pk_bf16_f32 v192, v193, v194
  v_lshlrev_b32 v193, 16, v192
  v_and_b32 v194, 0xffff0000, v192
  v_lshlrev_b32 v195, 16, v98
  v_and_b32 v196, 0xffff0000, v98
  v_add_f32 v193, v193, v195
  v_add_f32 v194, v194, v196
  v_cvt_pk_bf16_f32 v200, v193, v194
  v_cvt_pk_bf16_f32 v192, v34, v35
  v_lshlrev_b32 v193, 16, v192
  v_and_b32 v194, 0xffff0000, v192
  v_lshlrev_b32 v195, 16, v109
  v_and_b32 v196, 0xffff0000, v109
  v_add_f32 v193, v193, v195
  v_add_f32 v194, v194, v196
  v_cvt_pk_bf16_f32 v192, v193, v194
  v_lshlrev_b32 v193, 16, v192
  v_and_b32 v194, 0xffff0000, v192
  v_lshlrev_b32 v195, 16, v99
  v_and_b32 v196, 0xffff0000, v99
  v_add_f32 v193, v193, v195
  v_add_f32 v194, v194, v196
  v_cvt_pk_bf16_f32 v201, v193, v194
  buffer_store_dwordx2 v[200:201], v12, s[24:27], s46 offen offset:32
  v_cvt_pk_bf16_f32 v192, v48, v49
  v_lshlrev_b32 v193, 16, v192
  v_and_b32 v194, 0xffff0000, v192
  v_lshlrev_b32 v195, 16, v110
  v_and_b32 v196, 0xffff0000, v110
  v_add_f32 v193, v193, v195
  v_add_f32 v194, v194, v196
  v_cvt_pk_bf16_f32 v192, v193, v194
  v_lshlrev_b32 v193, 16, v192
  v_and_b32 v194, 0xffff0000, v192
  v_lshlrev_b32 v195, 16, v100
  v_and_b32 v196, 0xffff0000, v100
  v_add_f32 v193, v193, v195
  v_add_f32 v194, v194, v196
  v_cvt_pk_bf16_f32 v198, v193, v194
  v_cvt_pk_bf16_f32 v192, v50, v51
  v_lshlrev_b32 v193, 16, v192
  v_and_b32 v194, 0xffff0000, v192
  v_lshlrev_b32 v195, 16, v111
  v_and_b32 v196, 0xffff0000, v111
  v_add_f32 v193, v193, v195
  v_add_f32 v194, v194, v196
  v_cvt_pk_bf16_f32 v192, v193, v194
  v_lshlrev_b32 v193, 16, v192
  v_and_b32 v194, 0xffff0000, v192
  v_lshlrev_b32 v195, 16, v101
  v_and_b32 v196, 0xffff0000, v101
  v_add_f32 v193, v193, v195
  v_add_f32 v194, v194, v196
  v_cvt_pk_bf16_f32 v199, v193, v194
  buffer_store_dwordx2 v[198:199], v12, s[24:27], s46 offen offset:64
  v_cvt_pk_bf16_f32 v192, v64, v65
  v_lshlrev_b32 v193, 16, v192
  v_and_b32 v194, 0xffff0000, v192
  v_lshlrev_b32 v195, 16, v112
  v_and_b32 v196, 0xffff0000, v112
  v_add_f32 v193, v193, v195
  v_add_f32 v194, v194, v196
  v_cvt_pk_bf16_f32 v192, v193, v194
  v_lshlrev_b32 v193, 16, v192
  v_and_b32 v194, 0xffff0000, v192
  v_lshlrev_b32 v195, 16, v102
  v_and_b32 v196, 0xffff0000, v102
  v_add_f32 v193, v193, v195
  v_add_f32 v194, v194, v196
  v_cvt_pk_bf16_f32 v200, v193, v194
  v_cvt_pk_bf16_f32 v192, v66, v67
  v_lshlrev_b32 v193, 16, v192
  v_and_b32 v194, 0xffff0000, v192
  v_lshlrev_b32 v195, 16, v113
  v_and_b32 v196, 0xffff0000, v113
  v_add_f32 v193, v193, v195
  v_add_f32 v194, v194, v196
  v_cvt_pk_bf16_f32 v192, v193, v194
  v_lshlrev_b32 v193, 16, v192
  v_and_b32 v194, 0xffff0000, v192
  v_lshlrev_b32 v195, 16, v103
  v_and_b32 v196, 0xffff0000, v103
  v_add_f32 v193, v193, v195
  v_add_f32 v194, v194, v196
  v_cvt_pk_bf16_f32 v201, v193, v194
  buffer_store_dwordx2 v[200:201], v12, s[24:27], s46 offen offset:96
  v_cvt_pk_bf16_f32 v192, v80, v81
  v_lshlrev_b32 v193, 16, v192
  v_and_b32 v194, 0xffff0000, v192
  v_lshlrev_b32 v195, 16, v114
  v_and_b32 v196, 0xffff0000, v114
  v_add_f32 v193, v193, v195
  v_add_f32 v194, v194, v196
  v_cvt_pk_bf16_f32 v192, v193, v194
  v_lshlrev_b32 v193, 16, v192
  v_and_b32 v194, 0xffff0000, v192
  v_lshlrev_b32 v195, 16, v104
  v_and_b32 v196, 0xffff0000, v104
  v_add_f32 v193, v193, v195
  v_add_f32 v194, v194, v196
  v_cvt_pk_bf16_f32 v198, v193, v194
  v_cvt_pk_bf16_f32 v192, v82, v83
  v_lshlrev_b32 v193, 16, v192
  v_and_b32 v194, 0xffff0000, v192
  v_lshlrev_b32 v195, 16, v115
  v_and_b32 v196, 0xffff0000, v115
  v_add_f32 v193, v193, v195
  v_add_f32 v194, v194, v196
  v_cvt_pk_bf16_f32 v192, v193, v194
  v_lshlrev_b32 v193, 16, v192
  v_and_b32 v194, 0xffff0000, v192
  v_lshlrev_b32 v195, 16, v105
  v_and_b32 v196, 0xffff0000, v105
  v_add_f32 v193, v193, v195
  v_add_f32 v194, v194, v196
  v_cvt_pk_bf16_f32 v199, v193, v194
  buffer_store_dwordx2 v[198:199], v12, s[24:27], s46 offen offset:128
L_k5_done:
  s_endpgm
.section .rodata,"a"
.p2align 6
.amdhsa_kernel k1_kernel
  .amdhsa_next_free_vgpr 72
  .amdhsa_next_free_sgpr 102
  .amdhsa_accum_offset 72
  .amdhsa_group_segment_fixed_size 0
  .amdhsa_kernarg_size 88
  .amdhsa_user_sgpr_count 2
  .amdhsa_user_sgpr_kernarg_segment_ptr 1
  .amdhsa_system_sgpr_workgroup_id_x 1
.end_amdhsa_kernel
.p2align 6
.amdhsa_kernel k2_kernel
  .amdhsa_next_free_vgpr 104
  .amdhsa_next_free_sgpr 102
  .amdhsa_accum_offset 104
  .amdhsa_group_segment_fixed_size 0
  .amdhsa_kernarg_size 88
  .amdhsa_user_sgpr_count 2
  .amdhsa_user_sgpr_kernarg_segment_ptr 1
  .amdhsa_system_sgpr_workgroup_id_x 1
.end_amdhsa_kernel
.p2align 6
.amdhsa_kernel k3_kernel
  .amdhsa_next_free_vgpr 88
  .amdhsa_next_free_sgpr 102
  .amdhsa_accum_offset 88
  .amdhsa_group_segment_fixed_size 0
  .amdhsa_kernarg_size 88
  .amdhsa_user_sgpr_count 2
  .amdhsa_user_sgpr_kernarg_segment_ptr 1
  .amdhsa_system_sgpr_workgroup_id_x 1
.end_amdhsa_kernel
.p2align 6
.amdhsa_kernel k4_kernel
  .amdhsa_next_free_vgpr 160
  .amdhsa_next_free_sgpr 102
  .amdhsa_accum_offset 160
  .amdhsa_group_segment_fixed_size 0
  .amdhsa_kernarg_size 88
  .amdhsa_user_sgpr_count 2
  .amdhsa_user_sgpr_kernarg_segment_ptr 1
  .amdhsa_system_sgpr_workgroup_id_x 1
.end_amdhsa_kernel
.p2align 6
.amdhsa_kernel k5_kernel
  .amdhsa_next_free_vgpr 208
  .amdhsa_next_free_sgpr 102
  .amdhsa_accum_offset 208
  .amdhsa_group_segment_fixed_size 0
  .amdhsa_kernarg_size 88
  .amdhsa_user_sgpr_count 2
  .amdhsa_user_sgpr_kernarg_segment_ptr 1
  .amdhsa_system_sgpr_workgroup_id_x 1
.end_amdhsa_kernel
```
